```python
import torch

def _softmax(x, axis=-1):
    return torch.softmax(x, dim=axis)
def _gelu(x):
    return torch.nn.functional.gelu(x, approximate="tanh")
def _silu(x):
    return torch.nn.functional.silu(x)
def _sigmoid(x):
    return torch.sigmoid(x)
def _layernorm(x, axis=-1, eps=1e-5):
    m = x.mean(dim=axis, keepdim=True)
    v = x.var(dim=axis, keepdim=True, unbiased=False)
    return (x - m) / torch.sqrt(v + eps)
def _scatter_add(tgt, idx, src, axis=0):
    return tgt.clone().index_add_(axis, idx, src)
def _segment_sum(src, seg, n):
    out = torch.zeros((n,) + src.shape[1:], dtype=src.dtype)
    return out.index_add_(0, seg, src)
def _pad(x, pw):
    flat = tuple(v for pair in reversed(pw) for v in pair)
    return torch.nn.functional.pad(x, flat)

kernel_name = 'concat_heads__softmax_full_mha__spectral_gfnet__prompt'

def setup_inputs():

    _w = (lambda a: (lambda t: t.to(torch.bfloat16) if t.is_floating_point() else t)(torch.as_tensor(a)))
    def _A_setup():
        B, S, D = 1, 2048, 448
        return {
            "x": _w((lambda *s: torch.randn(*s, dtype=torch.bfloat16) * 0.2)(B, S, D)),
            "wqkv": _w((lambda *s: torch.randn(*s, dtype=torch.bfloat16) * 0.2)(D, 3 * D)),
            "wo": _w((lambda *s: torch.randn(*s, dtype=torch.bfloat16) * 0.05)(D, D)),
        }
    _A_in = _A_setup()

    def _B_setup():
        B, S, D = 1, 2048, 448
        Df = D // 2 + 1
        return {
            "x": _w((lambda *s: torch.randn(*s, dtype=torch.bfloat16) * 0.05)(B, S, D)),
            "w_r": _w((lambda *s: torch.randn(*s, dtype=torch.bfloat16) * 6.4)(S, Df) * 0.02),
            "w_i": _w((lambda *s: torch.randn(*s, dtype=torch.bfloat16) * 6.4)(S, Df) * 0.02),
        }
    _B_in = _B_setup()

    return {
        "A_x": _A_in["x"],
        "A_wqkv": _A_in["wqkv"],
        "A_wo": _A_in["wo"],
        "B_x": _B_in["x"],
        "B_w_r": _B_in["w_r"],
        "B_w_i": _B_in["w_i"],
    }

def reference(A_x, A_wqkv, A_wo, B_x, B_w_r, B_w_i):
    def _A_ref(x, wqkv, wo):
        B, S, D = x.shape
        H = 16; Dh = D // H
        qkv = (lambda x, *d: x.permute(*d))((x @ wqkv).reshape(B, S, 3, H, Dh), 2, 0, 3, 1, 4)
        q, k, v = qkv[0], qkv[1], qkv[2]
        scale = Dh ** -0.5
        scores = torch.einsum("bhqd,bhkd->bhqk", q, k) * scale
        p = _softmax(scores, axis=-1)
        o = torch.einsum("bhqk,bhkd->bhqd", p, v)
        return (lambda x, *d: x.permute(*d))(o, 0, 2, 1, 3).reshape(B, S, D) @ wo

    def _B_ref(x, w_r, w_i):
        B, S, D = x.shape
        X = (lambda x, axes=(-2,-1): torch.fft.rfft2(x.float(), dim=axes))(x, axes=(-2, -1))
        W = w_r + 1j * w_i
        X = X * W
        y = (lambda x, s, axes=(-2,-1): torch.fft.irfft2(x, s=s, dim=axes).to(torch.bfloat16))(X, (S, D), axes=(-2, -1))
        return y

    a = _A_ref(A_x, A_wqkv, A_wo)
    b = _B_ref(B_x, B_w_r, B_w_i)
    return torch.concatenate([a, b], axis=-1)
```

```asm
; @launch kernel=k1_kernel grid=(256,1,1) block=(512,1,1) lds=163840
; @launch kernel=k2_kernel grid=(256,1,1) block=(512,1,1) lds=141312
; @launch kernel=k3_kernel grid=(256,1,1) block=(256,1,1) lds=76800
.amdgcn_target "amdgcn-amd-amdhsa--gfx950"
.text
.globl k1_kernel
.p2align 8
.type k1_kernel,@function
k1_kernel:
    s_cmp_ge_u32 s2, 256
    s_cbranch_scc1 k1_end
    s_load_dwordx4 s[4:7], s[0:1], 0
    s_load_dwordx2 s[8:9], s[0:1], 24
    s_load_dwordx2 s[10:11], s[0:1], 64
    s_load_dwordx4 s[12:15], s[0:1], 32
    s_getpc_b64 s[42:43]
    s_add_u32 s42, s42, TF@rel32@lo+4
    s_addc_u32 s43, s43, TF@rel32@hi+12
    v_lshrrev_b32 v7, 6, v0
    v_and_b32 v1, 63, v0
    v_readfirstlane_b32 s54, v7
    s_and_b32 s40, s2, 7
    s_lshr_b32 s41, s2, 3
    s_lshr_b32 s16, s40, 1
    s_and_b32 s17, s40, 1
    s_lshl_b32 s17, s17, 3
    s_and_b32 s44, s41, 7
    s_or_b32 s17, s17, s44
    s_lshr_b32 s18, s41, 3
    s_and_b32 s19, s54, 3
    s_cmp_eq_u32 s16, 3
    s_mov_b32 s44, 896
    s_cselect_b32 s44, 57344, s44
    s_mov_b32 s47, 2688
    s_cselect_b32 s47, 1024, s47
    s_mov_b32 s45, 8*896
    s_cselect_b32 s45, 512*896, s45
    s_lshl_b32 s48, s17, 7
    s_lshl_b32 s49, s19, 5
    s_add_u32 s48, s48, s49
    s_lshl_b32 s49, s17, 2
    s_add_u32 s49, s49, s19
    s_cmp_eq_u32 s16, 3
    s_cselect_b32 s48, s49, s48
    s_mul_i32 s56, s48, 896
    s_lshl_b32 s55, s19, 12
    s_cmp_lt_u32 s54, 4
    s_cbranch_scc1 k1_cons
    s_lshl_b32 s60, s19, 4
    s_mul_i32 s60, s60, s47
    s_lshl_b32 s46, s47, 2
    s_add_u32 s61, s60, s46
    s_add_u32 s62, s61, s46
    s_add_u32 s63, s62, s46
    s_lshl_b32 s46, s47, 6
    v_lshrrev_b32 v7, 4, v1
    v_and_b32 v8, 15, v1
    v_lshlrev_b32 v9, 2, v7
    v_xor_b32 v8, v8, v9
    v_mul_lo_u32 v7, v7, s47
    v_lshl_add_u32 v6, v8, 4, v7
    v_cmp_gt_u32 vcc, 14, v8
    v_mov_b32 v9, 0x40000000
    s_mul_i32 s66, s16, 896
    v_cndmask_b32 v6, v9, v6, vcc
    s_mul_i32 s67, s18, 224
    s_add_u32 s66, s66, s67
    s_lshl_b32 s67, s18, 8
    s_cmp_eq_u32 s16, 3
    s_cselect_b32 s66, s67, s66
    s_mov_b32 s67, 1204224
    s_cselect_b32 s67, 458752, s67
    s_sub_u32 s67, s67, s66
    s_add_u32 s56, s56, 128
    s_load_dwordx2 s[72:73], s[0:1], 16
    s_waitcnt lgkmcnt(0)
    s_cmp_eq_u32 s16, 3
    s_cselect_b32 s48, s42, s6
    s_cselect_b32 s49, s43, s7
    s_add_u32 s48, s48, s66
    s_addc_u32 s49, s49, 0
    s_mov_b32 s24, s48
    s_and_b32 s25, s49, 0xffff
    s_mov_b32 s26, s67
    s_mov_b32 s27, 0x20000
    s_add_u32 m0, s55, 16384
    s_nop 0
    buffer_load_dwordx4 v6, s[24:27], s60 offen lds
    s_add_u32 m0, s55, 17408
    s_add_u32 s60, s60, s46
    buffer_load_dwordx4 v6, s[24:27], s61 offen lds
    s_add_u32 m0, s55, 18432
    s_add_u32 s61, s61, s46
    buffer_load_dwordx4 v6, s[24:27], s62 offen lds
    s_add_u32 m0, s55, 19456
    s_add_u32 s62, s62, s46
    buffer_load_dwordx4 v6, s[24:27], s63 offen lds
    s_add_u32 s63, s63, s46
    s_getpc_b64 s[68:69]
k1_pcS:
    s_sub_u32 s68, s68, k1_pcS-k1_kernel
    s_subb_u32 s69, s69, 0
    s_lshr_b32 s70, s2, 3
    s_and_b32 s70, s70, 31
    s_mul_i32 s70, s70, 4
    s_add_u32 s70, s70, s19
    s_mul_i32 s70, s70, 256
    s_min_u32 s70, s70, k3_end-k1_kernel-256
    s_add_u32 s68, s68, s70
    s_addc_u32 s69, s69, 0
    s_load_dwordx16 s[80:95], s[68:69], 0
    s_load_dwordx16 s[80:95], s[68:69], 64
    s_load_dwordx16 s[80:95], s[68:69], 128
    s_load_dwordx16 s[80:95], s[68:69], 192
    s_add_u32 s57, s56, s45
    s_add_u32 s58, s57, s45
    s_add_u32 s59, s58, s45
    v_lshrrev_b32 v7, 3, v1
    v_and_b32 v8, 7, v1
    v_lshrrev_b32 v9, 1, v7
    v_xor_b32 v8, v8, v9
    v_mul_lo_u32 v7, v7, s44
    v_lshl_add_u32 v4, v8, 4, v7
    v_xor_b32 v8, 4, v8
    v_lshl_add_u32 v5, v8, 4, v7
    s_cmp_eq_u32 s16, 3
    s_cselect_b32 s48, s8, s4
    s_cselect_b32 s49, s9, s5
    s_mov_b32 s20, s48
    s_and_b32 s21, s49, 0xffff
    s_mov_b32 s22, 1835008
    s_mov_b32 s23, 0x20000
    s_add_u32 m0, s55, 32768
    s_nop 0
    buffer_load_dwordx4 v4, s[20:23], s56 offen lds
    s_add_u32 m0, s55, 33792
    s_add_u32 s56, s56, 128
    buffer_load_dwordx4 v5, s[20:23], s57 offen lds
    s_add_u32 m0, s55, 34816
    s_add_u32 s57, s57, 128
    buffer_load_dwordx4 v4, s[20:23], s58 offen lds
    s_add_u32 m0, s55, 35840
    s_add_u32 s58, s58, 128
    buffer_load_dwordx4 v5, s[20:23], s59 offen lds
    s_add_u32 s59, s59, 128
    s_add_u32 m0, s55, 49152
    s_nop 0
    buffer_load_dwordx4 v6, s[24:27], s60 offen lds
    s_add_u32 m0, s55, 50176
    s_add_u32 s60, s60, s46
    buffer_load_dwordx4 v6, s[24:27], s61 offen lds
    s_add_u32 m0, s55, 51200
    s_add_u32 s61, s61, s46
    buffer_load_dwordx4 v6, s[24:27], s62 offen lds
    s_add_u32 m0, s55, 52224
    s_add_u32 s62, s62, s46
    buffer_load_dwordx4 v6, s[24:27], s63 offen lds
    s_add_u32 s63, s63, s46
    s_and_b32 s65, s2, 7
    s_lshr_b32 s66, s2, 3
    s_lshl_b32 s65, s65, 1
    s_and_b32 s67, s66, 1
    s_or_b32 s65, s65, s67
    s_bfe_u32 s67, s66, 0x20001
    s_lshr_b32 s66, s66, 3
    s_lshl_b32 s64, s65, 7
    s_lshl_b32 s50, s67, 3
    s_add_u32 s64, s64, s50
    s_mul_i32 s50, s64, 450
    s_mul_i32 s66, s66, 58
    s_min_u32 s66, s66, 167
    s_lshl_b32 s64, s66, 1
    s_add_u32 s50, s50, s64
    s_add_u32 s51, s50, 14400
    s_add_u32 s52, s50, 28800
    s_add_u32 s53, s50, 43200
    v_and_b32 v0, 255, v0
    v_lshrrev_b32 v12, 3, v0
    v_and_b32 v13, 7, v0
    v_lshrrev_b32 v208, 3, v1
    v_mul_u32_u24 v208, 450, v208
    v_and_b32 v211, 7, v1
    v_lshl_add_u32 v208, v211, 4, v208
    v_cmp_gt_u32 vcc, 29, v12
    v_mul_u32_u24 v209, 16640, v12
    v_lshl_add_u32 v209, v13, 4, v209
    v_mov_b32 v9, 0x40000000
    v_cndmask_b32 v209, v9, v209, vcc
    s_mul_i32 s64, s66, 8320
    s_lshl_b32 s65, s65, 9
    v_add_u32 v210, 8320, v209
    s_add_u32 s65, s65, s64
    s_lshl_b32 s67, s67, 7
    s_add_u32 s65, s65, s67
    s_add_u32 s65, s65, 9437184
    s_mov_b32 s32, s12
    s_and_b32 s33, s13, 0xffff
    s_mov_b32 s34, 921600
    s_mov_b32 s35, 0x20000
    s_mov_b32 s36, s14
    s_and_b32 s37, s15, 0xffff
    s_mov_b32 s38, 921600
    s_mov_b32 s39, 0x20000
    s_and_b32 s44, s19, 1
    s_mul_i32 s44, s44, 28800
    s_add_u32 s44, s44, s50
    s_add_u32 s45, s44, 14400
    s_cmp_ge_u32 s19, 2
    s_cselect_b32 s32, s36, s32
    s_cselect_b32 s33, s37, s33
    buffer_load_dwordx4 v[200:203], v208, s[32:35], s44 offen nt
    buffer_load_dwordx4 v[204:207], v208, s[32:35], s45 offen nt
    s_mov_b32 s28, s10
    s_and_b32 s29, s11, 0xffff
    s_mov_b32 s30, 17825792
    s_mov_b32 s31, 0x20000
    s_waitcnt vmcnt(10)
    s_barrier
    s_add_u32 m0, s55, 65536
    s_nop 0
    buffer_load_dwordx4 v4, s[20:23], s56 offen lds
    s_add_u32 m0, s55, 66560
    s_add_u32 s56, s56, 128
    buffer_load_dwordx4 v5, s[20:23], s57 offen lds
    s_add_u32 m0, s55, 67584
    s_add_u32 s57, s57, 128
    buffer_load_dwordx4 v4, s[20:23], s58 offen lds
    s_add_u32 m0, s55, 68608
    s_add_u32 s58, s58, 128
    buffer_load_dwordx4 v5, s[20:23], s59 offen lds
    s_add_u32 s59, s59, 128
    s_add_u32 m0, s55, 81920
    s_nop 0
    buffer_load_dwordx4 v6, s[24:27], s60 offen lds
    s_add_u32 m0, s55, 82944
    s_add_u32 s60, s60, s46
    buffer_load_dwordx4 v6, s[24:27], s61 offen lds
    s_add_u32 m0, s55, 83968
    s_add_u32 s61, s61, s46
    buffer_load_dwordx4 v6, s[24:27], s62 offen lds
    s_add_u32 m0, s55, 84992
    s_add_u32 s62, s62, s46
    buffer_load_dwordx4 v6, s[24:27], s63 offen lds
    s_add_u32 s63, s63, s46
    s_waitcnt vmcnt(10)
    s_barrier
    s_add_u32 m0, s55, 98304
    s_nop 0
    buffer_load_dwordx4 v4, s[20:23], s56 offen lds
    s_add_u32 m0, s55, 99328
    s_add_u32 s56, s56, 128
    buffer_load_dwordx4 v5, s[20:23], s57 offen lds
    s_add_u32 m0, s55, 100352
    s_add_u32 s57, s57, 128
    buffer_load_dwordx4 v4, s[20:23], s58 offen lds
    s_add_u32 m0, s55, 101376
    s_add_u32 s58, s58, 128
    buffer_load_dwordx4 v5, s[20:23], s59 offen lds
    s_add_u32 s59, s59, 128
    s_add_u32 m0, s55, 114688
    s_nop 0
    buffer_load_dwordx4 v6, s[24:27], s60 offen lds
    s_add_u32 m0, s55, 115712
    s_add_u32 s60, s60, s46
    buffer_load_dwordx4 v6, s[24:27], s61 offen lds
    s_add_u32 m0, s55, 116736
    s_add_u32 s61, s61, s46
    buffer_load_dwordx4 v6, s[24:27], s62 offen lds
    s_add_u32 m0, s55, 117760
    s_add_u32 s62, s62, s46
    buffer_load_dwordx4 v6, s[24:27], s63 offen lds
    s_add_u32 s63, s63, s46
    s_waitcnt vmcnt(8)
    s_barrier
    s_add_u32 m0, s55, 131072
    s_nop 0
    buffer_load_dwordx4 v4, s[20:23], s56 offen lds
    s_add_u32 m0, s55, 132096
    s_add_u32 s56, s56, 128
    buffer_load_dwordx4 v5, s[20:23], s57 offen lds
    s_add_u32 m0, s55, 133120
    s_add_u32 s57, s57, 128
    buffer_load_dwordx4 v4, s[20:23], s58 offen lds
    s_add_u32 m0, s55, 134144
    s_add_u32 s58, s58, 128
    buffer_load_dwordx4 v5, s[20:23], s59 offen lds
    s_add_u32 s59, s59, 128
    s_add_u32 m0, s55, 147456
    s_nop 0
    buffer_load_dwordx4 v6, s[24:27], s60 offen lds
    s_add_u32 m0, s55, 148480
    s_add_u32 s60, s60, s46
    buffer_load_dwordx4 v6, s[24:27], s61 offen lds
    s_add_u32 m0, s55, 149504
    s_add_u32 s61, s61, s46
    buffer_load_dwordx4 v6, s[24:27], s62 offen lds
    s_add_u32 m0, s55, 150528
    s_add_u32 s62, s62, s46
    buffer_load_dwordx4 v6, s[24:27], s63 offen lds
    s_add_u32 s63, s63, s46
    s_waitcnt vmcnt(8)
    s_barrier
    s_add_u32 m0, s55, 0
    s_nop 0
    buffer_load_dwordx4 v4, s[20:23], s56 offen lds
    s_add_u32 m0, s55, 1024
    s_add_u32 s56, s56, 128
    buffer_load_dwordx4 v5, s[20:23], s57 offen lds
    s_add_u32 m0, s55, 2048
    s_add_u32 s57, s57, 128
    buffer_load_dwordx4 v4, s[20:23], s58 offen lds
    s_add_u32 m0, s55, 3072
    s_add_u32 s58, s58, 128
    buffer_load_dwordx4 v5, s[20:23], s59 offen lds
    s_add_u32 s59, s59, 128
    s_add_u32 m0, s55, 16384
    s_nop 0
    buffer_load_dwordx4 v6, s[24:27], s60 offen lds
    s_add_u32 m0, s55, 17408
    s_add_u32 s60, s60, s46
    buffer_load_dwordx4 v6, s[24:27], s61 offen lds
    s_add_u32 m0, s55, 18432
    s_add_u32 s61, s61, s46
    buffer_load_dwordx4 v6, s[24:27], s62 offen lds
    s_add_u32 m0, s55, 19456
    s_add_u32 s62, s62, s46
    buffer_load_dwordx4 v6, s[24:27], s63 offen lds
    s_add_u32 s63, s63, s46
    s_waitcnt vmcnt(8)
    s_barrier
    s_add_u32 m0, s55, 32768
    s_nop 0
    buffer_load_dwordx4 v4, s[20:23], s56 offen lds
    s_add_u32 m0, s55, 33792
    s_add_u32 s56, s56, 128
    buffer_load_dwordx4 v5, s[20:23], s57 offen lds
    s_add_u32 m0, s55, 34816
    s_add_u32 s57, s57, 128
    buffer_load_dwordx4 v4, s[20:23], s58 offen lds
    s_add_u32 m0, s55, 35840
    s_add_u32 s58, s58, 128
    buffer_load_dwordx4 v5, s[20:23], s59 offen lds
    s_add_u32 s59, s59, 128
    s_add_u32 m0, s55, 49152
    s_nop 0
    buffer_load_dwordx4 v6, s[24:27], s60 offen lds
    s_add_u32 m0, s55, 50176
    s_add_u32 s60, s60, s46
    buffer_load_dwordx4 v6, s[24:27], s61 offen lds
    s_add_u32 m0, s55, 51200
    s_add_u32 s61, s61, s46
    buffer_load_dwordx4 v6, s[24:27], s62 offen lds
    s_add_u32 m0, s55, 52224
    s_add_u32 s62, s62, s46
    buffer_load_dwordx4 v6, s[24:27], s63 offen lds
    s_add_u32 s63, s63, s46
    s_mov_b32 s44, s72
    s_mov_b32 s45, s73
    s_getpc_b64 s[46:47]
    s_add_u32 s46, s46, TG@rel32@lo+4
    s_addc_u32 s47, s47, TG@rel32@hi+12
    s_getpc_b64 s[48:49]
    s_add_u32 s48, s48, TB2@rel32@lo+4
    s_addc_u32 s49, s49, TB2@rel32@hi+12
    s_lshl_b32 s50, s2, 12
    s_lshl_b32 s51, s19, 10
    s_add_u32 s50, s50, s51
    s_mov_b32 s52, 458752
    s_cmp_lt_u32 s2, 112
    s_cbranch_scc1 k1_pf1
    s_mov_b32 s46, s44
    s_mov_b32 s47, s45
    s_sub_u32 s50, s50, 458752
    s_mov_b32 s52, 401408
    s_cmp_lt_u32 s2, 210
    s_cbranch_scc1 k1_pf1
    s_mov_b32 s46, s48
    s_mov_b32 s47, s49
    s_sub_u32 s50, s50, 401408
    s_mov_b32 s52, 63488
k1_pf1:
    s_mov_b32 s40, s46
    s_and_b32 s41, s47, 0xffff
    s_mov_b32 s42, s52
    s_mov_b32 s43, 0x20000
    v_lshlrev_b32 v20, 4, v1
    buffer_load_dwordx4 v[28:31], v20, s[40:43], s50 offen
    s_waitcnt vmcnt(9)
    s_barrier
    s_waitcnt vmcnt(41)
    s_mul_i32 s70, s19, 2304
    s_add_u32 s70, s70, 65536
    v_lshrrev_b32 v211, 3, v1
    v_mul_u32_u24 v211, 144, v211
    v_and_b32 v12, 7, v1
    v_lshl_add_u32 v211, v12, 4, v211
    v_add_u32 v211, s70, v211
    ds_write_b128 v211, v[200:203]
    ds_write_b128 v211, v[204:207] offset:1152
    v_lshrrev_b32 v12, 3, v0
    v_and_b32 v13, 7, v0
    v_mul_u32_u24 v13, 144, v13
    v_lshl_add_u32 v211, v12, 2, v13
    v_add_u32 v211, 65536, v211
    s_waitcnt lgkmcnt(0)
    s_waitcnt vmcnt(1)
    s_barrier
    ds_read_b32 v200, v211 offset:0
    ds_read_b32 v201, v211 offset:1152
    ds_read_b32 v202, v211 offset:2304
    ds_read_b32 v203, v211 offset:3456
    ds_read_b32 v204, v211 offset:4608
    ds_read_b32 v205, v211 offset:5760
    ds_read_b32 v206, v211 offset:6912
    ds_read_b32 v207, v211 offset:8064
    s_mov_b32 s70, 0x05040100
    s_mov_b32 s73, 0x07060302
    s_waitcnt lgkmcnt(0)
    v_perm_b32 v212, v204, v200, s70
    v_perm_b32 v216, v204, v200, s73
    v_perm_b32 v213, v205, v201, s70
    v_perm_b32 v217, v205, v201, s73
    v_perm_b32 v214, v206, v202, s70
    v_perm_b32 v218, v206, v202, s73
    v_perm_b32 v215, v207, v203, s70
    v_perm_b32 v219, v207, v203, s73
    buffer_store_dwordx4 v[212:215], v209, s[28:31], s65 offen sc0 sc1
    buffer_store_dwordx4 v[216:219], v210, s[28:31], s65 offen sc0 sc1
    s_endpgm
k1_cons:
    s_add_u32 s57, s56, s45
    s_add_u32 s58, s57, s45
    s_add_u32 s59, s58, s45
    v_lshrrev_b32 v7, 3, v1
    v_and_b32 v8, 7, v1
    v_lshrrev_b32 v9, 1, v7
    v_xor_b32 v8, v8, v9
    v_mul_lo_u32 v7, v7, s44
    v_lshl_add_u32 v4, v8, 4, v7
    v_xor_b32 v8, 4, v8
    v_lshl_add_u32 v5, v8, 4, v7
    s_waitcnt lgkmcnt(0)
    s_cmp_eq_u32 s16, 3
    s_cselect_b32 s48, s8, s4
    s_cselect_b32 s49, s9, s5
    s_mov_b32 s20, s48
    s_and_b32 s21, s49, 0xffff
    s_mov_b32 s22, 1835008
    s_mov_b32 s23, 0x20000
    s_add_u32 m0, s55, 0
    s_nop 0
    buffer_load_dwordx4 v4, s[20:23], s56 offen lds
    s_add_u32 m0, s55, 1024
    s_add_u32 s56, s56, 128
    buffer_load_dwordx4 v5, s[20:23], s57 offen lds
    s_add_u32 m0, s55, 2048
    s_add_u32 s57, s57, 128
    buffer_load_dwordx4 v4, s[20:23], s58 offen lds
    s_add_u32 m0, s55, 3072
    s_add_u32 s58, s58, 128
    buffer_load_dwordx4 v5, s[20:23], s59 offen lds
    s_add_u32 s59, s59, 128
    v_lshlrev_b32 v15, 2, v1
    s_getpc_b64 s[60:61]
k1e_pcA:
    s_sub_u32 s60, s60, k1e_pcA-k1_kernel
    s_subb_u32 s61, s61, 0
    s_and_b32 s61, s61, 0xffff
    s_mov_b32 s62, k3_end-k1_kernel
    s_mov_b32 s63, 0x20000
    s_lshr_b32 s64, s2, 3
    s_mul_i32 s64, s64, 4
    s_add_u32 s64, s64, s19
    s_lshl_b32 s64, s64, 8
    buffer_load_dword v232, v15, s[60:63], s64 offen
    v_and_b32 v2, 31, v1
    v_lshrrev_b32 v3, 5, v1
    v_lshlrev_b32 v4, 4, v1
    s_mov_b32 s28, s10
    s_and_b32 s29, s11, 0xffff
    s_mov_b32 s30, 17825792
    s_mov_b32 s31, 0x20000
    s_lshr_b32 s68, s19, 1
    s_and_b32 s69, s19, 1
    v_lshrrev_b32 v7, 1, v2
    v_and_b32 v7, 7, v7
    s_lshl_b32 s70, s68, 13
    v_lshlrev_b32 v8, 7, v2
    v_add_u32 v8, s70, v8
    v_add_u32 v9, 0, v3
    v_xor_b32 v9, v9, v7
    v_lshl_add_u32 v64, v9, 4, v8
    v_add_u32 v68, 0x10000, v64
    v_add_u32 v72, 0x20000, v64
    v_add_u32 v9, 2, v3
    v_xor_b32 v9, v9, v7
    v_lshl_add_u32 v65, v9, 4, v8
    v_add_u32 v69, 0x10000, v65
    v_add_u32 v73, 0x20000, v65
    v_add_u32 v9, 4, v3
    v_xor_b32 v9, v9, v7
    v_lshl_add_u32 v66, v9, 4, v8
    v_add_u32 v70, 0x10000, v66
    v_add_u32 v74, 0x20000, v66
    v_add_u32 v9, 6, v3
    v_xor_b32 v9, v9, v7
    v_lshl_add_u32 v67, v9, 4, v8
    v_add_u32 v71, 0x10000, v67
    v_add_u32 v75, 0x20000, v67
    v_and_b32 v7, 15, v1
    v_lshrrev_b32 v7, 2, v7
    v_and_b32 v8, 3, v1
    v_bfe_u32 v9, v1, 4, 1
    v_lshlrev_b32 v9, 5, v9
    v_lshl_add_u32 v8, v8, 3, v9
    s_mul_i32 s70, s69, 112
    v_add_u32 v8, s70, v8
    v_lshl_add_u32 v9, v3, 3, v7
    v_lshlrev_b32 v9, 8, v9
    v_lshlrev_b32 v7, 2, v7
    v_add_u32 v12, 0, v8
    v_lshrrev_b32 v13, 4, v12
    v_xor_b32 v13, v13, v7
    v_and_b32 v12, 15, v12
    v_lshl_add_u32 v13, v13, 4, v12
    v_add_u32 v76, v13, v9
    v_add_u32 v78, 0x10000, v76
    v_add_u32 v80, 0x20000, v76
    v_add_u32 v12, 56, v8
    v_lshrrev_b32 v13, 4, v12
    v_xor_b32 v13, v13, v7
    v_and_b32 v12, 15, v12
    v_lshl_add_u32 v13, v13, 4, v12
    v_add_u32 v77, v13, v9
    v_add_u32 v79, 0x10000, v77
    v_add_u32 v81, 0x20000, v77
    v_mov_b32 v128, 0
    v_mov_b32 v129, 0
    v_mov_b32 v130, 0
    v_mov_b32 v131, 0
    v_mov_b32 v132, 0
    v_mov_b32 v133, 0
    v_mov_b32 v134, 0
    v_mov_b32 v135, 0
    v_mov_b32 v136, 0
    v_mov_b32 v137, 0
    v_mov_b32 v138, 0
    v_mov_b32 v139, 0
    v_mov_b32 v140, 0
    v_mov_b32 v141, 0
    v_mov_b32 v142, 0
    v_mov_b32 v143, 0
    v_mov_b32 v144, 0
    v_mov_b32 v145, 0
    v_mov_b32 v146, 0
    v_mov_b32 v147, 0
    v_mov_b32 v148, 0
    v_mov_b32 v149, 0
    v_mov_b32 v150, 0
    v_mov_b32 v151, 0
    v_mov_b32 v152, 0
    v_mov_b32 v153, 0
    v_mov_b32 v154, 0
    v_mov_b32 v155, 0
    v_mov_b32 v156, 0
    v_mov_b32 v157, 0
    v_mov_b32 v158, 0
    v_mov_b32 v159, 0
    v_mov_b32 v160, 0
    v_mov_b32 v161, 0
    v_mov_b32 v162, 0
    v_mov_b32 v163, 0
    v_mov_b32 v164, 0
    v_mov_b32 v165, 0
    v_mov_b32 v166, 0
    v_mov_b32 v167, 0
    v_mov_b32 v168, 0
    v_mov_b32 v169, 0
    v_mov_b32 v170, 0
    v_mov_b32 v171, 0
    v_mov_b32 v172, 0
    v_mov_b32 v173, 0
    v_mov_b32 v174, 0
    v_mov_b32 v175, 0
    v_mov_b32 v176, 0
    v_mov_b32 v177, 0
    v_mov_b32 v178, 0
    v_mov_b32 v179, 0
    v_mov_b32 v180, 0
    v_mov_b32 v181, 0
    v_mov_b32 v182, 0
    v_mov_b32 v183, 0
    v_mov_b32 v184, 0
    v_mov_b32 v185, 0
    v_mov_b32 v186, 0
    v_mov_b32 v187, 0
    v_mov_b32 v188, 0
    v_mov_b32 v189, 0
    v_mov_b32 v190, 0
    v_mov_b32 v191, 0
    s_waitcnt vmcnt(1)
    s_lshl_b32 s71, s17, 2
    s_lshl_b32 s72, s68, 1
    s_add_u32 s71, s71, s72
    s_lshl_b32 s72, s18, 2
    s_lshl_b32 s73, s69, 1
    s_add_u32 s72, s72, s73
    s_cmp_ge_u32 s16, 2
    s_cbranch_scc1 k1_vb
    s_barrier
    ds_read_b128 v[16:19], v64 offset:0
    ds_read_b128 v[20:23], v64 offset:4096
    ds_read_b64_tr_b16 v[32:33], v76 offset:16384
    ds_read_b64_tr_b16 v[34:35], v76 offset:17408
    ds_read_b64_tr_b16 v[36:37], v77 offset:16384
    ds_read_b64_tr_b16 v[38:39], v77 offset:17408
    ds_read_b128 v[24:27], v65 offset:0
    ds_read_b128 v[28:31], v65 offset:4096
    ds_read_b64_tr_b16 v[40:41], v76 offset:20480
    ds_read_b64_tr_b16 v[42:43], v76 offset:21504
    ds_read_b64_tr_b16 v[44:45], v77 offset:20480
    ds_read_b64_tr_b16 v[46:47], v77 offset:21504
    s_waitcnt lgkmcnt(6)
    v_mfma_f32_32x32x16_bf16 v[128:143], v[32:35], v[16:19], v[128:143]
    v_mfma_f32_32x32x16_bf16 v[144:159], v[36:39], v[16:19], v[144:159]
    v_mfma_f32_32x32x16_bf16 v[160:175], v[32:35], v[20:23], v[160:175]
    v_mfma_f32_32x32x16_bf16 v[176:191], v[36:39], v[20:23], v[176:191]
    ds_read_b128 v[16:19], v66 offset:0
    ds_read_b128 v[20:23], v66 offset:4096
    ds_read_b64_tr_b16 v[32:33], v76 offset:24576
    ds_read_b64_tr_b16 v[34:35], v76 offset:25600
    ds_read_b64_tr_b16 v[36:37], v77 offset:24576
    ds_read_b64_tr_b16 v[38:39], v77 offset:25600
    s_waitcnt lgkmcnt(6)
    v_mfma_f32_32x32x16_bf16 v[128:143], v[40:43], v[24:27], v[128:143]
    v_mfma_f32_32x32x16_bf16 v[144:159], v[44:47], v[24:27], v[144:159]
    v_mfma_f32_32x32x16_bf16 v[160:175], v[40:43], v[28:31], v[160:175]
    v_mfma_f32_32x32x16_bf16 v[176:191], v[44:47], v[28:31], v[176:191]
    ds_read_b128 v[24:27], v67 offset:0
    ds_read_b128 v[28:31], v67 offset:4096
    ds_read_b64_tr_b16 v[40:41], v76 offset:28672
    ds_read_b64_tr_b16 v[42:43], v76 offset:29696
    ds_read_b64_tr_b16 v[44:45], v77 offset:28672
    ds_read_b64_tr_b16 v[46:47], v77 offset:29696
    s_waitcnt lgkmcnt(6)
    v_mfma_f32_32x32x16_bf16 v[128:143], v[32:35], v[16:19], v[128:143]
    v_mfma_f32_32x32x16_bf16 v[144:159], v[36:39], v[16:19], v[144:159]
    v_mfma_f32_32x32x16_bf16 v[160:175], v[32:35], v[20:23], v[160:175]
    v_mfma_f32_32x32x16_bf16 v[176:191], v[36:39], v[20:23], v[176:191]
    s_barrier
    ds_read_b128 v[16:19], v64 offset:32768
    ds_read_b128 v[20:23], v64 offset:36864
    ds_read_b64_tr_b16 v[32:33], v76 offset:49152
    ds_read_b64_tr_b16 v[34:35], v76 offset:50176
    ds_read_b64_tr_b16 v[36:37], v77 offset:49152
    ds_read_b64_tr_b16 v[38:39], v77 offset:50176
    s_waitcnt lgkmcnt(6)
    v_mfma_f32_32x32x16_bf16 v[128:143], v[40:43], v[24:27], v[128:143]
    v_mfma_f32_32x32x16_bf16 v[144:159], v[44:47], v[24:27], v[144:159]
    v_mfma_f32_32x32x16_bf16 v[160:175], v[40:43], v[28:31], v[160:175]
    v_mfma_f32_32x32x16_bf16 v[176:191], v[44:47], v[28:31], v[176:191]
    ds_read_b128 v[24:27], v65 offset:32768
    ds_read_b128 v[28:31], v65 offset:36864
    ds_read_b64_tr_b16 v[40:41], v76 offset:53248
    ds_read_b64_tr_b16 v[42:43], v76 offset:54272
    ds_read_b64_tr_b16 v[44:45], v77 offset:53248
    ds_read_b64_tr_b16 v[46:47], v77 offset:54272
    s_waitcnt lgkmcnt(6)
    v_mfma_f32_32x32x16_bf16 v[128:143], v[32:35], v[16:19], v[128:143]
    v_mfma_f32_32x32x16_bf16 v[144:159], v[36:39], v[16:19], v[144:159]
    v_mfma_f32_32x32x16_bf16 v[160:175], v[32:35], v[20:23], v[160:175]
    v_mfma_f32_32x32x16_bf16 v[176:191], v[36:39], v[20:23], v[176:191]
    ds_read_b128 v[16:19], v66 offset:32768
    ds_read_b128 v[20:23], v66 offset:36864
    ds_read_b64_tr_b16 v[32:33], v76 offset:57344
    ds_read_b64_tr_b16 v[34:35], v76 offset:58368
    ds_read_b64_tr_b16 v[36:37], v77 offset:57344
    ds_read_b64_tr_b16 v[38:39], v77 offset:58368
    s_waitcnt lgkmcnt(6)
    v_mfma_f32_32x32x16_bf16 v[128:143], v[40:43], v[24:27], v[128:143]
    v_mfma_f32_32x32x16_bf16 v[144:159], v[44:47], v[24:27], v[144:159]
    v_mfma_f32_32x32x16_bf16 v[160:175], v[40:43], v[28:31], v[160:175]
    v_mfma_f32_32x32x16_bf16 v[176:191], v[44:47], v[28:31], v[176:191]
    ds_read_b128 v[24:27], v67 offset:32768
    ds_read_b128 v[28:31], v67 offset:36864
    ds_read_b64_tr_b16 v[40:41], v76 offset:61440
    ds_read_b64_tr_b16 v[42:43], v76 offset:62464
    ds_read_b64_tr_b16 v[44:45], v77 offset:61440
    ds_read_b64_tr_b16 v[46:47], v77 offset:62464
    s_waitcnt lgkmcnt(6)
    v_mfma_f32_32x32x16_bf16 v[128:143], v[32:35], v[16:19], v[128:143]
    v_mfma_f32_32x32x16_bf16 v[144:159], v[36:39], v[16:19], v[144:159]
    v_mfma_f32_32x32x16_bf16 v[160:175], v[32:35], v[20:23], v[160:175]
    v_mfma_f32_32x32x16_bf16 v[176:191], v[36:39], v[20:23], v[176:191]
    s_barrier
    ds_read_b128 v[16:19], v68 offset:0
    ds_read_b128 v[20:23], v68 offset:4096
    ds_read_b64_tr_b16 v[32:33], v78 offset:16384
    ds_read_b64_tr_b16 v[34:35], v78 offset:17408
    ds_read_b64_tr_b16 v[36:37], v79 offset:16384
    ds_read_b64_tr_b16 v[38:39], v79 offset:17408
    s_waitcnt lgkmcnt(6)
    v_mfma_f32_32x32x16_bf16 v[128:143], v[40:43], v[24:27], v[128:143]
    v_mfma_f32_32x32x16_bf16 v[144:159], v[44:47], v[24:27], v[144:159]
    v_mfma_f32_32x32x16_bf16 v[160:175], v[40:43], v[28:31], v[160:175]
    v_mfma_f32_32x32x16_bf16 v[176:191], v[44:47], v[28:31], v[176:191]
    ds_read_b128 v[24:27], v69 offset:0
    ds_read_b128 v[28:31], v69 offset:4096
    ds_read_b64_tr_b16 v[40:41], v78 offset:20480
    ds_read_b64_tr_b16 v[42:43], v78 offset:21504
    ds_read_b64_tr_b16 v[44:45], v79 offset:20480
    ds_read_b64_tr_b16 v[46:47], v79 offset:21504
    s_waitcnt lgkmcnt(6)
    v_mfma_f32_32x32x16_bf16 v[128:143], v[32:35], v[16:19], v[128:143]
    v_mfma_f32_32x32x16_bf16 v[144:159], v[36:39], v[16:19], v[144:159]
    v_mfma_f32_32x32x16_bf16 v[160:175], v[32:35], v[20:23], v[160:175]
    v_mfma_f32_32x32x16_bf16 v[176:191], v[36:39], v[20:23], v[176:191]
    ds_read_b128 v[16:19], v70 offset:0
    ds_read_b128 v[20:23], v70 offset:4096
    ds_read_b64_tr_b16 v[32:33], v78 offset:24576
    ds_read_b64_tr_b16 v[34:35], v78 offset:25600
    ds_read_b64_tr_b16 v[36:37], v79 offset:24576
    ds_read_b64_tr_b16 v[38:39], v79 offset:25600
    s_waitcnt lgkmcnt(6)
    v_mfma_f32_32x32x16_bf16 v[128:143], v[40:43], v[24:27], v[128:143]
    v_mfma_f32_32x32x16_bf16 v[144:159], v[44:47], v[24:27], v[144:159]
    v_mfma_f32_32x32x16_bf16 v[160:175], v[40:43], v[28:31], v[160:175]
    v_mfma_f32_32x32x16_bf16 v[176:191], v[44:47], v[28:31], v[176:191]
    ds_read_b128 v[24:27], v71 offset:0
    ds_read_b128 v[28:31], v71 offset:4096
    ds_read_b64_tr_b16 v[40:41], v78 offset:28672
    ds_read_b64_tr_b16 v[42:43], v78 offset:29696
    ds_read_b64_tr_b16 v[44:45], v79 offset:28672
    ds_read_b64_tr_b16 v[46:47], v79 offset:29696
    s_waitcnt lgkmcnt(6)
    v_mfma_f32_32x32x16_bf16 v[128:143], v[32:35], v[16:19], v[128:143]
    v_mfma_f32_32x32x16_bf16 v[144:159], v[36:39], v[16:19], v[144:159]
    v_mfma_f32_32x32x16_bf16 v[160:175], v[32:35], v[20:23], v[160:175]
    v_mfma_f32_32x32x16_bf16 v[176:191], v[36:39], v[20:23], v[176:191]
    s_barrier
    ds_read_b128 v[16:19], v68 offset:32768
    ds_read_b128 v[20:23], v68 offset:36864
    ds_read_b64_tr_b16 v[32:33], v78 offset:49152
    ds_read_b64_tr_b16 v[34:35], v78 offset:50176
    ds_read_b64_tr_b16 v[36:37], v79 offset:49152
    ds_read_b64_tr_b16 v[38:39], v79 offset:50176
    s_waitcnt lgkmcnt(6)
    v_mfma_f32_32x32x16_bf16 v[128:143], v[40:43], v[24:27], v[128:143]
    v_mfma_f32_32x32x16_bf16 v[144:159], v[44:47], v[24:27], v[144:159]
    v_mfma_f32_32x32x16_bf16 v[160:175], v[40:43], v[28:31], v[160:175]
    v_mfma_f32_32x32x16_bf16 v[176:191], v[44:47], v[28:31], v[176:191]
    ds_read_b128 v[24:27], v69 offset:32768
    ds_read_b128 v[28:31], v69 offset:36864
    ds_read_b64_tr_b16 v[40:41], v78 offset:53248
    ds_read_b64_tr_b16 v[42:43], v78 offset:54272
    ds_read_b64_tr_b16 v[44:45], v79 offset:53248
    ds_read_b64_tr_b16 v[46:47], v79 offset:54272
    s_waitcnt lgkmcnt(6)
    v_mfma_f32_32x32x16_bf16 v[128:143], v[32:35], v[16:19], v[128:143]
    v_mfma_f32_32x32x16_bf16 v[144:159], v[36:39], v[16:19], v[144:159]
    v_mfma_f32_32x32x16_bf16 v[160:175], v[32:35], v[20:23], v[160:175]
    v_mfma_f32_32x32x16_bf16 v[176:191], v[36:39], v[20:23], v[176:191]
    ds_read_b128 v[16:19], v70 offset:32768
    ds_read_b128 v[20:23], v70 offset:36864
    ds_read_b64_tr_b16 v[32:33], v78 offset:57344
    ds_read_b64_tr_b16 v[34:35], v78 offset:58368
    ds_read_b64_tr_b16 v[36:37], v79 offset:57344
    ds_read_b64_tr_b16 v[38:39], v79 offset:58368
    s_waitcnt lgkmcnt(6)
    v_mfma_f32_32x32x16_bf16 v[128:143], v[40:43], v[24:27], v[128:143]
    v_mfma_f32_32x32x16_bf16 v[144:159], v[44:47], v[24:27], v[144:159]
    v_mfma_f32_32x32x16_bf16 v[160:175], v[40:43], v[28:31], v[160:175]
    v_mfma_f32_32x32x16_bf16 v[176:191], v[44:47], v[28:31], v[176:191]
    ds_read_b128 v[24:27], v71 offset:32768
    ds_read_b128 v[28:31], v71 offset:36864
    ds_read_b64_tr_b16 v[40:41], v78 offset:61440
    ds_read_b64_tr_b16 v[42:43], v78 offset:62464
    ds_read_b64_tr_b16 v[44:45], v79 offset:61440
    ds_read_b64_tr_b16 v[46:47], v79 offset:62464
    s_waitcnt lgkmcnt(6)
    v_mfma_f32_32x32x16_bf16 v[128:143], v[32:35], v[16:19], v[128:143]
    v_mfma_f32_32x32x16_bf16 v[144:159], v[36:39], v[16:19], v[144:159]
    v_mfma_f32_32x32x16_bf16 v[160:175], v[32:35], v[20:23], v[160:175]
    v_mfma_f32_32x32x16_bf16 v[176:191], v[36:39], v[20:23], v[176:191]
    s_barrier
    ds_read_b128 v[16:19], v72 offset:0
    ds_read_b128 v[20:23], v72 offset:4096
    ds_read_b64_tr_b16 v[32:33], v80 offset:16384
    ds_read_b64_tr_b16 v[34:35], v80 offset:17408
    ds_read_b64_tr_b16 v[36:37], v81 offset:16384
    ds_read_b64_tr_b16 v[38:39], v81 offset:17408
    s_waitcnt lgkmcnt(6)
    v_mfma_f32_32x32x16_bf16 v[128:143], v[40:43], v[24:27], v[128:143]
    v_mfma_f32_32x32x16_bf16 v[144:159], v[44:47], v[24:27], v[144:159]
    v_mfma_f32_32x32x16_bf16 v[160:175], v[40:43], v[28:31], v[160:175]
    v_mfma_f32_32x32x16_bf16 v[176:191], v[44:47], v[28:31], v[176:191]
    ds_read_b128 v[24:27], v73 offset:0
    ds_read_b128 v[28:31], v73 offset:4096
    ds_read_b64_tr_b16 v[40:41], v80 offset:20480
    ds_read_b64_tr_b16 v[42:43], v80 offset:21504
    ds_read_b64_tr_b16 v[44:45], v81 offset:20480
    ds_read_b64_tr_b16 v[46:47], v81 offset:21504
    s_waitcnt lgkmcnt(6)
    v_mfma_f32_32x32x16_bf16 v[128:143], v[32:35], v[16:19], v[128:143]
    v_mfma_f32_32x32x16_bf16 v[144:159], v[36:39], v[16:19], v[144:159]
    v_mfma_f32_32x32x16_bf16 v[160:175], v[32:35], v[20:23], v[160:175]
    v_mfma_f32_32x32x16_bf16 v[176:191], v[36:39], v[20:23], v[176:191]
    ds_read_b128 v[16:19], v74 offset:0
    ds_read_b128 v[20:23], v74 offset:4096
    ds_read_b64_tr_b16 v[32:33], v80 offset:24576
    ds_read_b64_tr_b16 v[34:35], v80 offset:25600
    ds_read_b64_tr_b16 v[36:37], v81 offset:24576
    ds_read_b64_tr_b16 v[38:39], v81 offset:25600
    s_waitcnt lgkmcnt(6)
    v_mfma_f32_32x32x16_bf16 v[128:143], v[40:43], v[24:27], v[128:143]
    v_mfma_f32_32x32x16_bf16 v[144:159], v[44:47], v[24:27], v[144:159]
    v_mfma_f32_32x32x16_bf16 v[160:175], v[40:43], v[28:31], v[160:175]
    v_mfma_f32_32x32x16_bf16 v[176:191], v[44:47], v[28:31], v[176:191]
    ds_read_b128 v[24:27], v75 offset:0
    ds_read_b128 v[28:31], v75 offset:4096
    ds_read_b64_tr_b16 v[40:41], v80 offset:28672
    ds_read_b64_tr_b16 v[42:43], v80 offset:29696
    ds_read_b64_tr_b16 v[44:45], v81 offset:28672
    ds_read_b64_tr_b16 v[46:47], v81 offset:29696
    s_waitcnt lgkmcnt(6)
    v_mfma_f32_32x32x16_bf16 v[128:143], v[32:35], v[16:19], v[128:143]
    v_mfma_f32_32x32x16_bf16 v[144:159], v[36:39], v[16:19], v[144:159]
    v_mfma_f32_32x32x16_bf16 v[160:175], v[32:35], v[20:23], v[160:175]
    v_mfma_f32_32x32x16_bf16 v[176:191], v[36:39], v[20:23], v[176:191]
    s_barrier
    ds_read_b128 v[16:19], v64 offset:0
    ds_read_b128 v[20:23], v64 offset:4096
    ds_read_b64_tr_b16 v[32:33], v76 offset:16384
    ds_read_b64_tr_b16 v[34:35], v76 offset:17408
    ds_read_b64_tr_b16 v[36:37], v77 offset:16384
    ds_read_b64_tr_b16 v[38:39], v77 offset:17408
    s_waitcnt lgkmcnt(6)
    v_mfma_f32_32x32x16_bf16 v[128:143], v[40:43], v[24:27], v[128:143]
    v_mfma_f32_32x32x16_bf16 v[144:159], v[44:47], v[24:27], v[144:159]
    v_mfma_f32_32x32x16_bf16 v[160:175], v[40:43], v[28:31], v[160:175]
    v_mfma_f32_32x32x16_bf16 v[176:191], v[44:47], v[28:31], v[176:191]
    ds_read_b128 v[24:27], v65 offset:0
    ds_read_b128 v[28:31], v65 offset:4096
    ds_read_b64_tr_b16 v[40:41], v76 offset:20480
    ds_read_b64_tr_b16 v[42:43], v76 offset:21504
    ds_read_b64_tr_b16 v[44:45], v77 offset:20480
    ds_read_b64_tr_b16 v[46:47], v77 offset:21504
    s_waitcnt lgkmcnt(6)
    v_mfma_f32_32x32x16_bf16 v[128:143], v[32:35], v[16:19], v[128:143]
    v_mfma_f32_32x32x16_bf16 v[144:159], v[36:39], v[16:19], v[144:159]
    v_mfma_f32_32x32x16_bf16 v[160:175], v[32:35], v[20:23], v[160:175]
    v_mfma_f32_32x32x16_bf16 v[176:191], v[36:39], v[20:23], v[176:191]
    ds_read_b128 v[16:19], v66 offset:0
    ds_read_b128 v[20:23], v66 offset:4096
    ds_read_b64_tr_b16 v[32:33], v76 offset:24576
    ds_read_b64_tr_b16 v[34:35], v76 offset:25600
    ds_read_b64_tr_b16 v[36:37], v77 offset:24576
    ds_read_b64_tr_b16 v[38:39], v77 offset:25600
    s_waitcnt lgkmcnt(6)
    v_mfma_f32_32x32x16_bf16 v[128:143], v[40:43], v[24:27], v[128:143]
    v_mfma_f32_32x32x16_bf16 v[144:159], v[44:47], v[24:27], v[144:159]
    v_mfma_f32_32x32x16_bf16 v[160:175], v[40:43], v[28:31], v[160:175]
    v_mfma_f32_32x32x16_bf16 v[176:191], v[44:47], v[28:31], v[176:191]
    ds_read_b128 v[24:27], v67 offset:0
    ds_read_b128 v[28:31], v67 offset:4096
    ds_read_b64_tr_b16 v[40:41], v76 offset:28672
    ds_read_b64_tr_b16 v[42:43], v76 offset:29696
    ds_read_b64_tr_b16 v[44:45], v77 offset:28672
    ds_read_b64_tr_b16 v[46:47], v77 offset:29696
    s_waitcnt lgkmcnt(6)
    v_mfma_f32_32x32x16_bf16 v[128:143], v[32:35], v[16:19], v[128:143]
    v_mfma_f32_32x32x16_bf16 v[144:159], v[36:39], v[16:19], v[144:159]
    v_mfma_f32_32x32x16_bf16 v[160:175], v[32:35], v[20:23], v[160:175]
    v_mfma_f32_32x32x16_bf16 v[176:191], v[36:39], v[20:23], v[176:191]
    s_barrier
    ds_read_b128 v[16:19], v64 offset:32768
    ds_read_b128 v[20:23], v64 offset:36864
    ds_read_b64_tr_b16 v[32:33], v76 offset:49152
    ds_read_b64_tr_b16 v[34:35], v76 offset:50176
    ds_read_b64_tr_b16 v[36:37], v77 offset:49152
    ds_read_b64_tr_b16 v[38:39], v77 offset:50176
    s_waitcnt lgkmcnt(6)
    v_mfma_f32_32x32x16_bf16 v[128:143], v[40:43], v[24:27], v[128:143]
    v_mfma_f32_32x32x16_bf16 v[144:159], v[44:47], v[24:27], v[144:159]
    v_mfma_f32_32x32x16_bf16 v[160:175], v[40:43], v[28:31], v[160:175]
    v_mfma_f32_32x32x16_bf16 v[176:191], v[44:47], v[28:31], v[176:191]
    ds_read_b128 v[24:27], v65 offset:32768
    ds_read_b128 v[28:31], v65 offset:36864
    ds_read_b64_tr_b16 v[40:41], v76 offset:53248
    ds_read_b64_tr_b16 v[42:43], v76 offset:54272
    ds_read_b64_tr_b16 v[44:45], v77 offset:53248
    ds_read_b64_tr_b16 v[46:47], v77 offset:54272
    s_waitcnt lgkmcnt(6)
    v_mfma_f32_32x32x16_bf16 v[128:143], v[32:35], v[16:19], v[128:143]
    v_mfma_f32_32x32x16_bf16 v[144:159], v[36:39], v[16:19], v[144:159]
    v_mfma_f32_32x32x16_bf16 v[160:175], v[32:35], v[20:23], v[160:175]
    v_mfma_f32_32x32x16_bf16 v[176:191], v[36:39], v[20:23], v[176:191]
    ds_read_b128 v[16:19], v66 offset:32768
    ds_read_b128 v[20:23], v66 offset:36864
    ds_read_b64_tr_b16 v[32:33], v76 offset:57344
    ds_read_b64_tr_b16 v[34:35], v76 offset:58368
    ds_read_b64_tr_b16 v[36:37], v77 offset:57344
    ds_read_b64_tr_b16 v[38:39], v77 offset:58368
    s_waitcnt lgkmcnt(6)
    v_mfma_f32_32x32x16_bf16 v[128:143], v[40:43], v[24:27], v[128:143]
    v_mfma_f32_32x32x16_bf16 v[144:159], v[44:47], v[24:27], v[144:159]
    v_mfma_f32_32x32x16_bf16 v[160:175], v[40:43], v[28:31], v[160:175]
    v_mfma_f32_32x32x16_bf16 v[176:191], v[44:47], v[28:31], v[176:191]
    ds_read_b128 v[24:27], v67 offset:32768
    ds_read_b128 v[28:31], v67 offset:36864
    ds_read_b64_tr_b16 v[40:41], v76 offset:61440
    ds_read_b64_tr_b16 v[42:43], v76 offset:62464
    ds_read_b64_tr_b16 v[44:45], v77 offset:61440
    ds_read_b64_tr_b16 v[46:47], v77 offset:62464
    s_waitcnt lgkmcnt(6)
    v_mfma_f32_32x32x16_bf16 v[128:143], v[32:35], v[16:19], v[128:143]
    v_mfma_f32_32x32x16_bf16 v[144:159], v[36:39], v[16:19], v[144:159]
    v_mfma_f32_32x32x16_bf16 v[160:175], v[32:35], v[20:23], v[160:175]
    v_mfma_f32_32x32x16_bf16 v[176:191], v[36:39], v[20:23], v[176:191]
    s_waitcnt lgkmcnt(0)
    v_mfma_f32_32x32x16_bf16 v[128:143], v[40:43], v[24:27], v[128:143]
    v_mfma_f32_32x32x16_bf16 v[144:159], v[44:47], v[24:27], v[144:159]
    v_mfma_f32_32x32x16_bf16 v[160:175], v[40:43], v[28:31], v[160:175]
    v_mfma_f32_32x32x16_bf16 v[176:191], v[44:47], v[28:31], v[176:191]
    s_mov_b32 s66, 0
    s_mov_b32 s67, -1
    s_mov_b32 s68, 0x3e8b97f6
    s_cmp_eq_u32 s16, 0
    s_cselect_b32 s68, s68, 1.0
    s_mov_b32 s69, s68
    s_cmp_eq_u32 s16, 1
    s_cselect_b64 s[44:45], s[66:67], 0
    s_lshl_b32 s70, s72, 6
    s_add_u32 s70, s70, s71
    s_lshl_b32 s70, s70, 11
    s_lshl_b32 s73, s16, 21
    s_add_u32 s70, s70, s73
    v_lshlrev_b32 v4, 4, v1
    v_mov_b32 v5, 1.0
    s_nop 2
    v_pk_mul_f32 v[128:129], v[128:129], s[68:69]
    v_pk_mul_f32 v[130:131], v[130:131], s[68:69]
    v_pk_mul_f32 v[132:133], v[132:133], s[68:69]
    v_pk_mul_f32 v[134:135], v[134:135], s[68:69]
    v_pk_mul_f32 v[136:137], v[136:137], s[68:69]
    v_pk_mul_f32 v[138:139], v[138:139], s[68:69]
    v_pk_mul_f32 v[140:141], v[140:141], s[68:69]
    v_pk_mul_f32 v[142:143], v[142:143], s[68:69]
    v_cndmask_b32 v140, v140, 0, s[66:67]
    v_cndmask_b32 v141, v141, 0, s[66:67]
    v_cndmask_b32 v142, v142, 0, s[66:67]
    v_cndmask_b32 v143, v143, 0, s[66:67]
    v_pk_mul_f32 v[112:113], v[128:129], v[128:129]
    v_pk_fma_f32 v[112:113], v[130:131], v[130:131], v[112:113]
    v_pk_fma_f32 v[112:113], v[132:133], v[132:133], v[112:113]
    v_pk_fma_f32 v[112:113], v[134:135], v[134:135], v[112:113]
    v_pk_fma_f32 v[112:113], v[136:137], v[136:137], v[112:113]
    v_pk_fma_f32 v[112:113], v[138:139], v[138:139], v[112:113]
    v_pk_fma_f32 v[112:113], v[140:141], v[140:141], v[112:113]
    v_pk_fma_f32 v[112:113], v[142:143], v[142:143], v[112:113]
    v_cndmask_b32 v140, v140, v5, s[44:45]
    v_add_f32 v112, v112, v113
    v_cvt_pk_bf16_f32 v48, v128, v129
    v_cvt_pk_bf16_f32 v49, v130, v131
    v_cvt_pk_bf16_f32 v50, v132, v133
    v_cvt_pk_bf16_f32 v51, v134, v135
    v_cvt_pk_bf16_f32 v52, v136, v137
    v_cvt_pk_bf16_f32 v53, v138, v139
    v_cvt_pk_bf16_f32 v54, v140, v141
    v_cvt_pk_bf16_f32 v55, v142, v143
    s_add_u32 s73, s70, 0
    buffer_store_dwordx4 v[48:51], v4, s[28:31], s73 offen
    buffer_store_dwordx4 v[52:55], v4, s[28:31], s73 offen offset:1024
    v_pk_mul_f32 v[144:145], v[144:145], s[68:69]
    v_pk_mul_f32 v[146:147], v[146:147], s[68:69]
    v_pk_mul_f32 v[148:149], v[148:149], s[68:69]
    v_pk_mul_f32 v[150:151], v[150:151], s[68:69]
    v_pk_mul_f32 v[152:153], v[152:153], s[68:69]
    v_pk_mul_f32 v[154:155], v[154:155], s[68:69]
    v_pk_mul_f32 v[156:157], v[156:157], s[68:69]
    v_pk_mul_f32 v[158:159], v[158:159], s[68:69]
    v_cndmask_b32 v156, v156, 0, s[66:67]
    v_cndmask_b32 v157, v157, 0, s[66:67]
    v_cndmask_b32 v158, v158, 0, s[66:67]
    v_cndmask_b32 v159, v159, 0, s[66:67]
    v_pk_mul_f32 v[114:115], v[144:145], v[144:145]
    v_pk_fma_f32 v[114:115], v[146:147], v[146:147], v[114:115]
    v_pk_fma_f32 v[114:115], v[148:149], v[148:149], v[114:115]
    v_pk_fma_f32 v[114:115], v[150:151], v[150:151], v[114:115]
    v_pk_fma_f32 v[114:115], v[152:153], v[152:153], v[114:115]
    v_pk_fma_f32 v[114:115], v[154:155], v[154:155], v[114:115]
    v_pk_fma_f32 v[114:115], v[156:157], v[156:157], v[114:115]
    v_pk_fma_f32 v[114:115], v[158:159], v[158:159], v[114:115]
    v_cndmask_b32 v156, v156, v5, s[44:45]
    v_add_f32 v114, v114, v115
    v_cvt_pk_bf16_f32 v56, v144, v145
    v_cvt_pk_bf16_f32 v57, v146, v147
    v_cvt_pk_bf16_f32 v58, v148, v149
    v_cvt_pk_bf16_f32 v59, v150, v151
    v_cvt_pk_bf16_f32 v60, v152, v153
    v_cvt_pk_bf16_f32 v61, v154, v155
    v_cvt_pk_bf16_f32 v62, v156, v157
    v_cvt_pk_bf16_f32 v63, v158, v159
    s_add_u32 s73, s70, 131072
    buffer_store_dwordx4 v[56:59], v4, s[28:31], s73 offen
    buffer_store_dwordx4 v[60:63], v4, s[28:31], s73 offen offset:1024
    v_pk_mul_f32 v[160:161], v[160:161], s[68:69]
    v_pk_mul_f32 v[162:163], v[162:163], s[68:69]
    v_pk_mul_f32 v[164:165], v[164:165], s[68:69]
    v_pk_mul_f32 v[166:167], v[166:167], s[68:69]
    v_pk_mul_f32 v[168:169], v[168:169], s[68:69]
    v_pk_mul_f32 v[170:171], v[170:171], s[68:69]
    v_pk_mul_f32 v[172:173], v[172:173], s[68:69]
    v_pk_mul_f32 v[174:175], v[174:175], s[68:69]
    v_cndmask_b32 v172, v172, 0, s[66:67]
    v_cndmask_b32 v173, v173, 0, s[66:67]
    v_cndmask_b32 v174, v174, 0, s[66:67]
    v_cndmask_b32 v175, v175, 0, s[66:67]
    v_pk_mul_f32 v[116:117], v[160:161], v[160:161]
    v_pk_fma_f32 v[116:117], v[162:163], v[162:163], v[116:117]
    v_pk_fma_f32 v[116:117], v[164:165], v[164:165], v[116:117]
    v_pk_fma_f32 v[116:117], v[166:167], v[166:167], v[116:117]
    v_pk_fma_f32 v[116:117], v[168:169], v[168:169], v[116:117]
    v_pk_fma_f32 v[116:117], v[170:171], v[170:171], v[116:117]
    v_pk_fma_f32 v[116:117], v[172:173], v[172:173], v[116:117]
    v_pk_fma_f32 v[116:117], v[174:175], v[174:175], v[116:117]
    v_cndmask_b32 v172, v172, v5, s[44:45]
    v_add_f32 v116, v116, v117
    v_cvt_pk_bf16_f32 v64, v160, v161
    v_cvt_pk_bf16_f32 v65, v162, v163
    v_cvt_pk_bf16_f32 v66, v164, v165
    v_cvt_pk_bf16_f32 v67, v166, v167
    v_cvt_pk_bf16_f32 v68, v168, v169
    v_cvt_pk_bf16_f32 v69, v170, v171
    v_cvt_pk_bf16_f32 v70, v172, v173
    v_cvt_pk_bf16_f32 v71, v174, v175
    s_add_u32 s73, s70, 2048
    buffer_store_dwordx4 v[64:67], v4, s[28:31], s73 offen
    buffer_store_dwordx4 v[68:71], v4, s[28:31], s73 offen offset:1024
    v_pk_mul_f32 v[176:177], v[176:177], s[68:69]
    v_pk_mul_f32 v[178:179], v[178:179], s[68:69]
    v_pk_mul_f32 v[180:181], v[180:181], s[68:69]
    v_pk_mul_f32 v[182:183], v[182:183], s[68:69]
    v_pk_mul_f32 v[184:185], v[184:185], s[68:69]
    v_pk_mul_f32 v[186:187], v[186:187], s[68:69]
    v_pk_mul_f32 v[188:189], v[188:189], s[68:69]
    v_pk_mul_f32 v[190:191], v[190:191], s[68:69]
    v_cndmask_b32 v188, v188, 0, s[66:67]
    v_cndmask_b32 v189, v189, 0, s[66:67]
    v_cndmask_b32 v190, v190, 0, s[66:67]
    v_cndmask_b32 v191, v191, 0, s[66:67]
    v_pk_mul_f32 v[118:119], v[176:177], v[176:177]
    v_pk_fma_f32 v[118:119], v[178:179], v[178:179], v[118:119]
    v_pk_fma_f32 v[118:119], v[180:181], v[180:181], v[118:119]
    v_pk_fma_f32 v[118:119], v[182:183], v[182:183], v[118:119]
    v_pk_fma_f32 v[118:119], v[184:185], v[184:185], v[118:119]
    v_pk_fma_f32 v[118:119], v[186:187], v[186:187], v[118:119]
    v_pk_fma_f32 v[118:119], v[188:189], v[188:189], v[118:119]
    v_pk_fma_f32 v[118:119], v[190:191], v[190:191], v[118:119]
    v_cndmask_b32 v188, v188, v5, s[44:45]
    v_add_f32 v118, v118, v119
    v_cvt_pk_bf16_f32 v72, v176, v177
    v_cvt_pk_bf16_f32 v73, v178, v179
    v_cvt_pk_bf16_f32 v74, v180, v181
    v_cvt_pk_bf16_f32 v75, v182, v183
    v_cvt_pk_bf16_f32 v76, v184, v185
    v_cvt_pk_bf16_f32 v77, v186, v187
    v_cvt_pk_bf16_f32 v78, v188, v189
    v_cvt_pk_bf16_f32 v79, v190, v191
    s_add_u32 s73, s70, 133120
    buffer_store_dwordx4 v[72:75], v4, s[28:31], s73 offen
    buffer_store_dwordx4 v[76:79], v4, s[28:31], s73 offen offset:1024
    v_mov_b32 v113, v112
    v_mov_b32 v115, v114
    v_mov_b32 v117, v116
    v_mov_b32 v119, v118
    s_nop 0
    v_permlane32_swap_b32 v112, v113
    v_permlane32_swap_b32 v114, v115
    v_permlane32_swap_b32 v116, v117
    v_permlane32_swap_b32 v118, v119
    v_add_f32 v112, v112, v113
    v_add_f32 v114, v114, v115
    v_add_f32 v116, v116, v117
    v_add_f32 v118, v118, v119
    v_max_f32_dpp v112, v112, v112 row_shr:1 row_mask:0xf bank_mask:0xf
    v_max_f32_dpp v114, v114, v114 row_shr:1 row_mask:0xf bank_mask:0xf
    v_max_f32_dpp v116, v116, v116 row_shr:1 row_mask:0xf bank_mask:0xf
    v_max_f32_dpp v118, v118, v118 row_shr:1 row_mask:0xf bank_mask:0xf
    v_max_f32_dpp v112, v112, v112 row_shr:2 row_mask:0xf bank_mask:0xf
    v_max_f32_dpp v114, v114, v114 row_shr:2 row_mask:0xf bank_mask:0xf
    v_max_f32_dpp v116, v116, v116 row_shr:2 row_mask:0xf bank_mask:0xf
    v_max_f32_dpp v118, v118, v118 row_shr:2 row_mask:0xf bank_mask:0xf
    v_max_f32_dpp v112, v112, v112 row_shr:4 row_mask:0xf bank_mask:0xf
    v_max_f32_dpp v114, v114, v114 row_shr:4 row_mask:0xf bank_mask:0xf
    v_max_f32_dpp v116, v116, v116 row_shr:4 row_mask:0xf bank_mask:0xf
    v_max_f32_dpp v118, v118, v118 row_shr:4 row_mask:0xf bank_mask:0xf
    v_max_f32_dpp v112, v112, v112 row_shr:8 row_mask:0xf bank_mask:0xf
    v_max_f32_dpp v114, v114, v114 row_shr:8 row_mask:0xf bank_mask:0xf
    v_max_f32_dpp v116, v116, v116 row_shr:8 row_mask:0xf bank_mask:0xf
    v_max_f32_dpp v118, v118, v118 row_shr:8 row_mask:0xf bank_mask:0xf
    v_readlane_b32 s56, v112, 15
    v_readlane_b32 s57, v112, 31
    v_readlane_b32 s58, v114, 15
    v_readlane_b32 s59, v114, 31
    v_readlane_b32 s60, v116, 15
    v_readlane_b32 s61, v116, 31
    v_readlane_b32 s62, v118, 15
    v_readlane_b32 s63, v118, 31
    s_nop 1
    s_max_u32 s56, s56, s57
    s_max_u32 s58, s58, s59
    s_max_u32 s60, s60, s61
    s_max_u32 s62, s62, s63
    v_writelane_b32 v110, s56, 0
    v_writelane_b32 v110, s58, 1
    v_writelane_b32 v110, s60, 2
    v_writelane_b32 v110, s62, 3
    s_lshl_b32 s70, s16, 4
    s_add_u32 s70, s70, s72
    s_lshl_b32 s70, s70, 8
    s_lshl_b32 s73, s71, 2
    s_add_u32 s70, s70, s73
    s_add_u32 s70, s70, 6291456
    v_and_b32 v4, 1, v1
    v_lshlrev_b32 v4, 8, v4
    v_lshrrev_b32 v6, 1, v1
    v_lshl_add_u32 v4, v6, 2, v4
    v_mov_b32 v5, 0x40000000
    v_cmp_gt_u32 vcc, 4, v1
    s_nop 1
    v_cndmask_b32 v4, v5, v4, vcc
    buffer_store_dword v110, v4, s[28:31], s70 offen
    s_branch k1_fin
k1_vb:
    s_barrier
    ds_read_b128 v[16:19], v64 offset:0
    ds_read_b128 v[20:23], v64 offset:4096
    ds_read_b64_tr_b16 v[32:33], v76 offset:16384
    ds_read_b64_tr_b16 v[34:35], v76 offset:17408
    ds_read_b64_tr_b16 v[36:37], v77 offset:16384
    ds_read_b64_tr_b16 v[38:39], v77 offset:17408
    ds_read_b128 v[24:27], v65 offset:0
    ds_read_b128 v[28:31], v65 offset:4096
    ds_read_b64_tr_b16 v[40:41], v76 offset:20480
    ds_read_b64_tr_b16 v[42:43], v76 offset:21504
    ds_read_b64_tr_b16 v[44:45], v77 offset:20480
    ds_read_b64_tr_b16 v[46:47], v77 offset:21504
    s_waitcnt lgkmcnt(6)
    v_mfma_f32_32x32x16_bf16 v[128:143], v[16:19], v[32:35], v[128:143]
    v_mfma_f32_32x32x16_bf16 v[144:159], v[16:19], v[36:39], v[144:159]
    v_mfma_f32_32x32x16_bf16 v[160:175], v[20:23], v[32:35], v[160:175]
    v_mfma_f32_32x32x16_bf16 v[176:191], v[20:23], v[36:39], v[176:191]
    ds_read_b128 v[16:19], v66 offset:0
    ds_read_b128 v[20:23], v66 offset:4096
    ds_read_b64_tr_b16 v[32:33], v76 offset:24576
    ds_read_b64_tr_b16 v[34:35], v76 offset:25600
    ds_read_b64_tr_b16 v[36:37], v77 offset:24576
    ds_read_b64_tr_b16 v[38:39], v77 offset:25600
    s_waitcnt lgkmcnt(6)
    v_mfma_f32_32x32x16_bf16 v[128:143], v[24:27], v[40:43], v[128:143]
    v_mfma_f32_32x32x16_bf16 v[144:159], v[24:27], v[44:47], v[144:159]
    v_mfma_f32_32x32x16_bf16 v[160:175], v[28:31], v[40:43], v[160:175]
    v_mfma_f32_32x32x16_bf16 v[176:191], v[28:31], v[44:47], v[176:191]
    ds_read_b128 v[24:27], v67 offset:0
    ds_read_b128 v[28:31], v67 offset:4096
    ds_read_b64_tr_b16 v[40:41], v76 offset:28672
    ds_read_b64_tr_b16 v[42:43], v76 offset:29696
    ds_read_b64_tr_b16 v[44:45], v77 offset:28672
    ds_read_b64_tr_b16 v[46:47], v77 offset:29696
    s_waitcnt lgkmcnt(6)
    v_mfma_f32_32x32x16_bf16 v[128:143], v[16:19], v[32:35], v[128:143]
    v_mfma_f32_32x32x16_bf16 v[144:159], v[16:19], v[36:39], v[144:159]
    v_mfma_f32_32x32x16_bf16 v[160:175], v[20:23], v[32:35], v[160:175]
    v_mfma_f32_32x32x16_bf16 v[176:191], v[20:23], v[36:39], v[176:191]
    s_barrier
    ds_read_b128 v[16:19], v64 offset:32768
    ds_read_b128 v[20:23], v64 offset:36864
    ds_read_b64_tr_b16 v[32:33], v76 offset:49152
    ds_read_b64_tr_b16 v[34:35], v76 offset:50176
    ds_read_b64_tr_b16 v[36:37], v77 offset:49152
    ds_read_b64_tr_b16 v[38:39], v77 offset:50176
    s_waitcnt lgkmcnt(6)
    v_mfma_f32_32x32x16_bf16 v[128:143], v[24:27], v[40:43], v[128:143]
    v_mfma_f32_32x32x16_bf16 v[144:159], v[24:27], v[44:47], v[144:159]
    v_mfma_f32_32x32x16_bf16 v[160:175], v[28:31], v[40:43], v[160:175]
    v_mfma_f32_32x32x16_bf16 v[176:191], v[28:31], v[44:47], v[176:191]
    ds_read_b128 v[24:27], v65 offset:32768
    ds_read_b128 v[28:31], v65 offset:36864
    ds_read_b64_tr_b16 v[40:41], v76 offset:53248
    ds_read_b64_tr_b16 v[42:43], v76 offset:54272
    ds_read_b64_tr_b16 v[44:45], v77 offset:53248
    ds_read_b64_tr_b16 v[46:47], v77 offset:54272
    s_waitcnt lgkmcnt(6)
    v_mfma_f32_32x32x16_bf16 v[128:143], v[16:19], v[32:35], v[128:143]
    v_mfma_f32_32x32x16_bf16 v[144:159], v[16:19], v[36:39], v[144:159]
    v_mfma_f32_32x32x16_bf16 v[160:175], v[20:23], v[32:35], v[160:175]
    v_mfma_f32_32x32x16_bf16 v[176:191], v[20:23], v[36:39], v[176:191]
    ds_read_b128 v[16:19], v66 offset:32768
    ds_read_b128 v[20:23], v66 offset:36864
    ds_read_b64_tr_b16 v[32:33], v76 offset:57344
    ds_read_b64_tr_b16 v[34:35], v76 offset:58368
    ds_read_b64_tr_b16 v[36:37], v77 offset:57344
    ds_read_b64_tr_b16 v[38:39], v77 offset:58368
    s_waitcnt lgkmcnt(6)
    v_mfma_f32_32x32x16_bf16 v[128:143], v[24:27], v[40:43], v[128:143]
    v_mfma_f32_32x32x16_bf16 v[144:159], v[24:27], v[44:47], v[144:159]
    v_mfma_f32_32x32x16_bf16 v[160:175], v[28:31], v[40:43], v[160:175]
    v_mfma_f32_32x32x16_bf16 v[176:191], v[28:31], v[44:47], v[176:191]
    ds_read_b128 v[24:27], v67 offset:32768
    ds_read_b128 v[28:31], v67 offset:36864
    ds_read_b64_tr_b16 v[40:41], v76 offset:61440
    ds_read_b64_tr_b16 v[42:43], v76 offset:62464
    ds_read_b64_tr_b16 v[44:45], v77 offset:61440
    ds_read_b64_tr_b16 v[46:47], v77 offset:62464
    s_waitcnt lgkmcnt(6)
    v_mfma_f32_32x32x16_bf16 v[128:143], v[16:19], v[32:35], v[128:143]
    v_mfma_f32_32x32x16_bf16 v[144:159], v[16:19], v[36:39], v[144:159]
    v_mfma_f32_32x32x16_bf16 v[160:175], v[20:23], v[32:35], v[160:175]
    v_mfma_f32_32x32x16_bf16 v[176:191], v[20:23], v[36:39], v[176:191]
    s_barrier
    ds_read_b128 v[16:19], v68 offset:0
    ds_read_b128 v[20:23], v68 offset:4096
    ds_read_b64_tr_b16 v[32:33], v78 offset:16384
    ds_read_b64_tr_b16 v[34:35], v78 offset:17408
    ds_read_b64_tr_b16 v[36:37], v79 offset:16384
    ds_read_b64_tr_b16 v[38:39], v79 offset:17408
    s_waitcnt lgkmcnt(6)
    v_mfma_f32_32x32x16_bf16 v[128:143], v[24:27], v[40:43], v[128:143]
    v_mfma_f32_32x32x16_bf16 v[144:159], v[24:27], v[44:47], v[144:159]
    v_mfma_f32_32x32x16_bf16 v[160:175], v[28:31], v[40:43], v[160:175]
    v_mfma_f32_32x32x16_bf16 v[176:191], v[28:31], v[44:47], v[176:191]
    ds_read_b128 v[24:27], v69 offset:0
    ds_read_b128 v[28:31], v69 offset:4096
    ds_read_b64_tr_b16 v[40:41], v78 offset:20480
    ds_read_b64_tr_b16 v[42:43], v78 offset:21504
    ds_read_b64_tr_b16 v[44:45], v79 offset:20480
    ds_read_b64_tr_b16 v[46:47], v79 offset:21504
    s_waitcnt lgkmcnt(6)
    v_mfma_f32_32x32x16_bf16 v[128:143], v[16:19], v[32:35], v[128:143]
    v_mfma_f32_32x32x16_bf16 v[144:159], v[16:19], v[36:39], v[144:159]
    v_mfma_f32_32x32x16_bf16 v[160:175], v[20:23], v[32:35], v[160:175]
    v_mfma_f32_32x32x16_bf16 v[176:191], v[20:23], v[36:39], v[176:191]
    ds_read_b128 v[16:19], v70 offset:0
    ds_read_b128 v[20:23], v70 offset:4096
    ds_read_b64_tr_b16 v[32:33], v78 offset:24576
    ds_read_b64_tr_b16 v[34:35], v78 offset:25600
    ds_read_b64_tr_b16 v[36:37], v79 offset:24576
    ds_read_b64_tr_b16 v[38:39], v79 offset:25600
    s_waitcnt lgkmcnt(6)
    v_mfma_f32_32x32x16_bf16 v[128:143], v[24:27], v[40:43], v[128:143]
    v_mfma_f32_32x32x16_bf16 v[144:159], v[24:27], v[44:47], v[144:159]
    v_mfma_f32_32x32x16_bf16 v[160:175], v[28:31], v[40:43], v[160:175]
    v_mfma_f32_32x32x16_bf16 v[176:191], v[28:31], v[44:47], v[176:191]
    ds_read_b128 v[24:27], v71 offset:0
    ds_read_b128 v[28:31], v71 offset:4096
    ds_read_b64_tr_b16 v[40:41], v78 offset:28672
    ds_read_b64_tr_b16 v[42:43], v78 offset:29696
    ds_read_b64_tr_b16 v[44:45], v79 offset:28672
    ds_read_b64_tr_b16 v[46:47], v79 offset:29696
    s_waitcnt lgkmcnt(6)
    v_mfma_f32_32x32x16_bf16 v[128:143], v[16:19], v[32:35], v[128:143]
    v_mfma_f32_32x32x16_bf16 v[144:159], v[16:19], v[36:39], v[144:159]
    v_mfma_f32_32x32x16_bf16 v[160:175], v[20:23], v[32:35], v[160:175]
    v_mfma_f32_32x32x16_bf16 v[176:191], v[20:23], v[36:39], v[176:191]
    s_barrier
    ds_read_b128 v[16:19], v68 offset:32768
    ds_read_b128 v[20:23], v68 offset:36864
    ds_read_b64_tr_b16 v[32:33], v78 offset:49152
    ds_read_b64_tr_b16 v[34:35], v78 offset:50176
    ds_read_b64_tr_b16 v[36:37], v79 offset:49152
    ds_read_b64_tr_b16 v[38:39], v79 offset:50176
    s_waitcnt lgkmcnt(6)
    v_mfma_f32_32x32x16_bf16 v[128:143], v[24:27], v[40:43], v[128:143]
    v_mfma_f32_32x32x16_bf16 v[144:159], v[24:27], v[44:47], v[144:159]
    v_mfma_f32_32x32x16_bf16 v[160:175], v[28:31], v[40:43], v[160:175]
    v_mfma_f32_32x32x16_bf16 v[176:191], v[28:31], v[44:47], v[176:191]
    ds_read_b128 v[24:27], v69 offset:32768
    ds_read_b128 v[28:31], v69 offset:36864
    ds_read_b64_tr_b16 v[40:41], v78 offset:53248
    ds_read_b64_tr_b16 v[42:43], v78 offset:54272
    ds_read_b64_tr_b16 v[44:45], v79 offset:53248
    ds_read_b64_tr_b16 v[46:47], v79 offset:54272
    s_waitcnt lgkmcnt(6)
    v_mfma_f32_32x32x16_bf16 v[128:143], v[16:19], v[32:35], v[128:143]
    v_mfma_f32_32x32x16_bf16 v[144:159], v[16:19], v[36:39], v[144:159]
    v_mfma_f32_32x32x16_bf16 v[160:175], v[20:23], v[32:35], v[160:175]
    v_mfma_f32_32x32x16_bf16 v[176:191], v[20:23], v[36:39], v[176:191]
    ds_read_b128 v[16:19], v70 offset:32768
    ds_read_b128 v[20:23], v70 offset:36864
    ds_read_b64_tr_b16 v[32:33], v78 offset:57344
    ds_read_b64_tr_b16 v[34:35], v78 offset:58368
    ds_read_b64_tr_b16 v[36:37], v79 offset:57344
    ds_read_b64_tr_b16 v[38:39], v79 offset:58368
    s_waitcnt lgkmcnt(6)
    v_mfma_f32_32x32x16_bf16 v[128:143], v[24:27], v[40:43], v[128:143]
    v_mfma_f32_32x32x16_bf16 v[144:159], v[24:27], v[44:47], v[144:159]
    v_mfma_f32_32x32x16_bf16 v[160:175], v[28:31], v[40:43], v[160:175]
    v_mfma_f32_32x32x16_bf16 v[176:191], v[28:31], v[44:47], v[176:191]
    ds_read_b128 v[24:27], v71 offset:32768
    ds_read_b128 v[28:31], v71 offset:36864
    ds_read_b64_tr_b16 v[40:41], v78 offset:61440
    ds_read_b64_tr_b16 v[42:43], v78 offset:62464
    ds_read_b64_tr_b16 v[44:45], v79 offset:61440
    ds_read_b64_tr_b16 v[46:47], v79 offset:62464
    s_waitcnt lgkmcnt(6)
    v_mfma_f32_32x32x16_bf16 v[128:143], v[16:19], v[32:35], v[128:143]
    v_mfma_f32_32x32x16_bf16 v[144:159], v[16:19], v[36:39], v[144:159]
    v_mfma_f32_32x32x16_bf16 v[160:175], v[20:23], v[32:35], v[160:175]
    v_mfma_f32_32x32x16_bf16 v[176:191], v[20:23], v[36:39], v[176:191]
    s_barrier
    ds_read_b128 v[16:19], v72 offset:0
    ds_read_b128 v[20:23], v72 offset:4096
    ds_read_b64_tr_b16 v[32:33], v80 offset:16384
    ds_read_b64_tr_b16 v[34:35], v80 offset:17408
    ds_read_b64_tr_b16 v[36:37], v81 offset:16384
    ds_read_b64_tr_b16 v[38:39], v81 offset:17408
    s_waitcnt lgkmcnt(6)
    v_mfma_f32_32x32x16_bf16 v[128:143], v[24:27], v[40:43], v[128:143]
    v_mfma_f32_32x32x16_bf16 v[144:159], v[24:27], v[44:47], v[144:159]
    v_mfma_f32_32x32x16_bf16 v[160:175], v[28:31], v[40:43], v[160:175]
    v_mfma_f32_32x32x16_bf16 v[176:191], v[28:31], v[44:47], v[176:191]
    ds_read_b128 v[24:27], v73 offset:0
    ds_read_b128 v[28:31], v73 offset:4096
    ds_read_b64_tr_b16 v[40:41], v80 offset:20480
    ds_read_b64_tr_b16 v[42:43], v80 offset:21504
    ds_read_b64_tr_b16 v[44:45], v81 offset:20480
    ds_read_b64_tr_b16 v[46:47], v81 offset:21504
    s_waitcnt lgkmcnt(6)
    v_mfma_f32_32x32x16_bf16 v[128:143], v[16:19], v[32:35], v[128:143]
    v_mfma_f32_32x32x16_bf16 v[144:159], v[16:19], v[36:39], v[144:159]
    v_mfma_f32_32x32x16_bf16 v[160:175], v[20:23], v[32:35], v[160:175]
    v_mfma_f32_32x32x16_bf16 v[176:191], v[20:23], v[36:39], v[176:191]
    ds_read_b128 v[16:19], v74 offset:0
    ds_read_b128 v[20:23], v74 offset:4096
    ds_read_b64_tr_b16 v[32:33], v80 offset:24576
    ds_read_b64_tr_b16 v[34:35], v80 offset:25600
    ds_read_b64_tr_b16 v[36:37], v81 offset:24576
    ds_read_b64_tr_b16 v[38:39], v81 offset:25600
    s_waitcnt lgkmcnt(6)
    v_mfma_f32_32x32x16_bf16 v[128:143], v[24:27], v[40:43], v[128:143]
    v_mfma_f32_32x32x16_bf16 v[144:159], v[24:27], v[44:47], v[144:159]
    v_mfma_f32_32x32x16_bf16 v[160:175], v[28:31], v[40:43], v[160:175]
    v_mfma_f32_32x32x16_bf16 v[176:191], v[28:31], v[44:47], v[176:191]
    ds_read_b128 v[24:27], v75 offset:0
    ds_read_b128 v[28:31], v75 offset:4096
    ds_read_b64_tr_b16 v[40:41], v80 offset:28672
    ds_read_b64_tr_b16 v[42:43], v80 offset:29696
    ds_read_b64_tr_b16 v[44:45], v81 offset:28672
    ds_read_b64_tr_b16 v[46:47], v81 offset:29696
    s_waitcnt lgkmcnt(6)
    v_mfma_f32_32x32x16_bf16 v[128:143], v[16:19], v[32:35], v[128:143]
    v_mfma_f32_32x32x16_bf16 v[144:159], v[16:19], v[36:39], v[144:159]
    v_mfma_f32_32x32x16_bf16 v[160:175], v[20:23], v[32:35], v[160:175]
    v_mfma_f32_32x32x16_bf16 v[176:191], v[20:23], v[36:39], v[176:191]
    s_barrier
    ds_read_b128 v[16:19], v64 offset:0
    ds_read_b128 v[20:23], v64 offset:4096
    ds_read_b64_tr_b16 v[32:33], v76 offset:16384
    ds_read_b64_tr_b16 v[34:35], v76 offset:17408
    ds_read_b64_tr_b16 v[36:37], v77 offset:16384
    ds_read_b64_tr_b16 v[38:39], v77 offset:17408
    s_waitcnt lgkmcnt(6)
    v_mfma_f32_32x32x16_bf16 v[128:143], v[24:27], v[40:43], v[128:143]
    v_mfma_f32_32x32x16_bf16 v[144:159], v[24:27], v[44:47], v[144:159]
    v_mfma_f32_32x32x16_bf16 v[160:175], v[28:31], v[40:43], v[160:175]
    v_mfma_f32_32x32x16_bf16 v[176:191], v[28:31], v[44:47], v[176:191]
    ds_read_b128 v[24:27], v65 offset:0
    ds_read_b128 v[28:31], v65 offset:4096
    ds_read_b64_tr_b16 v[40:41], v76 offset:20480
    ds_read_b64_tr_b16 v[42:43], v76 offset:21504
    ds_read_b64_tr_b16 v[44:45], v77 offset:20480
    ds_read_b64_tr_b16 v[46:47], v77 offset:21504
    s_waitcnt lgkmcnt(6)
    v_mfma_f32_32x32x16_bf16 v[128:143], v[16:19], v[32:35], v[128:143]
    v_mfma_f32_32x32x16_bf16 v[144:159], v[16:19], v[36:39], v[144:159]
    v_mfma_f32_32x32x16_bf16 v[160:175], v[20:23], v[32:35], v[160:175]
    v_mfma_f32_32x32x16_bf16 v[176:191], v[20:23], v[36:39], v[176:191]
    ds_read_b128 v[16:19], v66 offset:0
    ds_read_b128 v[20:23], v66 offset:4096
    ds_read_b64_tr_b16 v[32:33], v76 offset:24576
    ds_read_b64_tr_b16 v[34:35], v76 offset:25600
    ds_read_b64_tr_b16 v[36:37], v77 offset:24576
    ds_read_b64_tr_b16 v[38:39], v77 offset:25600
    s_waitcnt lgkmcnt(6)
    v_mfma_f32_32x32x16_bf16 v[128:143], v[24:27], v[40:43], v[128:143]
    v_mfma_f32_32x32x16_bf16 v[144:159], v[24:27], v[44:47], v[144:159]
    v_mfma_f32_32x32x16_bf16 v[160:175], v[28:31], v[40:43], v[160:175]
    v_mfma_f32_32x32x16_bf16 v[176:191], v[28:31], v[44:47], v[176:191]
    ds_read_b128 v[24:27], v67 offset:0
    ds_read_b128 v[28:31], v67 offset:4096
    ds_read_b64_tr_b16 v[40:41], v76 offset:28672
    ds_read_b64_tr_b16 v[42:43], v76 offset:29696
    ds_read_b64_tr_b16 v[44:45], v77 offset:28672
    ds_read_b64_tr_b16 v[46:47], v77 offset:29696
    s_waitcnt lgkmcnt(6)
    v_mfma_f32_32x32x16_bf16 v[128:143], v[16:19], v[32:35], v[128:143]
    v_mfma_f32_32x32x16_bf16 v[144:159], v[16:19], v[36:39], v[144:159]
    v_mfma_f32_32x32x16_bf16 v[160:175], v[20:23], v[32:35], v[160:175]
    v_mfma_f32_32x32x16_bf16 v[176:191], v[20:23], v[36:39], v[176:191]
    s_barrier
    ds_read_b128 v[16:19], v64 offset:32768
    ds_read_b128 v[20:23], v64 offset:36864
    ds_read_b64_tr_b16 v[32:33], v76 offset:49152
    ds_read_b64_tr_b16 v[34:35], v76 offset:50176
    ds_read_b64_tr_b16 v[36:37], v77 offset:49152
    ds_read_b64_tr_b16 v[38:39], v77 offset:50176
    s_waitcnt lgkmcnt(6)
    v_mfma_f32_32x32x16_bf16 v[128:143], v[24:27], v[40:43], v[128:143]
    v_mfma_f32_32x32x16_bf16 v[144:159], v[24:27], v[44:47], v[144:159]
    v_mfma_f32_32x32x16_bf16 v[160:175], v[28:31], v[40:43], v[160:175]
    v_mfma_f32_32x32x16_bf16 v[176:191], v[28:31], v[44:47], v[176:191]
    ds_read_b128 v[24:27], v65 offset:32768
    ds_read_b128 v[28:31], v65 offset:36864
    ds_read_b64_tr_b16 v[40:41], v76 offset:53248
    ds_read_b64_tr_b16 v[42:43], v76 offset:54272
    ds_read_b64_tr_b16 v[44:45], v77 offset:53248
    ds_read_b64_tr_b16 v[46:47], v77 offset:54272
    s_waitcnt lgkmcnt(6)
    v_mfma_f32_32x32x16_bf16 v[128:143], v[16:19], v[32:35], v[128:143]
    v_mfma_f32_32x32x16_bf16 v[144:159], v[16:19], v[36:39], v[144:159]
    v_mfma_f32_32x32x16_bf16 v[160:175], v[20:23], v[32:35], v[160:175]
    v_mfma_f32_32x32x16_bf16 v[176:191], v[20:23], v[36:39], v[176:191]
    ds_read_b128 v[16:19], v66 offset:32768
    ds_read_b128 v[20:23], v66 offset:36864
    ds_read_b64_tr_b16 v[32:33], v76 offset:57344
    ds_read_b64_tr_b16 v[34:35], v76 offset:58368
    ds_read_b64_tr_b16 v[36:37], v77 offset:57344
    ds_read_b64_tr_b16 v[38:39], v77 offset:58368
    s_waitcnt lgkmcnt(6)
    v_mfma_f32_32x32x16_bf16 v[128:143], v[24:27], v[40:43], v[128:143]
    v_mfma_f32_32x32x16_bf16 v[144:159], v[24:27], v[44:47], v[144:159]
    v_mfma_f32_32x32x16_bf16 v[160:175], v[28:31], v[40:43], v[160:175]
    v_mfma_f32_32x32x16_bf16 v[176:191], v[28:31], v[44:47], v[176:191]
    ds_read_b128 v[24:27], v67 offset:32768
    ds_read_b128 v[28:31], v67 offset:36864
    ds_read_b64_tr_b16 v[40:41], v76 offset:61440
    ds_read_b64_tr_b16 v[42:43], v76 offset:62464
    ds_read_b64_tr_b16 v[44:45], v77 offset:61440
    ds_read_b64_tr_b16 v[46:47], v77 offset:62464
    s_waitcnt lgkmcnt(6)
    v_mfma_f32_32x32x16_bf16 v[128:143], v[16:19], v[32:35], v[128:143]
    v_mfma_f32_32x32x16_bf16 v[144:159], v[16:19], v[36:39], v[144:159]
    v_mfma_f32_32x32x16_bf16 v[160:175], v[20:23], v[32:35], v[160:175]
    v_mfma_f32_32x32x16_bf16 v[176:191], v[20:23], v[36:39], v[176:191]
    s_waitcnt lgkmcnt(0)
    v_mfma_f32_32x32x16_bf16 v[128:143], v[24:27], v[40:43], v[128:143]
    v_mfma_f32_32x32x16_bf16 v[144:159], v[24:27], v[44:47], v[144:159]
    v_mfma_f32_32x32x16_bf16 v[160:175], v[28:31], v[40:43], v[160:175]
    v_mfma_f32_32x32x16_bf16 v[176:191], v[28:31], v[44:47], v[176:191]
    s_cmp_eq_u32 s16, 3
    s_cbranch_scc1 k1_b1
    v_mov_b32 v5, 0x3f803f80
    v_cmp_eq_u32 vcc, 28, v2
    v_mov_b32 v6, 0
    v_cmp_lt_u32 s[44:45], 27, v2
    s_lshl_b32 s70, s72, 6
    v_cndmask_b32 v6, v6, v5, vcc
    s_add_u32 s70, s70, s71
    s_lshl_b32 s70, s70, 11
    s_add_u32 s70, s70, 4194304
    v_lshlrev_b32 v4, 4, v1
    s_nop 3
    v_cvt_pk_bf16_f32 v48, v128, v129
    v_cvt_pk_bf16_f32 v49, v130, v131
    v_cvt_pk_bf16_f32 v50, v132, v133
    v_cvt_pk_bf16_f32 v51, v134, v135
    v_cvt_pk_bf16_f32 v52, v136, v137
    v_cvt_pk_bf16_f32 v53, v138, v139
    v_cvt_pk_bf16_f32 v54, v140, v141
    v_cvt_pk_bf16_f32 v55, v142, v143
    v_cndmask_b32 v48, v48, v6, s[44:45]
    v_cndmask_b32 v49, v49, v6, s[44:45]
    v_cndmask_b32 v50, v50, v6, s[44:45]
    v_cndmask_b32 v51, v51, v6, s[44:45]
    v_cndmask_b32 v52, v52, v6, s[44:45]
    v_cndmask_b32 v53, v53, v6, s[44:45]
    v_cndmask_b32 v54, v54, v6, s[44:45]
    v_cndmask_b32 v55, v55, v6, s[44:45]
    s_add_u32 s73, s70, 0
    buffer_store_dwordx4 v[48:51], v4, s[28:31], s73 offen
    buffer_store_dwordx4 v[52:55], v4, s[28:31], s73 offen offset:1024
    v_cvt_pk_bf16_f32 v56, v144, v145
    v_cvt_pk_bf16_f32 v57, v146, v147
    v_cvt_pk_bf16_f32 v58, v148, v149
    v_cvt_pk_bf16_f32 v59, v150, v151
    v_cvt_pk_bf16_f32 v60, v152, v153
    v_cvt_pk_bf16_f32 v61, v154, v155
    v_cvt_pk_bf16_f32 v62, v156, v157
    v_cvt_pk_bf16_f32 v63, v158, v159
    v_cndmask_b32 v56, v56, v6, s[44:45]
    v_cndmask_b32 v57, v57, v6, s[44:45]
    v_cndmask_b32 v58, v58, v6, s[44:45]
    v_cndmask_b32 v59, v59, v6, s[44:45]
    v_cndmask_b32 v60, v60, v6, s[44:45]
    v_cndmask_b32 v61, v61, v6, s[44:45]
    v_cndmask_b32 v62, v62, v6, s[44:45]
    v_cndmask_b32 v63, v63, v6, s[44:45]
    s_add_u32 s73, s70, 131072
    buffer_store_dwordx4 v[56:59], v4, s[28:31], s73 offen
    buffer_store_dwordx4 v[60:63], v4, s[28:31], s73 offen offset:1024
    v_cvt_pk_bf16_f32 v64, v160, v161
    v_cvt_pk_bf16_f32 v65, v162, v163
    v_cvt_pk_bf16_f32 v66, v164, v165
    v_cvt_pk_bf16_f32 v67, v166, v167
    v_cvt_pk_bf16_f32 v68, v168, v169
    v_cvt_pk_bf16_f32 v69, v170, v171
    v_cvt_pk_bf16_f32 v70, v172, v173
    v_cvt_pk_bf16_f32 v71, v174, v175
    v_cndmask_b32 v64, v64, v6, s[44:45]
    v_cndmask_b32 v65, v65, v6, s[44:45]
    v_cndmask_b32 v66, v66, v6, s[44:45]
    v_cndmask_b32 v67, v67, v6, s[44:45]
    v_cndmask_b32 v68, v68, v6, s[44:45]
    v_cndmask_b32 v69, v69, v6, s[44:45]
    v_cndmask_b32 v70, v70, v6, s[44:45]
    v_cndmask_b32 v71, v71, v6, s[44:45]
    s_add_u32 s73, s70, 2048
    buffer_store_dwordx4 v[64:67], v4, s[28:31], s73 offen
    buffer_store_dwordx4 v[68:71], v4, s[28:31], s73 offen offset:1024
    v_cvt_pk_bf16_f32 v72, v176, v177
    v_cvt_pk_bf16_f32 v73, v178, v179
    v_cvt_pk_bf16_f32 v74, v180, v181
    v_cvt_pk_bf16_f32 v75, v182, v183
    v_cvt_pk_bf16_f32 v76, v184, v185
    v_cvt_pk_bf16_f32 v77, v186, v187
    v_cvt_pk_bf16_f32 v78, v188, v189
    v_cvt_pk_bf16_f32 v79, v190, v191
    v_cndmask_b32 v72, v72, v6, s[44:45]
    v_cndmask_b32 v73, v73, v6, s[44:45]
    v_cndmask_b32 v74, v74, v6, s[44:45]
    v_cndmask_b32 v75, v75, v6, s[44:45]
    v_cndmask_b32 v76, v76, v6, s[44:45]
    v_cndmask_b32 v77, v77, v6, s[44:45]
    v_cndmask_b32 v78, v78, v6, s[44:45]
    v_cndmask_b32 v79, v79, v6, s[44:45]
    s_add_u32 s73, s70, 133120
    buffer_store_dwordx4 v[72:75], v4, s[28:31], s73 offen
    buffer_store_dwordx4 v[76:79], v4, s[28:31], s73 offen offset:1024
    s_branch k1_fin
k1_b1:
    s_lshl_b32 s73, s19, 13
    s_add_u32 s73, s73, 98304
    v_and_b32 v5, 7, v2
    v_lshlrev_b32 v4, 7, v2
    v_add_u32 v4, s73, v4
    v_add_u32 v6, 0, v3
    v_xor_b32 v6, v6, v5
    v_lshl_add_u32 v112, v6, 4, v4
    v_add_u32 v6, 2, v3
    v_xor_b32 v6, v6, v5
    v_lshl_add_u32 v113, v6, 4, v4
    v_add_u32 v6, 4, v3
    v_xor_b32 v6, v6, v5
    v_lshl_add_u32 v114, v6, 4, v4
    v_add_u32 v6, 6, v3
    v_xor_b32 v6, v6, v5
    v_lshl_add_u32 v115, v6, 4, v4
    v_lshrrev_b32 v7, 3, v1
    v_and_b32 v8, 7, v1
    v_add_u32 v9, 0, v7
    v_cmp_lt_u32 vcc, 27, v9
    v_add_u32 v10, 4, v9
    v_mul_u32_u24 v96, 4224, v9
    v_cndmask_b32 v10, v9, v10, vcc
    v_lshl_add_u32 v96, v8, 4, v96
    v_and_b32 v11, 7, v10
    v_xor_b32 v11, v11, v8
    v_lshlrev_b32 v10, 7, v10
    v_lshl_add_u32 v10, v11, 4, v10
    v_add_u32 v104, s73, v10
    v_add_u32 v9, 8, v7
    v_cmp_lt_u32 vcc, 27, v9
    v_add_u32 v10, 4, v9
    v_mul_u32_u24 v97, 4224, v9
    v_cndmask_b32 v10, v9, v10, vcc
    v_lshl_add_u32 v97, v8, 4, v97
    v_and_b32 v11, 7, v10
    v_xor_b32 v11, v11, v8
    v_lshlrev_b32 v10, 7, v10
    v_lshl_add_u32 v10, v11, 4, v10
    v_add_u32 v105, s73, v10
    v_add_u32 v9, 16, v7
    v_cmp_lt_u32 vcc, 27, v9
    v_add_u32 v10, 4, v9
    v_mul_u32_u24 v98, 4224, v9
    v_cndmask_b32 v10, v9, v10, vcc
    v_lshl_add_u32 v98, v8, 4, v98
    v_and_b32 v11, 7, v10
    v_xor_b32 v11, v11, v8
    v_lshlrev_b32 v10, 7, v10
    v_lshl_add_u32 v10, v11, 4, v10
    v_add_u32 v106, s73, v10
    v_add_u32 v9, 24, v7
    v_cmp_lt_u32 vcc, 27, v9
    v_add_u32 v10, 4, v9
    v_mul_u32_u24 v99, 4224, v9
    v_cndmask_b32 v10, v9, v10, vcc
    v_lshl_add_u32 v99, v8, 4, v99
    v_and_b32 v11, 7, v10
    v_xor_b32 v11, v11, v8
    v_lshlrev_b32 v10, 7, v10
    v_lshl_add_u32 v10, v11, 4, v10
    v_add_u32 v107, s73, v10
    v_add_u32 v9, 32, v7
    v_cmp_lt_u32 vcc, 27, v9
    v_add_u32 v10, 4, v9
    v_mul_u32_u24 v100, 4224, v9
    v_cndmask_b32 v10, v9, v10, vcc
    v_lshl_add_u32 v100, v8, 4, v100
    v_and_b32 v11, 7, v10
    v_xor_b32 v11, v11, v8
    v_lshlrev_b32 v10, 7, v10
    v_lshl_add_u32 v10, v11, 4, v10
    v_add_u32 v108, s73, v10
    v_add_u32 v9, 40, v7
    v_cmp_lt_u32 vcc, 27, v9
    v_add_u32 v10, 4, v9
    v_mul_u32_u24 v101, 4224, v9
    v_cndmask_b32 v10, v9, v10, vcc
    v_lshl_add_u32 v101, v8, 4, v101
    v_and_b32 v11, 7, v10
    v_xor_b32 v11, v11, v8
    v_lshlrev_b32 v10, 7, v10
    v_lshl_add_u32 v10, v11, 4, v10
    v_add_u32 v109, s73, v10
    v_add_u32 v9, 48, v7
    v_cmp_lt_u32 vcc, 27, v9
    v_add_u32 v10, 4, v9
    v_mul_u32_u24 v102, 4224, v9
    v_cndmask_b32 v10, v9, v10, vcc
    v_lshl_add_u32 v102, v8, 4, v102
    v_and_b32 v11, 7, v10
    v_xor_b32 v11, v11, v8
    v_lshlrev_b32 v10, 7, v10
    v_lshl_add_u32 v10, v11, 4, v10
    v_add_u32 v110, s73, v10
    s_mul_i32 s70, s72, 118272
    s_lshl_b32 s73, s71, 6
    s_add_u32 s70, s70, s73
    s_add_u32 s70, s70, 7340032
    v_cvt_pk_bf16_f32 v48, v128, v129
    v_cvt_pk_bf16_f32 v49, v130, v131
    v_cvt_pk_bf16_f32 v50, v132, v133
    v_cvt_pk_bf16_f32 v51, v134, v135
    v_cvt_pk_bf16_f32 v52, v136, v137
    v_cvt_pk_bf16_f32 v53, v138, v139
    v_cvt_pk_bf16_f32 v54, v140, v141
    v_cvt_pk_bf16_f32 v55, v142, v143
    ds_write_b128 v112, v[48:51] offset:0
    ds_write_b128 v113, v[52:55] offset:0
    v_cvt_pk_bf16_f32 v56, v144, v145
    v_cvt_pk_bf16_f32 v57, v146, v147
    v_cvt_pk_bf16_f32 v58, v148, v149
    v_cvt_pk_bf16_f32 v59, v150, v151
    v_cvt_pk_bf16_f32 v60, v152, v153
    v_cvt_pk_bf16_f32 v61, v154, v155
    v_cvt_pk_bf16_f32 v62, v156, v157
    v_cvt_pk_bf16_f32 v63, v158, v159
    ds_write_b128 v112, v[56:59] offset:4096
    ds_write_b128 v113, v[60:63] offset:4096
    v_cvt_pk_bf16_f32 v64, v160, v161
    v_cvt_pk_bf16_f32 v65, v162, v163
    v_cvt_pk_bf16_f32 v66, v164, v165
    v_cvt_pk_bf16_f32 v67, v166, v167
    v_cvt_pk_bf16_f32 v68, v168, v169
    v_cvt_pk_bf16_f32 v69, v170, v171
    v_cvt_pk_bf16_f32 v70, v172, v173
    v_cvt_pk_bf16_f32 v71, v174, v175
    ds_write_b128 v114, v[64:67] offset:0
    ds_write_b128 v115, v[68:71] offset:0
    v_cvt_pk_bf16_f32 v72, v176, v177
    v_cvt_pk_bf16_f32 v73, v178, v179
    v_cvt_pk_bf16_f32 v74, v180, v181
    v_cvt_pk_bf16_f32 v75, v182, v183
    v_cvt_pk_bf16_f32 v76, v184, v185
    v_cvt_pk_bf16_f32 v77, v186, v187
    v_cvt_pk_bf16_f32 v78, v188, v189
    v_cvt_pk_bf16_f32 v79, v190, v191
    ds_write_b128 v114, v[72:75] offset:4096
    ds_write_b128 v115, v[76:79] offset:4096
    s_waitcnt lgkmcnt(0)
    ds_read_b128 v[128:131], v104
    ds_read_b128 v[132:135], v105
    ds_read_b128 v[136:139], v106
    ds_read_b128 v[140:143], v107
    ds_read_b128 v[144:147], v108
    ds_read_b128 v[148:151], v109
    ds_read_b128 v[152:155], v110
    s_waitcnt lgkmcnt(6)
    buffer_store_dwordx4 v[128:131], v96, s[28:31], s70 offen
    s_waitcnt lgkmcnt(5)
    buffer_store_dwordx4 v[132:135], v97, s[28:31], s70 offen
    s_waitcnt lgkmcnt(4)
    buffer_store_dwordx4 v[136:139], v98, s[28:31], s70 offen
    s_waitcnt lgkmcnt(3)
    buffer_store_dwordx4 v[140:143], v99, s[28:31], s70 offen
    s_waitcnt lgkmcnt(2)
    buffer_store_dwordx4 v[144:147], v100, s[28:31], s70 offen
    s_waitcnt lgkmcnt(1)
    buffer_store_dwordx4 v[148:151], v101, s[28:31], s70 offen
    s_waitcnt lgkmcnt(0)
    buffer_store_dwordx4 v[152:155], v102, s[28:31], s70 offen
k1_fin:
k1_end:
    s_endpgm

.text
.globl k2_kernel
.p2align 8
.type k2_kernel,@function
k2_kernel:
    s_cmp_ge_u32 s2, 256
    s_cbranch_scc1 k2_end
    s_setprio 3
    s_load_dwordx2 s[12:13], s[0:1], 64
    s_getpc_b64 s[14:15]
    s_add_u32 s14, s14, TB2@rel32@lo+4
    s_addc_u32 s15, s15, TB2@rel32@hi+12
    v_lshrrev_b32 v3, 6, v0
    v_and_b32 v1, 63, v0
    v_readfirstlane_b32 s26, v3
    v_lshlrev_b32 v2, 4, v1
    s_mov_b32 s8, s14
    s_and_b32 s9, s15, 0xffff
    s_mov_b32 s10, 63488
    s_mov_b32 s11, 0x20000
    s_and_b32 s27, s2, 7
    s_lshr_b32 s28, s2, 3
    s_lshl_b32 s46, s27, 1
    s_and_b32 s29, s28, 1
    s_or_b32 s46, s46, s29
    s_lshr_b32 s47, s28, 1
    s_and_b32 s48, s26, 3
    s_lshr_b32 s49, s26, 2
    s_lshl_b32 s30, s46, 8
    s_add_u32 s31, s30, 6295552
    s_lshl_b32 s29, s47, 4
    s_add_u32 s30, s30, s29
    s_add_u32 s30, s30, 6291456
    v_lshlrev_b32 v184, 2, v1
    v_and_b32 v185, 3, v1
    v_lshlrev_b32 v185, 2, v185
    s_lshl_b32 s32, s46, 6
    s_lshl_b32 s35, s47, 2
    s_lshl_b32 s34, s49, 1
    s_add_u32 s33, s35, s34
    s_add_u32 s34, s32, s33
    s_lshl_b32 s34, s34, 11
    s_mul_i32 s36, s48, 18
    s_cmp_eq_u32 s26, 3
    s_mov_b32 s17, 18
    s_cselect_b32 s17, 10, s17
    s_add_u32 s36, s36, s32
    s_lshl_b32 s36, s36, 11
    s_add_u32 s18, s36, 2097152
    s_add_u32 s19, s36, 4194304
    s_waitcnt lgkmcnt(0)
    s_mov_b32 s4, s12
    s_and_b32 s5, s13, 0xffff
    s_mov_b32 s6, 17825792
    s_mov_b32 s7, 0x20000
    s_getpc_b64 s[52:53]
k2_pcS:
    s_sub_u32 s52, s52, k2_pcS-k2_kernel
    s_subb_u32 s53, s53, 0
    s_lshr_b32 s54, s2, 3
    s_and_b32 s54, s54, 31
    s_mul_i32 s54, s54, 8
    s_add_u32 s54, s54, s26
    s_mul_i32 s54, s54, 64
    s_min_u32 s54, s54, k2_endcode-k2_kernel-64
    s_add_u32 s52, s52, s54
    s_addc_u32 s53, s53, 0
    s_load_dwordx16 s[80:95], s[52:53], 0
    s_cmp_eq_u32 s26, 7
    s_cbranch_scc1 k2_w7
    s_cmp_eq_u32 s26, 3
    s_cbranch_scc1 k2_w3
    buffer_load_dword v186, v184, s[4:7], s31 offen
    buffer_load_dword v187, v185, s[4:7], s30 offen
    buffer_load_dwordx4 v[8:11], v2, s[4:7], s34 offen offset:0
    buffer_load_dwordx4 v[12:15], v2, s[4:7], s34 offen offset:1024
    buffer_load_dwordx4 v[40:43], v2, s[4:7], s18 offen
    buffer_load_dwordx4 v[44:47], v2, s[4:7], s18 offen offset:1024
    buffer_load_dwordx4 v[16:19], v2, s[4:7], s34 offen offset:2048
    buffer_load_dwordx4 v[20:23], v2, s[4:7], s34 offen offset:3072
    buffer_load_dwordx4 v[48:51], v2, s[4:7], s18 offen offset:2048
    buffer_load_dwordx4 v[52:55], v2, s[4:7], s18 offen offset:3072
    buffer_load_dwordx4 v[56:59], v2, s[4:7], s19 offen
    buffer_load_dwordx4 v[60:63], v2, s[4:7], s19 offen offset:1024
    v_mov_b32 v120, 0
    v_mov_b32 v121, 0
    v_mov_b32 v122, 0
    v_mov_b32 v123, 0
    v_mov_b32 v124, 0
    v_mov_b32 v125, 0
    v_mov_b32 v126, 0
    v_mov_b32 v127, 0
    v_mov_b32 v128, 0
    v_mov_b32 v129, 0
    v_mov_b32 v130, 0
    v_mov_b32 v131, 0
    v_mov_b32 v132, 0
    v_mov_b32 v133, 0
    v_mov_b32 v134, 0
    v_mov_b32 v135, 0
    v_mov_b32 v136, 0
    v_mov_b32 v137, 0
    v_mov_b32 v138, 0
    v_mov_b32 v139, 0
    v_mov_b32 v140, 0
    v_mov_b32 v141, 0
    v_mov_b32 v142, 0
    v_mov_b32 v143, 0
    v_mov_b32 v144, 0
    v_mov_b32 v145, 0
    v_mov_b32 v146, 0
    v_mov_b32 v147, 0
    v_mov_b32 v148, 0
    v_mov_b32 v149, 0
    v_mov_b32 v150, 0
    v_mov_b32 v151, 0
    v_mov_b32 v112, 0
    v_mov_b32 v64, 0
    v_mov_b32 v113, 0
    v_mov_b32 v65, 0
    v_mov_b32 v114, 0
    v_mov_b32 v66, 0
    v_mov_b32 v115, 0
    v_mov_b32 v67, 0
    v_mov_b32 v116, 0
    v_mov_b32 v68, 0
    v_mov_b32 v117, 0
    v_mov_b32 v69, 0
    v_mov_b32 v118, 0
    v_mov_b32 v70, 0
    v_mov_b32 v119, 0
    v_mov_b32 v71, 0
    s_waitcnt vmcnt(10)
    v_max_u32_dpp v186, v186, v186 row_shr:1 row_mask:0xf bank_mask:0xf
    v_max_u32_dpp v187, v187, v187 row_shr:1 row_mask:0xf bank_mask:0xf
    s_nop 0
    v_max_u32_dpp v186, v186, v186 row_shr:2 row_mask:0xf bank_mask:0xf
    v_max_u32_dpp v187, v187, v187 row_shr:2 row_mask:0xf bank_mask:0xf
    s_nop 0
    v_max_u32_dpp v186, v186, v186 row_shr:4 row_mask:0xf bank_mask:0xf
    v_max_u32_dpp v187, v187, v187 row_shr:4 row_mask:0xf bank_mask:0xf
    s_nop 0
    v_max_u32_dpp v186, v186, v186 row_shr:8 row_mask:0xf bank_mask:0xf
    v_max_u32_dpp v187, v187, v187 row_shr:8 row_mask:0xf bank_mask:0xf
    s_nop 0
    v_max_u32_dpp v186, v186, v186 row_bcast:15 row_mask:0xa bank_mask:0xf
    v_readlane_b32 s38, v187, 15
    s_nop 0
    v_max_u32_dpp v186, v186, v186 row_bcast:31 row_mask:0xc bank_mask:0xf
    v_mov_b32 v187, 0x3e800000
    v_readlane_b32 s37, v186, 63
    v_mov_b32 v188, 0x3f828f5c
    s_nop 0
    v_mov_b32 v186, s37
    v_mul_f32 v186, s38, v186
    v_sqrt_f32 v186, v186
    s_nop 0
    v_fma_f32 v186, v186, v188, v187
    s_nop 0
    v_readfirstlane_b32 s37, v186
    s_nop 1
    s_cmp_gt_u32 s37, 0x42400000
    s_cbranch_scc1 k2_slow
    s_lshr_b32 s37, s37, 16
    s_add_u32 s37, s37, 1
    s_or_b32 s37, s37, 0x8000
    s_add_u32 s18, s18, 4096
    s_add_u32 s19, s19, 2048
    s_cmp_lt_u32 s26, 4
    s_cselect_b32 s43, 4, 0
    s_waitcnt vmcnt(6)
    s_mov_b32 exec_lo, 0
    v_mov_b32 v14, s37
    s_mov_b32 exec_lo, -1
    s_nop 0
    v_mfma_f32_32x32x16_bf16 v[72:87], v[40:43], v[8:11], 0
    v_mfma_f32_32x32x16_bf16 v[72:87], v[44:47], v[12:15], v[72:87]
    s_waitcnt vmcnt(4)
    s_mov_b32 exec_lo, 0
    v_mov_b32 v22, s37
    s_mov_b32 exec_lo, -1
    s_cbranch_scc1 k2_old
    s_setprio 1
    s_branch k2_go
k2_old:
    s_setprio 2
k2_go:
    s_nop 4
k2_loopa:
    v_mfma_f32_32x32x16_bf16 v[88:103], v[40:43], v[16:19], 0
    v_exp_f32 v72, v72
    v_exp_f32 v73, v73
    v_exp_f32 v74, v74
    v_exp_f32 v75, v75
    v_cvt_pk_bf16_f32 v104, v72, v73
    v_cvt_pk_bf16_f32 v105, v74, v75
    v_mfma_f32_32x32x16_bf16 v[88:103], v[44:47], v[20:23], v[88:103]
    v_exp_f32 v76, v76
    v_exp_f32 v77, v77
    v_exp_f32 v78, v78
    v_exp_f32 v79, v79
    v_cvt_pk_bf16_f32 v106, v76, v77
    v_cvt_pk_bf16_f32 v107, v78, v79
    buffer_load_dwordx4 v[40:43], v2, s[4:7], s18 offen
    buffer_load_dwordx4 v[44:47], v2, s[4:7], s18 offen offset:1024
    v_mfma_f32_32x32x16_bf16 v[136:151], v[64:67], v[112:115], v[136:151]
    v_exp_f32 v80, v80
    v_exp_f32 v81, v81
    v_exp_f32 v82, v82
    v_exp_f32 v83, v83
    v_cvt_pk_bf16_f32 v108, v80, v81
    v_cvt_pk_bf16_f32 v109, v82, v83
    v_mfma_f32_32x32x16_bf16 v[136:151], v[68:71], v[116:119], v[136:151]
    buffer_load_dwordx4 v[64:67], v2, s[4:7], s19 offen
    buffer_load_dwordx4 v[68:71], v2, s[4:7], s19 offen offset:1024
    v_exp_f32 v84, v84
    v_exp_f32 v85, v85
    v_exp_f32 v86, v86
    v_exp_f32 v87, v87
    v_cvt_pk_bf16_f32 v110, v84, v85
    v_cvt_pk_bf16_f32 v111, v86, v87
    s_waitcnt vmcnt(6)
    v_mfma_f32_32x32x16_bf16 v[72:87], v[48:51], v[8:11], 0
    v_exp_f32 v88, v88
    v_exp_f32 v89, v89
    v_exp_f32 v90, v90
    v_exp_f32 v91, v91
    v_cvt_pk_bf16_f32 v112, v88, v89
    v_cvt_pk_bf16_f32 v113, v90, v91
    v_mfma_f32_32x32x16_bf16 v[72:87], v[52:55], v[12:15], v[72:87]
    v_exp_f32 v92, v92
    v_exp_f32 v93, v93
    v_exp_f32 v94, v94
    v_exp_f32 v95, v95
    v_cvt_pk_bf16_f32 v114, v92, v93
    v_cvt_pk_bf16_f32 v115, v94, v95
    s_waitcnt vmcnt(4)
    v_mfma_f32_32x32x16_bf16 v[120:135], v[56:59], v[104:107], v[120:135]
    v_exp_f32 v96, v96
    v_exp_f32 v97, v97
    v_exp_f32 v98, v98
    v_exp_f32 v99, v99
    v_cvt_pk_bf16_f32 v116, v96, v97
    v_cvt_pk_bf16_f32 v117, v98, v99
    v_mfma_f32_32x32x16_bf16 v[120:135], v[60:63], v[108:111], v[120:135]
    s_add_u32 s18, s18, 2048
    s_add_u32 s19, s19, 2048
    s_sub_u32 s17, s17, 1
    v_exp_f32 v100, v100
    v_exp_f32 v101, v101
    v_exp_f32 v102, v102
    v_exp_f32 v103, v103
    v_cvt_pk_bf16_f32 v118, v100, v101
    v_cvt_pk_bf16_f32 v119, v102, v103
    s_cmp_eq_u32 s17, 0
    s_cbranch_scc1 k2_exit0a
    v_mfma_f32_32x32x16_bf16 v[88:103], v[48:51], v[16:19], 0
    v_exp_f32 v72, v72
    v_exp_f32 v73, v73
    v_exp_f32 v74, v74
    v_exp_f32 v75, v75
    v_cvt_pk_bf16_f32 v104, v72, v73
    v_cvt_pk_bf16_f32 v105, v74, v75
    v_mfma_f32_32x32x16_bf16 v[88:103], v[52:55], v[20:23], v[88:103]
    v_exp_f32 v76, v76
    v_exp_f32 v77, v77
    v_exp_f32 v78, v78
    v_exp_f32 v79, v79
    v_cvt_pk_bf16_f32 v106, v76, v77
    v_cvt_pk_bf16_f32 v107, v78, v79
    buffer_load_dwordx4 v[48:51], v2, s[4:7], s18 offen
    buffer_load_dwordx4 v[52:55], v2, s[4:7], s18 offen offset:1024
    v_mfma_f32_32x32x16_bf16 v[136:151], v[56:59], v[112:115], v[136:151]
    v_exp_f32 v80, v80
    v_exp_f32 v81, v81
    v_exp_f32 v82, v82
    v_exp_f32 v83, v83
    v_cvt_pk_bf16_f32 v108, v80, v81
    v_cvt_pk_bf16_f32 v109, v82, v83
    v_mfma_f32_32x32x16_bf16 v[136:151], v[60:63], v[116:119], v[136:151]
    buffer_load_dwordx4 v[56:59], v2, s[4:7], s19 offen
    buffer_load_dwordx4 v[60:63], v2, s[4:7], s19 offen offset:1024
    v_exp_f32 v84, v84
    v_exp_f32 v85, v85
    v_exp_f32 v86, v86
    v_exp_f32 v87, v87
    v_cvt_pk_bf16_f32 v110, v84, v85
    v_cvt_pk_bf16_f32 v111, v86, v87
    s_waitcnt vmcnt(6)
    v_mfma_f32_32x32x16_bf16 v[72:87], v[40:43], v[8:11], 0
    v_exp_f32 v88, v88
    v_exp_f32 v89, v89
    v_exp_f32 v90, v90
    v_exp_f32 v91, v91
    v_cvt_pk_bf16_f32 v112, v88, v89
    v_cvt_pk_bf16_f32 v113, v90, v91
    v_mfma_f32_32x32x16_bf16 v[72:87], v[44:47], v[12:15], v[72:87]
    v_exp_f32 v92, v92
    v_exp_f32 v93, v93
    v_exp_f32 v94, v94
    v_exp_f32 v95, v95
    v_cvt_pk_bf16_f32 v114, v92, v93
    v_cvt_pk_bf16_f32 v115, v94, v95
    s_waitcnt vmcnt(4)
    v_mfma_f32_32x32x16_bf16 v[120:135], v[64:67], v[104:107], v[120:135]
    v_exp_f32 v96, v96
    v_exp_f32 v97, v97
    v_exp_f32 v98, v98
    v_exp_f32 v99, v99
    v_cvt_pk_bf16_f32 v116, v96, v97
    v_cvt_pk_bf16_f32 v117, v98, v99
    v_mfma_f32_32x32x16_bf16 v[120:135], v[68:71], v[108:111], v[120:135]
    s_add_u32 s18, s18, 2048
    s_add_u32 s19, s19, 2048
    s_sub_u32 s17, s17, 1
    v_exp_f32 v100, v100
    v_exp_f32 v101, v101
    v_exp_f32 v102, v102
    v_exp_f32 v103, v103
    v_cvt_pk_bf16_f32 v118, v100, v101
    v_cvt_pk_bf16_f32 v119, v102, v103
    s_cmp_gt_u32 s17, s43
    s_cbranch_scc1 k2_loopa
    s_setprio 0
    s_cmp_lg_u32 s17, 0
    s_cbranch_scc1 k2_loopa
    v_mfma_f32_32x32x16_bf16 v[136:151], v[64:67], v[112:115], v[136:151]
    v_mfma_f32_32x32x16_bf16 v[136:151], v[68:71], v[116:119], v[136:151]
    s_branch k2_fina
k2_exit0a:
    v_mfma_f32_32x32x16_bf16 v[136:151], v[56:59], v[112:115], v[136:151]
    v_mfma_f32_32x32x16_bf16 v[136:151], v[60:63], v[116:119], v[136:151]
k2_fina:
    s_nop 7
    s_nop 3
k2_red:
    s_lshl_b32 s37, s26, 13
    v_add_u32 v184, s37, v2
    ds_write_b128 v184, v[120:123] offset:0
    ds_write_b128 v184, v[124:127] offset:1024
    ds_write_b128 v184, v[128:131] offset:2048
    ds_write_b128 v184, v[132:135] offset:3072
    ds_write_b128 v184, v[136:139] offset:4096
    ds_write_b128 v184, v[140:143] offset:5120
    ds_write_b128 v184, v[144:147] offset:6144
    ds_write_b128 v184, v[148:151] offset:7168
k2_red2:
    s_lshr_b32 s38, s48, 1
    s_and_b32 s39, s48, 1
    s_lshl_b32 s40, s49, 15
    s_lshl_b32 s41, s38, 12
    s_add_u32 s40, s40, s41
    s_lshl_b32 s41, s39, 11
    s_add_u32 s41, s41, s40
    v_add_u32 v185, s41, v2
    v_and_b32 v186, 31, v1
    v_lshlrev_b32 v186, 4, v186
    s_add_u32 s40, s40, 3*1024+512
    v_add_u32 v186, s40, v186
    s_add_u32 s42, s33, s38
    s_lshl_b32 s42, s42, 4
    s_add_u32 s42, s42, s46
    s_lshl_b32 s42, s42, 1
    s_add_u32 s42, s42, s39
    s_lshl_b32 s42, s42, 10
    s_add_u32 s42, s42, 13631488
    s_waitcnt lgkmcnt(0)
    s_barrier
    ds_read_b32 v188, v186 offset:0
    ds_read_b32 v189, v186 offset:8192
    ds_read_b32 v190, v186 offset:16384
    ds_read_b32 v191, v186 offset:24576
    ds_read_b128 v[72:75], v185 offset:0
    ds_read_b128 v[76:79], v185 offset:1024
    ds_read_b128 v[80:83], v185 offset:8192
    ds_read_b128 v[84:87], v185 offset:9216
    ds_read_b128 v[88:91], v185 offset:16384
    ds_read_b128 v[92:95], v185 offset:17408
    ds_read_b128 v[96:99], v185 offset:24576
    ds_read_b128 v[100:103], v185 offset:25600
    s_cmp_eq_u32 s39, 1
    s_cselect_b32 s45, -1, 0
    s_mov_b32 s44, 0
    s_waitcnt lgkmcnt(8)
    v_add_f32 v188, v188, v189
    v_add_f32 v190, v190, v191
    v_add_f32 v188, v188, v190
    v_rcp_f32 v188, v188
    s_waitcnt lgkmcnt(0)
    v_pk_add_f32 v[72:73], v[72:73], v[80:81]
    v_pk_add_f32 v[88:89], v[88:89], v[96:97]
    v_pk_add_f32 v[74:75], v[74:75], v[82:83]
    v_pk_add_f32 v[90:91], v[90:91], v[98:99]
    v_pk_add_f32 v[76:77], v[76:77], v[84:85]
    v_pk_add_f32 v[92:93], v[92:93], v[100:101]
    v_pk_add_f32 v[78:79], v[78:79], v[86:87]
    v_pk_add_f32 v[94:95], v[94:95], v[102:103]
    v_pk_add_f32 v[72:73], v[72:73], v[88:89]
    v_pk_add_f32 v[74:75], v[74:75], v[90:91]
    v_pk_add_f32 v[76:77], v[76:77], v[92:93]
    v_pk_add_f32 v[78:79], v[78:79], v[94:95]
    v_pk_mul_f32 v[72:73], v[72:73], v[188:189] op_sel_hi:[1,0]
    v_pk_mul_f32 v[74:75], v[74:75], v[188:189] op_sel_hi:[1,0]
    v_pk_mul_f32 v[76:77], v[76:77], v[188:189] op_sel_hi:[1,0]
    v_pk_mul_f32 v[78:79], v[78:79], v[188:189] op_sel_hi:[1,0]
    v_cvt_pk_bf16_f32 v104, v72, v73
    v_cvt_pk_bf16_f32 v105, v74, v75
    v_cvt_pk_bf16_f32 v106, v76, v77
    v_cvt_pk_bf16_f32 v107, v78, v79
    v_cndmask_b32 v106, v106, 0, s[44:45]
    v_cndmask_b32 v107, v107, 0, s[44:45]
    buffer_store_dwordx4 v[104:107], v2, s[4:7], s42 offen
k2_end:
    s_endpgm
k2_w3:
    buffer_load_dword v186, v184, s[4:7], s31 offen
    buffer_load_dword v187, v185, s[4:7], s30 offen
    s_add_u32 s35, s34, 4096
    buffer_load_dwordx4 v[8:11], v2, s[4:7], s34 offen offset:0
    buffer_load_dwordx4 v[12:15], v2, s[4:7], s34 offen offset:1024
    buffer_load_dwordx4 v[40:43], v2, s[4:7], s18 offen
    buffer_load_dwordx4 v[44:47], v2, s[4:7], s18 offen offset:1024
    buffer_load_dwordx4 v[16:19], v2, s[4:7], s34 offen offset:2048
    buffer_load_dwordx4 v[20:23], v2, s[4:7], s34 offen offset:3072
    buffer_load_dwordx4 v[24:27], v2, s[4:7], s35 offen offset:0
    buffer_load_dwordx4 v[28:31], v2, s[4:7], s35 offen offset:1024
    buffer_load_dwordx4 v[32:35], v2, s[4:7], s35 offen offset:2048
    buffer_load_dwordx4 v[36:39], v2, s[4:7], s35 offen offset:3072
    buffer_load_dwordx4 v[56:59], v2, s[4:7], s19 offen
    buffer_load_dwordx4 v[60:63], v2, s[4:7], s19 offen offset:1024
    buffer_load_dwordx4 v[48:51], v2, s[4:7], s18 offen offset:2048
    buffer_load_dwordx4 v[52:55], v2, s[4:7], s18 offen offset:3072
    v_mov_b32 v120, 0
    v_mov_b32 v121, 0
    v_mov_b32 v122, 0
    v_mov_b32 v123, 0
    v_mov_b32 v124, 0
    v_mov_b32 v125, 0
    v_mov_b32 v126, 0
    v_mov_b32 v127, 0
    v_mov_b32 v128, 0
    v_mov_b32 v129, 0
    v_mov_b32 v130, 0
    v_mov_b32 v131, 0
    v_mov_b32 v132, 0
    v_mov_b32 v133, 0
    v_mov_b32 v134, 0
    v_mov_b32 v135, 0
    v_mov_b32 v136, 0
    v_mov_b32 v137, 0
    v_mov_b32 v138, 0
    v_mov_b32 v139, 0
    v_mov_b32 v140, 0
    v_mov_b32 v141, 0
    v_mov_b32 v142, 0
    v_mov_b32 v143, 0
    v_mov_b32 v144, 0
    v_mov_b32 v145, 0
    v_mov_b32 v146, 0
    v_mov_b32 v147, 0
    v_mov_b32 v148, 0
    v_mov_b32 v149, 0
    v_mov_b32 v150, 0
    v_mov_b32 v151, 0
    v_mov_b32 v152, 0
    v_mov_b32 v153, 0
    v_mov_b32 v154, 0
    v_mov_b32 v155, 0
    v_mov_b32 v156, 0
    v_mov_b32 v157, 0
    v_mov_b32 v158, 0
    v_mov_b32 v159, 0
    v_mov_b32 v160, 0
    v_mov_b32 v161, 0
    v_mov_b32 v162, 0
    v_mov_b32 v163, 0
    v_mov_b32 v164, 0
    v_mov_b32 v165, 0
    v_mov_b32 v166, 0
    v_mov_b32 v167, 0
    v_mov_b32 v168, 0
    v_mov_b32 v169, 0
    v_mov_b32 v170, 0
    v_mov_b32 v171, 0
    v_mov_b32 v172, 0
    v_mov_b32 v173, 0
    v_mov_b32 v174, 0
    v_mov_b32 v175, 0
    v_mov_b32 v176, 0
    v_mov_b32 v177, 0
    v_mov_b32 v178, 0
    v_mov_b32 v179, 0
    v_mov_b32 v180, 0
    v_mov_b32 v181, 0
    v_mov_b32 v182, 0
    v_mov_b32 v183, 0
    v_mov_b32 v112, 0
    v_mov_b32 v64, 0
    v_mov_b32 v113, 0
    v_mov_b32 v65, 0
    v_mov_b32 v114, 0
    v_mov_b32 v66, 0
    v_mov_b32 v115, 0
    v_mov_b32 v67, 0
    v_mov_b32 v116, 0
    v_mov_b32 v68, 0
    v_mov_b32 v117, 0
    v_mov_b32 v69, 0
    v_mov_b32 v118, 0
    v_mov_b32 v70, 0
    v_mov_b32 v119, 0
    v_mov_b32 v71, 0
    s_waitcnt vmcnt(14)
    v_max_u32_dpp v186, v186, v186 row_shr:1 row_mask:0xf bank_mask:0xf
    v_max_u32_dpp v187, v187, v187 row_shr:1 row_mask:0xf bank_mask:0xf
    s_nop 0
    v_max_u32_dpp v186, v186, v186 row_shr:2 row_mask:0xf bank_mask:0xf
    v_max_u32_dpp v187, v187, v187 row_shr:2 row_mask:0xf bank_mask:0xf
    s_nop 0
    v_max_u32_dpp v186, v186, v186 row_shr:4 row_mask:0xf bank_mask:0xf
    v_max_u32_dpp v187, v187, v187 row_shr:4 row_mask:0xf bank_mask:0xf
    s_nop 0
    v_max_u32_dpp v186, v186, v186 row_shr:8 row_mask:0xf bank_mask:0xf
    v_max_u32_dpp v187, v187, v187 row_shr:8 row_mask:0xf bank_mask:0xf
    s_nop 0
    v_max_u32_dpp v186, v186, v186 row_bcast:15 row_mask:0xa bank_mask:0xf
    v_readlane_b32 s38, v187, 15
    s_nop 0
    v_max_u32_dpp v186, v186, v186 row_bcast:31 row_mask:0xc bank_mask:0xf
    v_mov_b32 v187, 0x3e800000
    v_readlane_b32 s37, v186, 63
    v_mov_b32 v188, 0x3f828f5c
    s_nop 0
    v_mov_b32 v186, s37
    v_mul_f32 v186, s38, v186
    v_sqrt_f32 v186, v186
    s_nop 0
    v_fma_f32 v186, v186, v188, v187
    s_nop 0
    v_readfirstlane_b32 s37, v186
    s_nop 1
    s_cmp_gt_u32 s37, 0x42400000
    s_cbranch_scc1 k2_slow
    s_lshr_b32 s37, s37, 16
    s_add_u32 s37, s37, 1
    s_or_b32 s37, s37, 0x8000
    s_waitcnt vmcnt(4)
    s_mov_b32 exec_lo, 0
    v_mov_b32 v14, s37
    v_mov_b32 v22, s37
    v_mov_b32 v30, s37
    v_mov_b32 v38, s37
    s_mov_b32 exec_lo, -1
    s_add_u32 s18, s18, 4096
    s_add_u32 s19, s19, 2048
    s_mov_b32 s43, 0
    s_setprio 2
    s_waitcnt vmcnt(4)
    v_mfma_f32_32x32x16_bf16 v[72:87], v[40:43], v[8:11], 0
    v_mfma_f32_32x32x16_bf16 v[72:87], v[44:47], v[12:15], v[72:87]
    s_nop 7
    s_nop 2
k2_loopb:
    v_mfma_f32_32x32x16_bf16 v[88:103], v[40:43], v[16:19], 0
    v_exp_f32 v72, v72
    v_exp_f32 v73, v73
    v_exp_f32 v74, v74
    v_exp_f32 v75, v75
    v_cvt_pk_bf16_f32 v104, v72, v73
    v_cvt_pk_bf16_f32 v105, v74, v75
    v_mfma_f32_32x32x16_bf16 v[88:103], v[44:47], v[20:23], v[88:103]
    v_exp_f32 v76, v76
    v_exp_f32 v77, v77
    v_exp_f32 v78, v78
    v_exp_f32 v79, v79
    v_cvt_pk_bf16_f32 v106, v76, v77
    v_cvt_pk_bf16_f32 v107, v78, v79
    v_mfma_f32_32x32x16_bf16 v[168:183], v[64:67], v[112:115], v[168:183]
    v_exp_f32 v80, v80
    v_exp_f32 v81, v81
    v_exp_f32 v82, v82
    v_exp_f32 v83, v83
    v_cvt_pk_bf16_f32 v108, v80, v81
    v_cvt_pk_bf16_f32 v109, v82, v83
    v_mfma_f32_32x32x16_bf16 v[168:183], v[68:71], v[116:119], v[168:183]
    buffer_load_dwordx4 v[64:67], v2, s[4:7], s19 offen
    buffer_load_dwordx4 v[68:71], v2, s[4:7], s19 offen offset:1024
    v_exp_f32 v84, v84
    v_exp_f32 v85, v85
    v_exp_f32 v86, v86
    v_exp_f32 v87, v87
    v_cvt_pk_bf16_f32 v110, v84, v85
    v_cvt_pk_bf16_f32 v111, v86, v87
    v_mfma_f32_32x32x16_bf16 v[72:87], v[40:43], v[24:27], 0
    v_exp_f32 v88, v88
    v_exp_f32 v89, v89
    v_exp_f32 v90, v90
    v_exp_f32 v91, v91
    v_cvt_pk_bf16_f32 v112, v88, v89
    v_cvt_pk_bf16_f32 v113, v90, v91
    v_mfma_f32_32x32x16_bf16 v[72:87], v[44:47], v[28:31], v[72:87]
    v_exp_f32 v92, v92
    v_exp_f32 v93, v93
    v_exp_f32 v94, v94
    v_exp_f32 v95, v95
    v_cvt_pk_bf16_f32 v114, v92, v93
    v_cvt_pk_bf16_f32 v115, v94, v95
    s_waitcnt vmcnt(4)
    v_mfma_f32_32x32x16_bf16 v[120:135], v[56:59], v[104:107], v[120:135]
    v_exp_f32 v96, v96
    v_exp_f32 v97, v97
    v_exp_f32 v98, v98
    v_exp_f32 v99, v99
    v_cvt_pk_bf16_f32 v116, v96, v97
    v_cvt_pk_bf16_f32 v117, v98, v99
    v_mfma_f32_32x32x16_bf16 v[120:135], v[60:63], v[108:111], v[120:135]
    v_exp_f32 v100, v100
    v_exp_f32 v101, v101
    v_exp_f32 v102, v102
    v_exp_f32 v103, v103
    v_cvt_pk_bf16_f32 v118, v100, v101
    v_cvt_pk_bf16_f32 v119, v102, v103
    v_mfma_f32_32x32x16_bf16 v[88:103], v[40:43], v[32:35], 0
    v_exp_f32 v72, v72
    v_exp_f32 v73, v73
    v_exp_f32 v74, v74
    v_exp_f32 v75, v75
    v_cvt_pk_bf16_f32 v104, v72, v73
    v_cvt_pk_bf16_f32 v105, v74, v75
    v_mfma_f32_32x32x16_bf16 v[88:103], v[44:47], v[36:39], v[88:103]
    v_exp_f32 v76, v76
    v_exp_f32 v77, v77
    v_exp_f32 v78, v78
    v_exp_f32 v79, v79
    v_cvt_pk_bf16_f32 v106, v76, v77
    v_cvt_pk_bf16_f32 v107, v78, v79
    buffer_load_dwordx4 v[40:43], v2, s[4:7], s18 offen
    buffer_load_dwordx4 v[44:47], v2, s[4:7], s18 offen offset:1024
    v_mfma_f32_32x32x16_bf16 v[136:151], v[56:59], v[112:115], v[136:151]
    v_exp_f32 v80, v80
    v_exp_f32 v81, v81
    v_exp_f32 v82, v82
    v_exp_f32 v83, v83
    v_cvt_pk_bf16_f32 v108, v80, v81
    v_cvt_pk_bf16_f32 v109, v82, v83
    v_mfma_f32_32x32x16_bf16 v[136:151], v[60:63], v[116:119], v[136:151]
    v_exp_f32 v84, v84
    v_exp_f32 v85, v85
    v_exp_f32 v86, v86
    v_exp_f32 v87, v87
    v_cvt_pk_bf16_f32 v110, v84, v85
    v_cvt_pk_bf16_f32 v111, v86, v87
    s_waitcnt vmcnt(4)
    v_mfma_f32_32x32x16_bf16 v[72:87], v[48:51], v[8:11], 0
    v_exp_f32 v88, v88
    v_exp_f32 v89, v89
    v_exp_f32 v90, v90
    v_exp_f32 v91, v91
    v_cvt_pk_bf16_f32 v112, v88, v89
    v_cvt_pk_bf16_f32 v113, v90, v91
    v_mfma_f32_32x32x16_bf16 v[72:87], v[52:55], v[12:15], v[72:87]
    v_exp_f32 v92, v92
    v_exp_f32 v93, v93
    v_exp_f32 v94, v94
    v_exp_f32 v95, v95
    v_cvt_pk_bf16_f32 v114, v92, v93
    v_cvt_pk_bf16_f32 v115, v94, v95
    v_mfma_f32_32x32x16_bf16 v[152:167], v[56:59], v[104:107], v[152:167]
    v_exp_f32 v96, v96
    v_exp_f32 v97, v97
    v_exp_f32 v98, v98
    v_exp_f32 v99, v99
    v_cvt_pk_bf16_f32 v116, v96, v97
    v_cvt_pk_bf16_f32 v117, v98, v99
    v_mfma_f32_32x32x16_bf16 v[152:167], v[60:63], v[108:111], v[152:167]
    s_add_u32 s18, s18, 2048
    s_add_u32 s19, s19, 2048
    s_sub_u32 s17, s17, 1
    v_exp_f32 v100, v100
    v_exp_f32 v101, v101
    v_exp_f32 v102, v102
    v_exp_f32 v103, v103
    v_cvt_pk_bf16_f32 v118, v100, v101
    v_cvt_pk_bf16_f32 v119, v102, v103
    s_cmp_eq_u32 s17, 0
    s_cbranch_scc1 k2_exit0b
    v_mfma_f32_32x32x16_bf16 v[88:103], v[48:51], v[16:19], 0
    v_exp_f32 v72, v72
    v_exp_f32 v73, v73
    v_exp_f32 v74, v74
    v_exp_f32 v75, v75
    v_cvt_pk_bf16_f32 v104, v72, v73
    v_cvt_pk_bf16_f32 v105, v74, v75
    v_mfma_f32_32x32x16_bf16 v[88:103], v[52:55], v[20:23], v[88:103]
    v_exp_f32 v76, v76
    v_exp_f32 v77, v77
    v_exp_f32 v78, v78
    v_exp_f32 v79, v79
    v_cvt_pk_bf16_f32 v106, v76, v77
    v_cvt_pk_bf16_f32 v107, v78, v79
    v_mfma_f32_32x32x16_bf16 v[168:183], v[56:59], v[112:115], v[168:183]
    v_exp_f32 v80, v80
    v_exp_f32 v81, v81
    v_exp_f32 v82, v82
    v_exp_f32 v83, v83
    v_cvt_pk_bf16_f32 v108, v80, v81
    v_cvt_pk_bf16_f32 v109, v82, v83
    v_mfma_f32_32x32x16_bf16 v[168:183], v[60:63], v[116:119], v[168:183]
    buffer_load_dwordx4 v[56:59], v2, s[4:7], s19 offen
    buffer_load_dwordx4 v[60:63], v2, s[4:7], s19 offen offset:1024
    v_exp_f32 v84, v84
    v_exp_f32 v85, v85
    v_exp_f32 v86, v86
    v_exp_f32 v87, v87
    v_cvt_pk_bf16_f32 v110, v84, v85
    v_cvt_pk_bf16_f32 v111, v86, v87
    v_mfma_f32_32x32x16_bf16 v[72:87], v[48:51], v[24:27], 0
    v_exp_f32 v88, v88
    v_exp_f32 v89, v89
    v_exp_f32 v90, v90
    v_exp_f32 v91, v91
    v_cvt_pk_bf16_f32 v112, v88, v89
    v_cvt_pk_bf16_f32 v113, v90, v91
    v_mfma_f32_32x32x16_bf16 v[72:87], v[52:55], v[28:31], v[72:87]
    v_exp_f32 v92, v92
    v_exp_f32 v93, v93
    v_exp_f32 v94, v94
    v_exp_f32 v95, v95
    v_cvt_pk_bf16_f32 v114, v92, v93
    v_cvt_pk_bf16_f32 v115, v94, v95
    s_waitcnt vmcnt(4)
    v_mfma_f32_32x32x16_bf16 v[120:135], v[64:67], v[104:107], v[120:135]
    v_exp_f32 v96, v96
    v_exp_f32 v97, v97
    v_exp_f32 v98, v98
    v_exp_f32 v99, v99
    v_cvt_pk_bf16_f32 v116, v96, v97
    v_cvt_pk_bf16_f32 v117, v98, v99
    v_mfma_f32_32x32x16_bf16 v[120:135], v[68:71], v[108:111], v[120:135]
    v_exp_f32 v100, v100
    v_exp_f32 v101, v101
    v_exp_f32 v102, v102
    v_exp_f32 v103, v103
    v_cvt_pk_bf16_f32 v118, v100, v101
    v_cvt_pk_bf16_f32 v119, v102, v103
    v_mfma_f32_32x32x16_bf16 v[88:103], v[48:51], v[32:35], 0
    v_exp_f32 v72, v72
    v_exp_f32 v73, v73
    v_exp_f32 v74, v74
    v_exp_f32 v75, v75
    v_cvt_pk_bf16_f32 v104, v72, v73
    v_cvt_pk_bf16_f32 v105, v74, v75
    v_mfma_f32_32x32x16_bf16 v[88:103], v[52:55], v[36:39], v[88:103]
    v_exp_f32 v76, v76
    v_exp_f32 v77, v77
    v_exp_f32 v78, v78
    v_exp_f32 v79, v79
    v_cvt_pk_bf16_f32 v106, v76, v77
    v_cvt_pk_bf16_f32 v107, v78, v79
    buffer_load_dwordx4 v[48:51], v2, s[4:7], s18 offen
    buffer_load_dwordx4 v[52:55], v2, s[4:7], s18 offen offset:1024
    v_mfma_f32_32x32x16_bf16 v[136:151], v[64:67], v[112:115], v[136:151]
    v_exp_f32 v80, v80
    v_exp_f32 v81, v81
    v_exp_f32 v82, v82
    v_exp_f32 v83, v83
    v_cvt_pk_bf16_f32 v108, v80, v81
    v_cvt_pk_bf16_f32 v109, v82, v83
    v_mfma_f32_32x32x16_bf16 v[136:151], v[68:71], v[116:119], v[136:151]
    v_exp_f32 v84, v84
    v_exp_f32 v85, v85
    v_exp_f32 v86, v86
    v_exp_f32 v87, v87
    v_cvt_pk_bf16_f32 v110, v84, v85
    v_cvt_pk_bf16_f32 v111, v86, v87
    s_waitcnt vmcnt(4)
    v_mfma_f32_32x32x16_bf16 v[72:87], v[40:43], v[8:11], 0
    v_exp_f32 v88, v88
    v_exp_f32 v89, v89
    v_exp_f32 v90, v90
    v_exp_f32 v91, v91
    v_cvt_pk_bf16_f32 v112, v88, v89
    v_cvt_pk_bf16_f32 v113, v90, v91
    v_mfma_f32_32x32x16_bf16 v[72:87], v[44:47], v[12:15], v[72:87]
    v_exp_f32 v92, v92
    v_exp_f32 v93, v93
    v_exp_f32 v94, v94
    v_exp_f32 v95, v95
    v_cvt_pk_bf16_f32 v114, v92, v93
    v_cvt_pk_bf16_f32 v115, v94, v95
    v_mfma_f32_32x32x16_bf16 v[152:167], v[64:67], v[104:107], v[152:167]
    v_exp_f32 v96, v96
    v_exp_f32 v97, v97
    v_exp_f32 v98, v98
    v_exp_f32 v99, v99
    v_cvt_pk_bf16_f32 v116, v96, v97
    v_cvt_pk_bf16_f32 v117, v98, v99
    v_mfma_f32_32x32x16_bf16 v[152:167], v[68:71], v[108:111], v[152:167]
    s_add_u32 s18, s18, 2048
    s_add_u32 s19, s19, 2048
    s_sub_u32 s17, s17, 1
    v_exp_f32 v100, v100
    v_exp_f32 v101, v101
    v_exp_f32 v102, v102
    v_exp_f32 v103, v103
    v_cvt_pk_bf16_f32 v118, v100, v101
    v_cvt_pk_bf16_f32 v119, v102, v103
    s_cmp_gt_u32 s17, s43
    s_cbranch_scc1 k2_loopb
    s_setprio 0
    s_cmp_lg_u32 s17, 0
    s_cbranch_scc1 k2_loopb
    v_mfma_f32_32x32x16_bf16 v[168:183], v[64:67], v[112:115], v[168:183]
    v_mfma_f32_32x32x16_bf16 v[168:183], v[68:71], v[116:119], v[168:183]
    s_branch k2_finb
k2_exit0b:
    v_mfma_f32_32x32x16_bf16 v[168:183], v[56:59], v[112:115], v[168:183]
    v_mfma_f32_32x32x16_bf16 v[168:183], v[60:63], v[116:119], v[168:183]
k2_finb:
    s_nop 7
    s_nop 3
    v_add_u32 v184, 24576, v2
    ds_write_b128 v184, v[120:123] offset:0
    ds_write_b128 v184, v[124:127] offset:1024
    ds_write_b128 v184, v[128:131] offset:2048
    ds_write_b128 v184, v[132:135] offset:3072
    ds_write_b128 v184, v[136:139] offset:4096
    ds_write_b128 v184, v[140:143] offset:5120
    ds_write_b128 v184, v[144:147] offset:6144
    ds_write_b128 v184, v[148:151] offset:7168
    ds_write_b128 v184, v[152:155] offset:32768
    ds_write_b128 v184, v[156:159] offset:33792
    ds_write_b128 v184, v[160:163] offset:34816
    ds_write_b128 v184, v[164:167] offset:35840
    ds_write_b128 v184, v[168:171] offset:36864
    ds_write_b128 v184, v[172:175] offset:37888
    ds_write_b128 v184, v[176:179] offset:38912
    ds_write_b128 v184, v[180:183] offset:39936
    s_branch k2_red2
k2_w7:
    buffer_load_dword v186, v184, s[4:7], s31 offen
    buffer_load_dword v187, v185, s[4:7], s30 offen
    s_waitcnt vmcnt(0)
    v_max_u32_dpp v186, v186, v186 row_shr:1 row_mask:0xf bank_mask:0xf
    v_max_u32_dpp v187, v187, v187 row_shr:1 row_mask:0xf bank_mask:0xf
    s_nop 0
    v_max_u32_dpp v186, v186, v186 row_shr:2 row_mask:0xf bank_mask:0xf
    v_max_u32_dpp v187, v187, v187 row_shr:2 row_mask:0xf bank_mask:0xf
    s_nop 0
    v_max_u32_dpp v186, v186, v186 row_shr:4 row_mask:0xf bank_mask:0xf
    v_max_u32_dpp v187, v187, v187 row_shr:4 row_mask:0xf bank_mask:0xf
    s_nop 0
    v_max_u32_dpp v186, v186, v186 row_shr:8 row_mask:0xf bank_mask:0xf
    v_max_u32_dpp v187, v187, v187 row_shr:8 row_mask:0xf bank_mask:0xf
    s_nop 0
    v_max_u32_dpp v186, v186, v186 row_bcast:15 row_mask:0xa bank_mask:0xf
    v_readlane_b32 s38, v187, 15
    s_nop 0
    v_max_u32_dpp v186, v186, v186 row_bcast:31 row_mask:0xc bank_mask:0xf
    v_mov_b32 v187, 0x3e800000
    v_readlane_b32 s37, v186, 63
    v_mov_b32 v188, 0x3f828f5c
    s_nop 0
    v_mov_b32 v186, s37
    v_mul_f32 v186, s38, v186
    v_sqrt_f32 v186, v186
    s_nop 0
    v_fma_f32 v186, v186, v188, v187
    s_nop 0
    v_readfirstlane_b32 s37, v186
    s_nop 1
    s_cmp_gt_u32 s37, 0x42400000
    s_cselect_b32 s53, 1, 0
    s_cmp_ge_u32 s2, 225
    s_cbranch_scc1 k2_w7b
    s_setprio 1
    s_lshl_b32 s20, s2, 1
    s_cmp_eq_u32 s2, 224
    s_cselect_b32 s20, 1, s20
    s_lshl_b32 s21, s2, 1
    s_add_u32 s21, s21, 1
    s_mul_i32 s20, s20, 4224
    s_mul_i32 s21, s21, 4224
    s_cmp_eq_u32 s2, 224
    s_cselect_b32 s21, 0x40000000, s21
    s_cmp_eq_u32 s2, 0
    s_cselect_b32 s21, 0x40000000, s21
    v_and_b32 v3, 31, v1
    v_lshrrev_b32 v6, 5, v1
    v_lshlrev_b32 v6, 4, v6
    v_lshl_add_u32 v6, v3, 6, v6
    s_add_u32 s22, s20, 7340032
    s_add_u32 s23, s21, 7340032
    buffer_load_dwordx4 v[8:11], v6, s[4:7], s22 offen offset:0
    buffer_load_dwordx4 v[12:15], v6, s[4:7], s22 offen offset:32
    buffer_load_dwordx4 v[16:19], v6, s[4:7], s22 offen offset:2048
    buffer_load_dwordx4 v[20:23], v6, s[4:7], s22 offen offset:2080
    buffer_load_dwordx4 v[24:27], v6, s[4:7], s23 offen offset:0
    buffer_load_dwordx4 v[28:31], v6, s[4:7], s23 offen offset:32
    buffer_load_dwordx4 v[32:35], v6, s[4:7], s23 offen offset:2048
    buffer_load_dwordx4 v[36:39], v6, s[4:7], s23 offen offset:2080
    s_mov_b32 s24, 0
    s_mov_b32 m0, 65536
    s_nop 0
    buffer_load_dwordx4 v2, s[8:11], s24 offen offset:0 lds
    buffer_load_dwordx4 v2, s[8:11], s24 offen offset:1024 lds
    buffer_load_dwordx4 v2, s[8:11], s24 offen offset:2048 lds
    buffer_load_dwordx4 v2, s[8:11], s24 offen offset:3072 lds
    s_add_u32 s24, s24, 4096
    s_add_u32 m0, m0, 4096
    s_nop 0
    buffer_load_dwordx4 v2, s[8:11], s24 offen offset:0 lds
    buffer_load_dwordx4 v2, s[8:11], s24 offen offset:1024 lds
    v_add_u32 v4, 65536, v2
    v_add_u32 v5, 129024, v2
    s_mov_b32 s24, 30720
    s_mov_b32 m0, 96256
    s_nop 0
    buffer_load_dwordx4 v2, s[8:11], s24 offen offset:0 lds
    buffer_load_dwordx4 v2, s[8:11], s24 offen offset:1024 lds
    buffer_load_dwordx4 v2, s[8:11], s24 offen offset:2048 lds
    buffer_load_dwordx4 v2, s[8:11], s24 offen offset:3072 lds
    s_add_u32 s24, s24, 4096
    s_add_u32 m0, m0, 4096
    s_nop 0
    buffer_load_dwordx4 v2, s[8:11], s24 offen offset:0 lds
    buffer_load_dwordx4 v2, s[8:11], s24 offen offset:1024 lds
    buffer_load_dwordx4 v2, s[8:11], s24 offen offset:2048 lds
    buffer_load_dwordx4 v2, s[8:11], s24 offen offset:3072 lds
    s_add_u32 s24, s24, 4096
    s_add_u32 m0, m0, 4096
    s_nop 0
    buffer_load_dwordx4 v2, s[8:11], s24 offen offset:0 lds
    buffer_load_dwordx4 v2, s[8:11], s24 offen offset:1024 lds
    buffer_load_dwordx4 v2, s[8:11], s24 offen offset:2048 lds
    buffer_load_dwordx4 v2, s[8:11], s24 offen offset:3072 lds
    s_add_u32 s24, s24, 4096
    s_add_u32 m0, m0, 4096
    s_nop 0
    buffer_load_dwordx4 v2, s[8:11], s24 offen offset:0 lds
    buffer_load_dwordx4 v2, s[8:11], s24 offen offset:1024 lds
    buffer_load_dwordx4 v2, s[8:11], s24 offen offset:2048 lds
    buffer_load_dwordx4 v2, s[8:11], s24 offen offset:3072 lds
    s_mov_b32 s24, 6144
    s_mov_b32 m0, 71680
    s_nop 0
    buffer_load_dwordx4 v2, s[8:11], s24 offen offset:0 lds
    buffer_load_dwordx4 v2, s[8:11], s24 offen offset:1024 lds
    buffer_load_dwordx4 v2, s[8:11], s24 offen offset:2048 lds
    buffer_load_dwordx4 v2, s[8:11], s24 offen offset:3072 lds
    s_add_u32 s24, s24, 4096
    s_add_u32 m0, m0, 4096
    s_nop 0
    buffer_load_dwordx4 v2, s[8:11], s24 offen offset:0 lds
    buffer_load_dwordx4 v2, s[8:11], s24 offen offset:1024 lds
    buffer_load_dwordx4 v2, s[8:11], s24 offen offset:2048 lds
    buffer_load_dwordx4 v2, s[8:11], s24 offen offset:3072 lds
    s_add_u32 s24, s24, 4096
    s_add_u32 m0, m0, 4096
    s_nop 0
    buffer_load_dwordx4 v2, s[8:11], s24 offen offset:0 lds
    buffer_load_dwordx4 v2, s[8:11], s24 offen offset:1024 lds
    buffer_load_dwordx4 v2, s[8:11], s24 offen offset:2048 lds
    buffer_load_dwordx4 v2, s[8:11], s24 offen offset:3072 lds
    s_add_u32 s24, s24, 4096
    s_add_u32 m0, m0, 4096
    s_nop 0
    buffer_load_dwordx4 v2, s[8:11], s24 offen offset:0 lds
    buffer_load_dwordx4 v2, s[8:11], s24 offen offset:1024 lds
    buffer_load_dwordx4 v2, s[8:11], s24 offen offset:2048 lds
    buffer_load_dwordx4 v2, s[8:11], s24 offen offset:3072 lds
    s_add_u32 s24, s24, 4096
    s_add_u32 m0, m0, 4096
    s_nop 0
    buffer_load_dwordx4 v2, s[8:11], s24 offen offset:0 lds
    buffer_load_dwordx4 v2, s[8:11], s24 offen offset:1024 lds
    buffer_load_dwordx4 v2, s[8:11], s24 offen offset:2048 lds
    buffer_load_dwordx4 v2, s[8:11], s24 offen offset:3072 lds
    s_add_u32 s24, s24, 4096
    s_add_u32 m0, m0, 4096
    s_nop 0
    buffer_load_dwordx4 v2, s[8:11], s24 offen offset:0 lds
    buffer_load_dwordx4 v2, s[8:11], s24 offen offset:1024 lds
    buffer_load_dwordx4 v2, s[8:11], s24 offen offset:2048 lds
    buffer_load_dwordx4 v2, s[8:11], s24 offen offset:3072 lds
    s_waitcnt vmcnt(40)
    s_mul_i32 s25, s2, 8320
    s_add_u32 s25, s25, 9437184
    s_mov_b32 s24, s25
    s_mov_b32 m0, 129024
    s_nop 0
    buffer_load_dwordx4 v2, s[4:7], s24 offen offset:0 lds
    buffer_load_dwordx4 v2, s[4:7], s24 offen offset:1024 lds
    buffer_load_dwordx4 v2, s[4:7], s24 offen offset:2048 lds
    buffer_load_dwordx4 v2, s[4:7], s24 offen offset:3072 lds
    s_add_u32 s24, s24, 4096
    s_add_u32 m0, m0, 4096
    s_nop 0
    buffer_load_dwordx4 v2, s[4:7], s24 offen offset:0 lds
    buffer_load_dwordx4 v2, s[4:7], s24 offen offset:1024 lds
    buffer_load_dwordx4 v2, s[4:7], s24 offen offset:2048 lds
    buffer_load_dwordx4 v2, s[4:7], s24 offen offset:3072 lds
    ds_read_b128 v[160:163], v4 offset:0
    ds_read_b128 v[164:167], v4 offset:1024
    ds_read_b128 v[168:171], v4 offset:2048
    ds_read_b128 v[172:175], v4 offset:3072
    ds_read_b128 v[176:179], v4 offset:4096
    ds_read_b128 v[180:183], v4 offset:5120
    s_waitcnt lgkmcnt(0)
    v_mfma_f32_32x32x16_bf16 v[64:79], v[8:11], v[160:163], 0
    v_mfma_f32_32x32x16_bf16 v[96:111], v[8:11], v[168:171], 0
    v_mfma_f32_32x32x16_bf16 v[64:79], v[12:15], v[164:167], v[64:79]
    v_mfma_f32_32x32x16_bf16 v[96:111], v[12:15], v[172:175], v[96:111]
    v_mfma_f32_32x32x16_bf16 v[64:79], v[24:27], v[176:179], v[64:79]
    v_mfma_f32_32x32x16_bf16 v[96:111], v[24:27], v[160:163], v[96:111]
    v_mfma_f32_32x32x16_bf16 v[64:79], v[28:31], v[180:183], v[64:79]
    v_mfma_f32_32x32x16_bf16 v[96:111], v[28:31], v[164:167], v[96:111]
    v_mfma_f32_32x32x16_bf16 v[80:95], v[16:19], v[160:163], 0
    v_mfma_f32_32x32x16_bf16 v[112:127], v[16:19], v[168:171], 0
    v_mfma_f32_32x32x16_bf16 v[80:95], v[20:23], v[164:167], v[80:95]
    v_mfma_f32_32x32x16_bf16 v[112:127], v[20:23], v[172:175], v[112:127]
    v_mfma_f32_32x32x16_bf16 v[80:95], v[32:35], v[176:179], v[80:95]
    v_mfma_f32_32x32x16_bf16 v[112:127], v[32:35], v[160:163], v[112:127]
    v_mfma_f32_32x32x16_bf16 v[80:95], v[36:39], v[180:183], v[80:95]
    v_mfma_f32_32x32x16_bf16 v[112:127], v[36:39], v[164:167], v[112:127]
    s_waitcnt vmcnt(32)
    s_nop 7
    s_nop 3
    ds_read_b128 v[208:211], v4 offset:30720
    ds_read_b128 v[212:215], v4 offset:31744
    ds_read_b128 v[216:219], v4 offset:32768
    ds_read_b128 v[220:223], v4 offset:33792
    ds_read_b128 v[224:227], v4 offset:34816
    ds_read_b128 v[228:231], v4 offset:35840
    ds_read_b128 v[232:235], v4 offset:36864
    ds_read_b128 v[236:239], v4 offset:37888
    s_waitcnt lgkmcnt(6)
    v_pk_mul_f32 v[240:241], v[64:65], v[208:209]
    v_pk_mul_f32 v[242:243], v[64:65], v[212:213]
    v_pk_mul_f32 v[244:245], v[66:67], v[210:211]
    v_pk_mul_f32 v[246:247], v[66:67], v[214:215]
    v_pk_fma_f32 v[240:241], v[96:97], v[212:213], v[240:241] neg_lo:[1,0,0] neg_hi:[1,0,0]
    v_pk_fma_f32 v[242:243], v[96:97], v[208:209], v[242:243]
    v_pk_fma_f32 v[244:245], v[98:99], v[214:215], v[244:245] neg_lo:[1,0,0] neg_hi:[1,0,0]
    v_pk_fma_f32 v[246:247], v[98:99], v[210:211], v[246:247]
    v_cvt_pk_bf16_f32 v128, v240, v241
    v_cvt_pk_bf16_f32 v144, v242, v243
    v_cvt_pk_bf16_f32 v129, v244, v245
    v_cvt_pk_bf16_f32 v145, v246, v247
    s_waitcnt lgkmcnt(4)
    v_pk_mul_f32 v[240:241], v[68:69], v[216:217]
    v_pk_mul_f32 v[242:243], v[68:69], v[220:221]
    v_pk_mul_f32 v[244:245], v[70:71], v[218:219]
    v_pk_mul_f32 v[246:247], v[70:71], v[222:223]
    v_pk_fma_f32 v[240:241], v[100:101], v[220:221], v[240:241] neg_lo:[1,0,0] neg_hi:[1,0,0]
    v_pk_fma_f32 v[242:243], v[100:101], v[216:217], v[242:243]
    v_pk_fma_f32 v[244:245], v[102:103], v[222:223], v[244:245] neg_lo:[1,0,0] neg_hi:[1,0,0]
    v_pk_fma_f32 v[246:247], v[102:103], v[218:219], v[246:247]
    v_cvt_pk_bf16_f32 v130, v240, v241
    v_cvt_pk_bf16_f32 v146, v242, v243
    v_cvt_pk_bf16_f32 v131, v244, v245
    v_cvt_pk_bf16_f32 v147, v246, v247
    s_waitcnt lgkmcnt(2)
    v_pk_mul_f32 v[240:241], v[72:73], v[224:225]
    v_pk_mul_f32 v[242:243], v[72:73], v[228:229]
    v_pk_mul_f32 v[244:245], v[74:75], v[226:227]
    v_pk_mul_f32 v[246:247], v[74:75], v[230:231]
    v_pk_fma_f32 v[240:241], v[104:105], v[228:229], v[240:241] neg_lo:[1,0,0] neg_hi:[1,0,0]
    v_pk_fma_f32 v[242:243], v[104:105], v[224:225], v[242:243]
    v_pk_fma_f32 v[244:245], v[106:107], v[230:231], v[244:245] neg_lo:[1,0,0] neg_hi:[1,0,0]
    v_pk_fma_f32 v[246:247], v[106:107], v[226:227], v[246:247]
    v_cvt_pk_bf16_f32 v132, v240, v241
    v_cvt_pk_bf16_f32 v148, v242, v243
    v_cvt_pk_bf16_f32 v133, v244, v245
    v_cvt_pk_bf16_f32 v149, v246, v247
    s_waitcnt lgkmcnt(0)
    v_pk_mul_f32 v[240:241], v[76:77], v[232:233]
    v_pk_mul_f32 v[242:243], v[76:77], v[236:237]
    v_pk_mul_f32 v[244:245], v[78:79], v[234:235]
    v_pk_mul_f32 v[246:247], v[78:79], v[238:239]
    v_pk_fma_f32 v[240:241], v[108:109], v[236:237], v[240:241] neg_lo:[1,0,0] neg_hi:[1,0,0]
    v_pk_fma_f32 v[242:243], v[108:109], v[232:233], v[242:243]
    v_pk_fma_f32 v[244:245], v[110:111], v[238:239], v[244:245] neg_lo:[1,0,0] neg_hi:[1,0,0]
    v_pk_fma_f32 v[246:247], v[110:111], v[234:235], v[246:247]
    v_cvt_pk_bf16_f32 v134, v240, v241
    v_cvt_pk_bf16_f32 v150, v242, v243
    v_cvt_pk_bf16_f32 v135, v244, v245
    v_cvt_pk_bf16_f32 v151, v246, v247
    ds_read_b128 v[208:211], v4 offset:38912
    ds_read_b128 v[212:215], v4 offset:39936
    ds_read_b128 v[216:219], v4 offset:40960
    ds_read_b128 v[220:223], v4 offset:41984
    ds_read_b128 v[224:227], v4 offset:43008
    ds_read_b128 v[228:231], v4 offset:44032
    ds_read_b128 v[232:235], v4 offset:45056
    ds_read_b128 v[236:239], v4 offset:46080
    s_waitcnt lgkmcnt(6)
    v_pk_mul_f32 v[240:241], v[80:81], v[208:209]
    v_pk_mul_f32 v[242:243], v[80:81], v[212:213]
    v_pk_mul_f32 v[244:245], v[82:83], v[210:211]
    v_pk_mul_f32 v[246:247], v[82:83], v[214:215]
    v_pk_fma_f32 v[240:241], v[112:113], v[212:213], v[240:241] neg_lo:[1,0,0] neg_hi:[1,0,0]
    v_pk_fma_f32 v[242:243], v[112:113], v[208:209], v[242:243]
    v_pk_fma_f32 v[244:245], v[114:115], v[214:215], v[244:245] neg_lo:[1,0,0] neg_hi:[1,0,0]
    v_pk_fma_f32 v[246:247], v[114:115], v[210:211], v[246:247]
    v_cvt_pk_bf16_f32 v136, v240, v241
    v_cvt_pk_bf16_f32 v152, v242, v243
    v_cvt_pk_bf16_f32 v137, v244, v245
    v_cvt_pk_bf16_f32 v153, v246, v247
    s_waitcnt lgkmcnt(4)
    v_pk_mul_f32 v[240:241], v[84:85], v[216:217]
    v_pk_mul_f32 v[242:243], v[84:85], v[220:221]
    v_pk_mul_f32 v[244:245], v[86:87], v[218:219]
    v_pk_mul_f32 v[246:247], v[86:87], v[222:223]
    v_pk_fma_f32 v[240:241], v[116:117], v[220:221], v[240:241] neg_lo:[1,0,0] neg_hi:[1,0,0]
    v_pk_fma_f32 v[242:243], v[116:117], v[216:217], v[242:243]
    v_pk_fma_f32 v[244:245], v[118:119], v[222:223], v[244:245] neg_lo:[1,0,0] neg_hi:[1,0,0]
    v_pk_fma_f32 v[246:247], v[118:119], v[218:219], v[246:247]
    v_cvt_pk_bf16_f32 v138, v240, v241
    v_cvt_pk_bf16_f32 v154, v242, v243
    v_cvt_pk_bf16_f32 v139, v244, v245
    v_cvt_pk_bf16_f32 v155, v246, v247
    s_waitcnt lgkmcnt(2)
    v_pk_mul_f32 v[240:241], v[88:89], v[224:225]
    v_pk_mul_f32 v[242:243], v[88:89], v[228:229]
    v_pk_mul_f32 v[244:245], v[90:91], v[226:227]
    v_pk_mul_f32 v[246:247], v[90:91], v[230:231]
    v_pk_fma_f32 v[240:241], v[120:121], v[228:229], v[240:241] neg_lo:[1,0,0] neg_hi:[1,0,0]
    v_pk_fma_f32 v[242:243], v[120:121], v[224:225], v[242:243]
    v_pk_fma_f32 v[244:245], v[122:123], v[230:231], v[244:245] neg_lo:[1,0,0] neg_hi:[1,0,0]
    v_pk_fma_f32 v[246:247], v[122:123], v[226:227], v[246:247]
    v_cvt_pk_bf16_f32 v140, v240, v241
    v_cvt_pk_bf16_f32 v156, v242, v243
    v_cvt_pk_bf16_f32 v141, v244, v245
    v_cvt_pk_bf16_f32 v157, v246, v247
    s_waitcnt lgkmcnt(0)
    v_pk_mul_f32 v[240:241], v[92:93], v[232:233]
    v_pk_mul_f32 v[242:243], v[92:93], v[236:237]
    v_pk_mul_f32 v[244:245], v[94:95], v[234:235]
    v_pk_mul_f32 v[246:247], v[94:95], v[238:239]
    v_pk_fma_f32 v[240:241], v[124:125], v[236:237], v[240:241] neg_lo:[1,0,0] neg_hi:[1,0,0]
    v_pk_fma_f32 v[242:243], v[124:125], v[232:233], v[242:243]
    v_pk_fma_f32 v[244:245], v[126:127], v[238:239], v[244:245] neg_lo:[1,0,0] neg_hi:[1,0,0]
    v_pk_fma_f32 v[246:247], v[126:127], v[234:235], v[246:247]
    v_cvt_pk_bf16_f32 v142, v240, v241
    v_cvt_pk_bf16_f32 v158, v242, v243
    v_cvt_pk_bf16_f32 v143, v244, v245
    v_cvt_pk_bf16_f32 v159, v246, v247
    s_mov_b32 s24, 47104
    s_mov_b32 m0, 112640
    s_nop 0
    buffer_load_dwordx4 v2, s[8:11], s24 offen offset:0 lds
    buffer_load_dwordx4 v2, s[8:11], s24 offen offset:1024 lds
    buffer_load_dwordx4 v2, s[8:11], s24 offen offset:2048 lds
    buffer_load_dwordx4 v2, s[8:11], s24 offen offset:3072 lds
    s_add_u32 s24, s24, 4096
    s_add_u32 m0, m0, 4096
    s_nop 0
    buffer_load_dwordx4 v2, s[8:11], s24 offen offset:0 lds
    buffer_load_dwordx4 v2, s[8:11], s24 offen offset:1024 lds
    buffer_load_dwordx4 v2, s[8:11], s24 offen offset:2048 lds
    buffer_load_dwordx4 v2, s[8:11], s24 offen offset:3072 lds
    s_add_u32 s24, s24, 4096
    s_add_u32 m0, m0, 4096
    s_nop 0
    buffer_load_dwordx4 v2, s[8:11], s24 offen offset:0 lds
    buffer_load_dwordx4 v2, s[8:11], s24 offen offset:1024 lds
    buffer_load_dwordx4 v2, s[8:11], s24 offen offset:2048 lds
    buffer_load_dwordx4 v2, s[8:11], s24 offen offset:3072 lds
    s_add_u32 s24, s24, 4096
    s_add_u32 m0, m0, 4096
    s_nop 0
    buffer_load_dwordx4 v2, s[8:11], s24 offen offset:0 lds
    buffer_load_dwordx4 v2, s[8:11], s24 offen offset:1024 lds
    buffer_load_dwordx4 v2, s[8:11], s24 offen offset:2048 lds
    buffer_load_dwordx4 v2, s[8:11], s24 offen offset:3072 lds
    s_waitcnt vmcnt(24)
    ds_read_b128 v[160:163], v4 offset:6144
    ds_read_b128 v[164:167], v4 offset:7168
    ds_read_b128 v[168:171], v4 offset:8192
    ds_read_b128 v[172:175], v4 offset:9216
    ds_read_b128 v[176:179], v4 offset:10240
    ds_read_b128 v[180:183], v4 offset:11264
    ds_read_b128 v[184:187], v4 offset:12288
    ds_read_b128 v[188:191], v4 offset:13312
    ds_read_b128 v[192:195], v4 offset:14336
    s_waitcnt lgkmcnt(6)
    v_mfma_f32_32x32x16_bf16 v[64:79], v[160:163], v[128:131], 0
    v_mfma_f32_32x32x16_bf16 v[96:111], v[164:167], v[128:131], 0
    v_mfma_f32_32x32x16_bf16 v[64:79], v[168:171], v[144:147], v[64:79]
    v_mfma_f32_32x32x16_bf16 v[96:111], v[160:163], v[144:147], v[96:111]
    ds_read_b128 v[196:199], v4 offset:15360
    ds_read_b128 v[200:203], v4 offset:16384
    ds_read_b128 v[204:207], v4 offset:17408
    s_waitcnt lgkmcnt(6)
    v_mfma_f32_32x32x16_bf16 v[64:79], v[172:175], v[132:135], v[64:79]
    v_mfma_f32_32x32x16_bf16 v[96:111], v[176:179], v[132:135], v[96:111]
    v_mfma_f32_32x32x16_bf16 v[64:79], v[180:183], v[148:151], v[64:79]
    v_mfma_f32_32x32x16_bf16 v[96:111], v[172:175], v[148:151], v[96:111]
    ds_read_b128 v[160:163], v4 offset:18432
    ds_read_b128 v[164:167], v4 offset:19456
    ds_read_b128 v[168:171], v4 offset:20480
    s_waitcnt lgkmcnt(6)
    v_mfma_f32_32x32x16_bf16 v[64:79], v[184:187], v[136:139], v[64:79]
    v_mfma_f32_32x32x16_bf16 v[96:111], v[188:191], v[136:139], v[96:111]
    v_mfma_f32_32x32x16_bf16 v[64:79], v[192:195], v[152:155], v[64:79]
    v_mfma_f32_32x32x16_bf16 v[96:111], v[184:187], v[152:155], v[96:111]
    ds_read_b128 v[172:175], v4 offset:21504
    ds_read_b128 v[176:179], v4 offset:22528
    ds_read_b128 v[180:183], v4 offset:23552
    s_waitcnt lgkmcnt(6)
    v_mfma_f32_32x32x16_bf16 v[64:79], v[196:199], v[140:143], v[64:79]
    v_mfma_f32_32x32x16_bf16 v[96:111], v[200:203], v[140:143], v[96:111]
    v_mfma_f32_32x32x16_bf16 v[64:79], v[204:207], v[156:159], v[64:79]
    v_mfma_f32_32x32x16_bf16 v[96:111], v[196:199], v[156:159], v[96:111]
    ds_read_b128 v[184:187], v4 offset:24576
    ds_read_b128 v[188:191], v4 offset:25600
    ds_read_b128 v[192:195], v4 offset:26624
    s_waitcnt lgkmcnt(6)
    v_mfma_f32_32x32x16_bf16 v[80:95], v[160:163], v[128:131], 0
    v_mfma_f32_32x32x16_bf16 v[112:127], v[164:167], v[128:131], 0
    v_mfma_f32_32x32x16_bf16 v[80:95], v[168:171], v[144:147], v[80:95]
    v_mfma_f32_32x32x16_bf16 v[112:127], v[160:163], v[144:147], v[112:127]
    ds_read_b128 v[196:199], v4 offset:27648
    ds_read_b128 v[200:203], v4 offset:28672
    ds_read_b128 v[204:207], v4 offset:29696
    s_waitcnt lgkmcnt(6)
    v_mfma_f32_32x32x16_bf16 v[80:95], v[172:175], v[132:135], v[80:95]
    v_mfma_f32_32x32x16_bf16 v[112:127], v[176:179], v[132:135], v[112:127]
    v_mfma_f32_32x32x16_bf16 v[80:95], v[180:183], v[148:151], v[80:95]
    v_mfma_f32_32x32x16_bf16 v[112:127], v[172:175], v[148:151], v[112:127]
    s_waitcnt lgkmcnt(3)
    v_mfma_f32_32x32x16_bf16 v[80:95], v[184:187], v[136:139], v[80:95]
    v_mfma_f32_32x32x16_bf16 v[112:127], v[188:191], v[136:139], v[112:127]
    v_mfma_f32_32x32x16_bf16 v[80:95], v[192:195], v[152:155], v[80:95]
    v_mfma_f32_32x32x16_bf16 v[112:127], v[184:187], v[152:155], v[112:127]
    s_waitcnt lgkmcnt(0)
    v_mfma_f32_32x32x16_bf16 v[80:95], v[196:199], v[140:143], v[80:95]
    v_mfma_f32_32x32x16_bf16 v[112:127], v[200:203], v[140:143], v[112:127]
    v_mfma_f32_32x32x16_bf16 v[80:95], v[204:207], v[156:159], v[80:95]
    v_mfma_f32_32x32x16_bf16 v[112:127], v[196:199], v[156:159], v[112:127]
    s_waitcnt vmcnt(16)
    s_nop 7
    s_nop 3
    ds_read_b128 v[208:211], v5 offset:0
    ds_read_b128 v[212:215], v5 offset:1024
    ds_read_b128 v[216:219], v5 offset:2048
    ds_read_b128 v[220:223], v5 offset:3072
    s_waitcnt lgkmcnt(3)
    v_lshlrev_b32 v224, 16, v208
    v_and_b32 v228, 0xffff0000, v208
    v_lshlrev_b32 v225, 16, v209
    v_and_b32 v229, 0xffff0000, v209
    v_lshlrev_b32 v226, 16, v210
    v_and_b32 v230, 0xffff0000, v210
    v_lshlrev_b32 v227, 16, v211
    v_and_b32 v231, 0xffff0000, v211
    v_pk_mul_f32 v[240:241], v[64:65], v[224:225]
    v_pk_mul_f32 v[242:243], v[64:65], v[228:229]
    v_pk_mul_f32 v[244:245], v[66:67], v[226:227]
    v_pk_mul_f32 v[246:247], v[66:67], v[230:231]
    v_pk_fma_f32 v[240:241], v[96:97], v[228:229], v[240:241] neg_lo:[1,0,0] neg_hi:[1,0,0]
    v_pk_fma_f32 v[242:243], v[96:97], v[224:225], v[242:243]
    v_pk_fma_f32 v[244:245], v[98:99], v[230:231], v[244:245] neg_lo:[1,0,0] neg_hi:[1,0,0]
    v_pk_fma_f32 v[246:247], v[98:99], v[226:227], v[246:247]
    v_cvt_pk_bf16_f32 v128, v240, v241
    v_cvt_pk_bf16_f32 v144, v242, v243
    v_cvt_pk_bf16_f32 v129, v244, v245
    v_cvt_pk_bf16_f32 v145, v246, v247
    s_waitcnt lgkmcnt(2)
    v_lshlrev_b32 v224, 16, v212
    v_and_b32 v228, 0xffff0000, v212
    v_lshlrev_b32 v225, 16, v213
    v_and_b32 v229, 0xffff0000, v213
    v_lshlrev_b32 v226, 16, v214
    v_and_b32 v230, 0xffff0000, v214
    v_lshlrev_b32 v227, 16, v215
    v_and_b32 v231, 0xffff0000, v215
    v_pk_mul_f32 v[240:241], v[68:69], v[224:225]
    v_pk_mul_f32 v[242:243], v[68:69], v[228:229]
    v_pk_mul_f32 v[244:245], v[70:71], v[226:227]
    v_pk_mul_f32 v[246:247], v[70:71], v[230:231]
    v_pk_fma_f32 v[240:241], v[100:101], v[228:229], v[240:241] neg_lo:[1,0,0] neg_hi:[1,0,0]
    v_pk_fma_f32 v[242:243], v[100:101], v[224:225], v[242:243]
    v_pk_fma_f32 v[244:245], v[102:103], v[230:231], v[244:245] neg_lo:[1,0,0] neg_hi:[1,0,0]
    v_pk_fma_f32 v[246:247], v[102:103], v[226:227], v[246:247]
    v_cvt_pk_bf16_f32 v130, v240, v241
    v_cvt_pk_bf16_f32 v146, v242, v243
    v_cvt_pk_bf16_f32 v131, v244, v245
    v_cvt_pk_bf16_f32 v147, v246, v247
    s_waitcnt lgkmcnt(1)
    v_lshlrev_b32 v224, 16, v216
    v_and_b32 v228, 0xffff0000, v216
    v_lshlrev_b32 v225, 16, v217
    v_and_b32 v229, 0xffff0000, v217
    v_lshlrev_b32 v226, 16, v218
    v_and_b32 v230, 0xffff0000, v218
    v_lshlrev_b32 v227, 16, v219
    v_and_b32 v231, 0xffff0000, v219
    v_pk_mul_f32 v[240:241], v[72:73], v[224:225]
    v_pk_mul_f32 v[242:243], v[72:73], v[228:229]
    v_pk_mul_f32 v[244:245], v[74:75], v[226:227]
    v_pk_mul_f32 v[246:247], v[74:75], v[230:231]
    v_pk_fma_f32 v[240:241], v[104:105], v[228:229], v[240:241] neg_lo:[1,0,0] neg_hi:[1,0,0]
    v_pk_fma_f32 v[242:243], v[104:105], v[224:225], v[242:243]
    v_pk_fma_f32 v[244:245], v[106:107], v[230:231], v[244:245] neg_lo:[1,0,0] neg_hi:[1,0,0]
    v_pk_fma_f32 v[246:247], v[106:107], v[226:227], v[246:247]
    v_cvt_pk_bf16_f32 v132, v240, v241
    v_cvt_pk_bf16_f32 v148, v242, v243
    v_cvt_pk_bf16_f32 v133, v244, v245
    v_cvt_pk_bf16_f32 v149, v246, v247
    s_waitcnt lgkmcnt(0)
    v_lshlrev_b32 v224, 16, v220
    v_and_b32 v228, 0xffff0000, v220
    v_lshlrev_b32 v225, 16, v221
    v_and_b32 v229, 0xffff0000, v221
    v_lshlrev_b32 v226, 16, v222
    v_and_b32 v230, 0xffff0000, v222
    v_lshlrev_b32 v227, 16, v223
    v_and_b32 v231, 0xffff0000, v223
    v_pk_mul_f32 v[240:241], v[76:77], v[224:225]
    v_pk_mul_f32 v[242:243], v[76:77], v[228:229]
    v_pk_mul_f32 v[244:245], v[78:79], v[226:227]
    v_pk_mul_f32 v[246:247], v[78:79], v[230:231]
    v_pk_fma_f32 v[240:241], v[108:109], v[228:229], v[240:241] neg_lo:[1,0,0] neg_hi:[1,0,0]
    v_pk_fma_f32 v[242:243], v[108:109], v[224:225], v[242:243]
    v_pk_fma_f32 v[244:245], v[110:111], v[230:231], v[244:245] neg_lo:[1,0,0] neg_hi:[1,0,0]
    v_pk_fma_f32 v[246:247], v[110:111], v[226:227], v[246:247]
    v_cvt_pk_bf16_f32 v134, v240, v241
    v_cvt_pk_bf16_f32 v150, v242, v243
    v_cvt_pk_bf16_f32 v135, v244, v245
    v_cvt_pk_bf16_f32 v151, v246, v247
    ds_read_b128 v[208:211], v5 offset:4096
    ds_read_b128 v[212:215], v5 offset:5120
    ds_read_b128 v[216:219], v5 offset:6144
    ds_read_b128 v[220:223], v5 offset:7168
    s_waitcnt lgkmcnt(3)
    v_lshlrev_b32 v224, 16, v208
    v_and_b32 v228, 0xffff0000, v208
    v_lshlrev_b32 v225, 16, v209
    v_and_b32 v229, 0xffff0000, v209
    v_lshlrev_b32 v226, 16, v210
    v_and_b32 v230, 0xffff0000, v210
    v_lshlrev_b32 v227, 16, v211
    v_and_b32 v231, 0xffff0000, v211
    v_pk_mul_f32 v[240:241], v[80:81], v[224:225]
    v_pk_mul_f32 v[242:243], v[80:81], v[228:229]
    v_pk_mul_f32 v[244:245], v[82:83], v[226:227]
    v_pk_mul_f32 v[246:247], v[82:83], v[230:231]
    v_pk_fma_f32 v[240:241], v[112:113], v[228:229], v[240:241] neg_lo:[1,0,0] neg_hi:[1,0,0]
    v_pk_fma_f32 v[242:243], v[112:113], v[224:225], v[242:243]
    v_pk_fma_f32 v[244:245], v[114:115], v[230:231], v[244:245] neg_lo:[1,0,0] neg_hi:[1,0,0]
    v_pk_fma_f32 v[246:247], v[114:115], v[226:227], v[246:247]
    v_cvt_pk_bf16_f32 v136, v240, v241
    v_cvt_pk_bf16_f32 v152, v242, v243
    v_cvt_pk_bf16_f32 v137, v244, v245
    v_cvt_pk_bf16_f32 v153, v246, v247
    s_waitcnt lgkmcnt(2)
    v_lshlrev_b32 v224, 16, v212
    v_and_b32 v228, 0xffff0000, v212
    v_lshlrev_b32 v225, 16, v213
    v_and_b32 v229, 0xffff0000, v213
    v_lshlrev_b32 v226, 16, v214
    v_and_b32 v230, 0xffff0000, v214
    v_lshlrev_b32 v227, 16, v215
    v_and_b32 v231, 0xffff0000, v215
    v_pk_mul_f32 v[240:241], v[84:85], v[224:225]
    v_pk_mul_f32 v[242:243], v[84:85], v[228:229]
    v_pk_mul_f32 v[244:245], v[86:87], v[226:227]
    v_pk_mul_f32 v[246:247], v[86:87], v[230:231]
    v_pk_fma_f32 v[240:241], v[116:117], v[228:229], v[240:241] neg_lo:[1,0,0] neg_hi:[1,0,0]
    v_pk_fma_f32 v[242:243], v[116:117], v[224:225], v[242:243]
    v_pk_fma_f32 v[244:245], v[118:119], v[230:231], v[244:245] neg_lo:[1,0,0] neg_hi:[1,0,0]
    v_pk_fma_f32 v[246:247], v[118:119], v[226:227], v[246:247]
    v_cvt_pk_bf16_f32 v138, v240, v241
    v_cvt_pk_bf16_f32 v154, v242, v243
    v_cvt_pk_bf16_f32 v139, v244, v245
    v_cvt_pk_bf16_f32 v155, v246, v247
    s_waitcnt lgkmcnt(1)
    v_lshlrev_b32 v224, 16, v216
    v_and_b32 v228, 0xffff0000, v216
    v_lshlrev_b32 v225, 16, v217
    v_and_b32 v229, 0xffff0000, v217
    v_lshlrev_b32 v226, 16, v218
    v_and_b32 v230, 0xffff0000, v218
    v_lshlrev_b32 v227, 16, v219
    v_and_b32 v231, 0xffff0000, v219
    v_pk_mul_f32 v[240:241], v[88:89], v[224:225]
    v_pk_mul_f32 v[242:243], v[88:89], v[228:229]
    v_pk_mul_f32 v[244:245], v[90:91], v[226:227]
    v_pk_mul_f32 v[246:247], v[90:91], v[230:231]
    v_pk_fma_f32 v[240:241], v[120:121], v[228:229], v[240:241] neg_lo:[1,0,0] neg_hi:[1,0,0]
    v_pk_fma_f32 v[242:243], v[120:121], v[224:225], v[242:243]
    v_pk_fma_f32 v[244:245], v[122:123], v[230:231], v[244:245] neg_lo:[1,0,0] neg_hi:[1,0,0]
    v_pk_fma_f32 v[246:247], v[122:123], v[226:227], v[246:247]
    v_cvt_pk_bf16_f32 v140, v240, v241
    v_cvt_pk_bf16_f32 v156, v242, v243
    v_cvt_pk_bf16_f32 v141, v244, v245
    v_cvt_pk_bf16_f32 v157, v246, v247
    s_waitcnt lgkmcnt(0)
    v_lshlrev_b32 v224, 16, v220
    v_and_b32 v228, 0xffff0000, v220
    v_lshlrev_b32 v225, 16, v221
    v_and_b32 v229, 0xffff0000, v221
    v_lshlrev_b32 v226, 16, v222
    v_and_b32 v230, 0xffff0000, v222
    v_lshlrev_b32 v227, 16, v223
    v_and_b32 v231, 0xffff0000, v223
    v_pk_mul_f32 v[240:241], v[92:93], v[224:225]
    v_pk_mul_f32 v[242:243], v[92:93], v[228:229]
    v_pk_mul_f32 v[244:245], v[94:95], v[226:227]
    v_pk_mul_f32 v[246:247], v[94:95], v[230:231]
    v_pk_fma_f32 v[240:241], v[124:125], v[228:229], v[240:241] neg_lo:[1,0,0] neg_hi:[1,0,0]
    v_pk_fma_f32 v[242:243], v[124:125], v[224:225], v[242:243]
    v_pk_fma_f32 v[244:245], v[126:127], v[230:231], v[244:245] neg_lo:[1,0,0] neg_hi:[1,0,0]
    v_pk_fma_f32 v[246:247], v[126:127], v[226:227], v[246:247]
    v_cvt_pk_bf16_f32 v142, v240, v241
    v_cvt_pk_bf16_f32 v158, v242, v243
    v_cvt_pk_bf16_f32 v143, v244, v245
    v_cvt_pk_bf16_f32 v159, v246, v247
    s_nop 1
    ds_read_b128 v[160:163], v4 offset:6144
    ds_read_b128 v[164:167], v4 offset:7168
    ds_read_b128 v[168:171], v4 offset:8192
    ds_read_b128 v[172:175], v4 offset:9216
    ds_read_b128 v[176:179], v4 offset:10240
    ds_read_b128 v[180:183], v4 offset:11264
    ds_read_b128 v[184:187], v4 offset:12288
    ds_read_b128 v[188:191], v4 offset:13312
    ds_read_b128 v[192:195], v4 offset:14336
    s_waitcnt lgkmcnt(6)
    v_mfma_f32_32x32x16_bf16 v[64:79], v[128:131], v[160:163], 0
    v_mfma_f32_32x32x16_bf16 v[96:111], v[128:131], v[168:171], 0
    v_mfma_f32_32x32x16_bf16 v[64:79], v[144:147], v[164:167], v[64:79]
    v_mfma_f32_32x32x16_bf16 v[96:111], v[144:147], v[160:163], v[96:111]
    ds_read_b128 v[196:199], v4 offset:15360
    ds_read_b128 v[200:203], v4 offset:16384
    ds_read_b128 v[204:207], v4 offset:17408
    s_waitcnt lgkmcnt(6)
    v_mfma_f32_32x32x16_bf16 v[64:79], v[132:135], v[172:175], v[64:79]
    v_mfma_f32_32x32x16_bf16 v[96:111], v[132:135], v[180:183], v[96:111]
    v_mfma_f32_32x32x16_bf16 v[64:79], v[148:151], v[176:179], v[64:79]
    v_mfma_f32_32x32x16_bf16 v[96:111], v[148:151], v[172:175], v[96:111]
    ds_read_b128 v[160:163], v4 offset:18432
    ds_read_b128 v[164:167], v4 offset:19456
    ds_read_b128 v[168:171], v4 offset:20480
    s_waitcnt lgkmcnt(6)
    v_mfma_f32_32x32x16_bf16 v[64:79], v[136:139], v[184:187], v[64:79]
    v_mfma_f32_32x32x16_bf16 v[96:111], v[136:139], v[192:195], v[96:111]
    v_mfma_f32_32x32x16_bf16 v[64:79], v[152:155], v[188:191], v[64:79]
    v_mfma_f32_32x32x16_bf16 v[96:111], v[152:155], v[184:187], v[96:111]
    ds_read_b128 v[172:175], v4 offset:21504
    ds_read_b128 v[176:179], v4 offset:22528
    ds_read_b128 v[180:183], v4 offset:23552
    s_waitcnt lgkmcnt(6)
    v_mfma_f32_32x32x16_bf16 v[64:79], v[140:143], v[196:199], v[64:79]
    v_mfma_f32_32x32x16_bf16 v[96:111], v[140:143], v[204:207], v[96:111]
    v_mfma_f32_32x32x16_bf16 v[64:79], v[156:159], v[200:203], v[64:79]
    v_mfma_f32_32x32x16_bf16 v[96:111], v[156:159], v[196:199], v[96:111]
    ds_read_b128 v[184:187], v4 offset:24576
    ds_read_b128 v[188:191], v4 offset:25600
    ds_read_b128 v[192:195], v4 offset:26624
    s_waitcnt lgkmcnt(6)
    v_mfma_f32_32x32x16_bf16 v[80:95], v[128:131], v[160:163], 0
    v_mfma_f32_32x32x16_bf16 v[112:127], v[128:131], v[168:171], 0
    v_mfma_f32_32x32x16_bf16 v[80:95], v[144:147], v[164:167], v[80:95]
    v_mfma_f32_32x32x16_bf16 v[112:127], v[144:147], v[160:163], v[112:127]
    ds_read_b128 v[196:199], v4 offset:27648
    ds_read_b128 v[200:203], v4 offset:28672
    ds_read_b128 v[204:207], v4 offset:29696
    s_waitcnt lgkmcnt(6)
    v_mfma_f32_32x32x16_bf16 v[80:95], v[132:135], v[172:175], v[80:95]
    v_mfma_f32_32x32x16_bf16 v[112:127], v[132:135], v[180:183], v[112:127]
    v_mfma_f32_32x32x16_bf16 v[80:95], v[148:151], v[176:179], v[80:95]
    v_mfma_f32_32x32x16_bf16 v[112:127], v[148:151], v[172:175], v[112:127]
    s_waitcnt lgkmcnt(3)
    v_mfma_f32_32x32x16_bf16 v[80:95], v[136:139], v[184:187], v[80:95]
    v_mfma_f32_32x32x16_bf16 v[112:127], v[136:139], v[192:195], v[112:127]
    v_mfma_f32_32x32x16_bf16 v[80:95], v[152:155], v[188:191], v[80:95]
    v_mfma_f32_32x32x16_bf16 v[112:127], v[152:155], v[184:187], v[112:127]
    s_waitcnt lgkmcnt(0)
    v_mfma_f32_32x32x16_bf16 v[80:95], v[140:143], v[196:199], v[80:95]
    v_mfma_f32_32x32x16_bf16 v[112:127], v[140:143], v[204:207], v[112:127]
    v_mfma_f32_32x32x16_bf16 v[80:95], v[156:159], v[200:203], v[80:95]
    v_mfma_f32_32x32x16_bf16 v[112:127], v[156:159], v[196:199], v[112:127]
    s_waitcnt vmcnt(0)
    ds_read_b128 v[160:163], v4 offset:0
    ds_read_b128 v[164:167], v4 offset:1024
    ds_read_b128 v[168:171], v4 offset:2048
    ds_read_b128 v[172:175], v4 offset:3072
    ds_read_b128 v[176:179], v4 offset:4096
    ds_read_b128 v[180:183], v4 offset:5120
    s_nop 7
    s_nop 3
    ds_read_b128 v[208:211], v4 offset:47104
    ds_read_b128 v[212:215], v4 offset:48128
    ds_read_b128 v[216:219], v4 offset:49152
    ds_read_b128 v[220:223], v4 offset:50176
    ds_read_b128 v[224:227], v4 offset:51200
    ds_read_b128 v[228:231], v4 offset:52224
    ds_read_b128 v[232:235], v4 offset:53248
    ds_read_b128 v[236:239], v4 offset:54272
    s_waitcnt lgkmcnt(6)
    v_pk_mul_f32 v[240:241], v[64:65], v[208:209]
    v_pk_mul_f32 v[242:243], v[64:65], v[212:213]
    v_pk_mul_f32 v[244:245], v[66:67], v[210:211]
    v_pk_mul_f32 v[246:247], v[66:67], v[214:215]
    v_pk_fma_f32 v[240:241], v[96:97], v[212:213], v[240:241] neg_lo:[1,0,0] neg_hi:[1,0,0]
    v_pk_fma_f32 v[242:243], v[96:97], v[208:209], v[242:243]
    v_pk_fma_f32 v[244:245], v[98:99], v[214:215], v[244:245] neg_lo:[1,0,0] neg_hi:[1,0,0]
    v_pk_fma_f32 v[246:247], v[98:99], v[210:211], v[246:247]
    v_cvt_pk_bf16_f32 v128, v240, v241
    v_cvt_pk_bf16_f32 v144, v242, v243
    v_cvt_pk_bf16_f32 v129, v244, v245
    v_cvt_pk_bf16_f32 v145, v246, v247
    s_waitcnt lgkmcnt(4)
    v_pk_mul_f32 v[240:241], v[68:69], v[216:217]
    v_pk_mul_f32 v[242:243], v[68:69], v[220:221]
    v_pk_mul_f32 v[244:245], v[70:71], v[218:219]
    v_pk_mul_f32 v[246:247], v[70:71], v[222:223]
    v_pk_fma_f32 v[240:241], v[100:101], v[220:221], v[240:241] neg_lo:[1,0,0] neg_hi:[1,0,0]
    v_pk_fma_f32 v[242:243], v[100:101], v[216:217], v[242:243]
    v_pk_fma_f32 v[244:245], v[102:103], v[222:223], v[244:245] neg_lo:[1,0,0] neg_hi:[1,0,0]
    v_pk_fma_f32 v[246:247], v[102:103], v[218:219], v[246:247]
    v_cvt_pk_bf16_f32 v130, v240, v241
    v_cvt_pk_bf16_f32 v146, v242, v243
    v_cvt_pk_bf16_f32 v131, v244, v245
    v_cvt_pk_bf16_f32 v147, v246, v247
    s_waitcnt lgkmcnt(2)
    v_pk_mul_f32 v[240:241], v[72:73], v[224:225]
    v_pk_mul_f32 v[242:243], v[72:73], v[228:229]
    v_pk_mul_f32 v[244:245], v[74:75], v[226:227]
    v_pk_mul_f32 v[246:247], v[74:75], v[230:231]
    v_pk_fma_f32 v[240:241], v[104:105], v[228:229], v[240:241] neg_lo:[1,0,0] neg_hi:[1,0,0]
    v_pk_fma_f32 v[242:243], v[104:105], v[224:225], v[242:243]
    v_pk_fma_f32 v[244:245], v[106:107], v[230:231], v[244:245] neg_lo:[1,0,0] neg_hi:[1,0,0]
    v_pk_fma_f32 v[246:247], v[106:107], v[226:227], v[246:247]
    v_cvt_pk_bf16_f32 v132, v240, v241
    v_cvt_pk_bf16_f32 v148, v242, v243
    v_cvt_pk_bf16_f32 v133, v244, v245
    v_cvt_pk_bf16_f32 v149, v246, v247
    s_waitcnt lgkmcnt(0)
    v_pk_mul_f32 v[240:241], v[76:77], v[232:233]
    v_pk_mul_f32 v[242:243], v[76:77], v[236:237]
    v_pk_mul_f32 v[244:245], v[78:79], v[234:235]
    v_pk_mul_f32 v[246:247], v[78:79], v[238:239]
    v_pk_fma_f32 v[240:241], v[108:109], v[236:237], v[240:241] neg_lo:[1,0,0] neg_hi:[1,0,0]
    v_pk_fma_f32 v[242:243], v[108:109], v[232:233], v[242:243]
    v_pk_fma_f32 v[244:245], v[110:111], v[238:239], v[244:245] neg_lo:[1,0,0] neg_hi:[1,0,0]
    v_pk_fma_f32 v[246:247], v[110:111], v[234:235], v[246:247]
    v_cvt_pk_bf16_f32 v134, v240, v241
    v_cvt_pk_bf16_f32 v150, v242, v243
    v_cvt_pk_bf16_f32 v135, v244, v245
    v_cvt_pk_bf16_f32 v151, v246, v247
    ds_read_b128 v[208:211], v4 offset:55296
    ds_read_b128 v[212:215], v4 offset:56320
    ds_read_b128 v[216:219], v4 offset:57344
    ds_read_b128 v[220:223], v4 offset:58368
    ds_read_b128 v[224:227], v4 offset:59392
    ds_read_b128 v[228:231], v4 offset:60416
    ds_read_b128 v[232:235], v4 offset:61440
    ds_read_b128 v[236:239], v4 offset:62464
    s_waitcnt lgkmcnt(6)
    v_pk_mul_f32 v[240:241], v[80:81], v[208:209]
    v_pk_mul_f32 v[242:243], v[80:81], v[212:213]
    v_pk_mul_f32 v[244:245], v[82:83], v[210:211]
    v_pk_mul_f32 v[246:247], v[82:83], v[214:215]
    v_pk_fma_f32 v[240:241], v[112:113], v[212:213], v[240:241] neg_lo:[1,0,0] neg_hi:[1,0,0]
    v_pk_fma_f32 v[242:243], v[112:113], v[208:209], v[242:243]
    v_pk_fma_f32 v[244:245], v[114:115], v[214:215], v[244:245] neg_lo:[1,0,0] neg_hi:[1,0,0]
    v_pk_fma_f32 v[246:247], v[114:115], v[210:211], v[246:247]
    v_cvt_pk_bf16_f32 v136, v240, v241
    v_cvt_pk_bf16_f32 v152, v242, v243
    v_cvt_pk_bf16_f32 v137, v244, v245
    v_cvt_pk_bf16_f32 v153, v246, v247
    s_waitcnt lgkmcnt(4)
    v_pk_mul_f32 v[240:241], v[84:85], v[216:217]
    v_pk_mul_f32 v[242:243], v[84:85], v[220:221]
    v_pk_mul_f32 v[244:245], v[86:87], v[218:219]
    v_pk_mul_f32 v[246:247], v[86:87], v[222:223]
    v_pk_fma_f32 v[240:241], v[116:117], v[220:221], v[240:241] neg_lo:[1,0,0] neg_hi:[1,0,0]
    v_pk_fma_f32 v[242:243], v[116:117], v[216:217], v[242:243]
    v_pk_fma_f32 v[244:245], v[118:119], v[222:223], v[244:245] neg_lo:[1,0,0] neg_hi:[1,0,0]
    v_pk_fma_f32 v[246:247], v[118:119], v[218:219], v[246:247]
    v_cvt_pk_bf16_f32 v138, v240, v241
    v_cvt_pk_bf16_f32 v154, v242, v243
    v_cvt_pk_bf16_f32 v139, v244, v245
    v_cvt_pk_bf16_f32 v155, v246, v247
    s_waitcnt lgkmcnt(2)
    v_pk_mul_f32 v[240:241], v[88:89], v[224:225]
    v_pk_mul_f32 v[242:243], v[88:89], v[228:229]
    v_pk_mul_f32 v[244:245], v[90:91], v[226:227]
    v_pk_mul_f32 v[246:247], v[90:91], v[230:231]
    v_pk_fma_f32 v[240:241], v[120:121], v[228:229], v[240:241] neg_lo:[1,0,0] neg_hi:[1,0,0]
    v_pk_fma_f32 v[242:243], v[120:121], v[224:225], v[242:243]
    v_pk_fma_f32 v[244:245], v[122:123], v[230:231], v[244:245] neg_lo:[1,0,0] neg_hi:[1,0,0]
    v_pk_fma_f32 v[246:247], v[122:123], v[226:227], v[246:247]
    v_cvt_pk_bf16_f32 v140, v240, v241
    v_cvt_pk_bf16_f32 v156, v242, v243
    v_cvt_pk_bf16_f32 v141, v244, v245
    v_cvt_pk_bf16_f32 v157, v246, v247
    s_waitcnt lgkmcnt(0)
    v_pk_mul_f32 v[240:241], v[92:93], v[232:233]
    v_pk_mul_f32 v[242:243], v[92:93], v[236:237]
    v_pk_mul_f32 v[244:245], v[94:95], v[234:235]
    v_pk_mul_f32 v[246:247], v[94:95], v[238:239]
    v_pk_fma_f32 v[240:241], v[124:125], v[236:237], v[240:241] neg_lo:[1,0,0] neg_hi:[1,0,0]
    v_pk_fma_f32 v[242:243], v[124:125], v[232:233], v[242:243]
    v_pk_fma_f32 v[244:245], v[126:127], v[238:239], v[244:245] neg_lo:[1,0,0] neg_hi:[1,0,0]
    v_pk_fma_f32 v[246:247], v[126:127], v[234:235], v[246:247]
    v_cvt_pk_bf16_f32 v142, v240, v241
    v_cvt_pk_bf16_f32 v158, v242, v243
    v_cvt_pk_bf16_f32 v143, v244, v245
    v_cvt_pk_bf16_f32 v159, v246, v247
    s_nop 1
    v_mfma_f32_32x32x16_bf16 v[64:79], v[128:131], v[160:163], 0
    v_mfma_f32_32x32x16_bf16 v[96:111], v[128:131], v[176:179], 0
    v_mfma_f32_32x32x16_bf16 v[64:79], v[132:135], v[164:167], v[64:79]
    v_mfma_f32_32x32x16_bf16 v[96:111], v[132:135], v[180:183], v[96:111]
    v_mfma_f32_32x32x16_bf16 v[64:79], v[144:147], v[168:171], v[64:79]
    v_mfma_f32_32x32x16_bf16 v[96:111], v[144:147], v[160:163], v[96:111]
    v_mfma_f32_32x32x16_bf16 v[64:79], v[148:151], v[172:175], v[64:79]
    v_mfma_f32_32x32x16_bf16 v[96:111], v[148:151], v[164:167], v[96:111]
    v_mfma_f32_32x32x16_bf16 v[80:95], v[136:139], v[160:163], 0
    v_mfma_f32_32x32x16_bf16 v[112:127], v[136:139], v[176:179], 0
    v_mfma_f32_32x32x16_bf16 v[80:95], v[140:143], v[164:167], v[80:95]
    v_mfma_f32_32x32x16_bf16 v[112:127], v[140:143], v[180:183], v[112:127]
    v_mfma_f32_32x32x16_bf16 v[80:95], v[152:155], v[168:171], v[80:95]
    v_mfma_f32_32x32x16_bf16 v[112:127], v[152:155], v[160:163], v[112:127]
    v_mfma_f32_32x32x16_bf16 v[80:95], v[156:159], v[172:175], v[80:95]
    v_mfma_f32_32x32x16_bf16 v[112:127], v[156:159], v[164:167], v[112:127]
    v_and_b32 v3, 31, v1
    v_lshrrev_b32 v6, 5, v1
    v_lshlrev_b32 v6, 4, v6
    v_lshl_add_u32 v6, v3, 7, v6
    s_add_u32 s22, s20, 15728640
    s_add_u32 s23, s21, 15728640
    s_nop 7
    s_nop 3
    v_cvt_pk_bf16_f32 v128, v64, v65
    v_cvt_pk_bf16_f32 v129, v66, v67
    v_cvt_pk_bf16_f32 v130, v68, v69
    v_cvt_pk_bf16_f32 v131, v70, v71
    v_cvt_pk_bf16_f32 v132, v72, v73
    v_cvt_pk_bf16_f32 v133, v74, v75
    v_cvt_pk_bf16_f32 v134, v76, v77
    v_cvt_pk_bf16_f32 v135, v78, v79
    s_nop 1
    v_permlane32_swap_b32 v128, v130
    v_permlane32_swap_b32 v129, v131
    v_permlane32_swap_b32 v132, v134
    v_permlane32_swap_b32 v133, v135
    buffer_store_dwordx4 v[128:131], v6, s[4:7], s22 offen offset:0
    buffer_store_dwordx4 v[132:135], v6, s[4:7], s22 offen offset:32
    v_cvt_pk_bf16_f32 v136, v80, v81
    v_cvt_pk_bf16_f32 v137, v82, v83
    v_cvt_pk_bf16_f32 v138, v84, v85
    v_cvt_pk_bf16_f32 v139, v86, v87
    v_cvt_pk_bf16_f32 v140, v88, v89
    v_cvt_pk_bf16_f32 v141, v90, v91
    v_cvt_pk_bf16_f32 v142, v92, v93
    v_cvt_pk_bf16_f32 v143, v94, v95
    s_nop 1
    v_permlane32_swap_b32 v136, v138
    v_permlane32_swap_b32 v137, v139
    v_permlane32_swap_b32 v140, v142
    v_permlane32_swap_b32 v141, v143
    buffer_store_dwordx4 v[136:139], v6, s[4:7], s22 offen offset:64
    buffer_store_dwordx4 v[140:143], v6, s[4:7], s22 offen offset:96
    v_cvt_pk_bf16_f32 v144, v96, v97
    v_cvt_pk_bf16_f32 v145, v98, v99
    v_cvt_pk_bf16_f32 v146, v100, v101
    v_cvt_pk_bf16_f32 v147, v102, v103
    v_cvt_pk_bf16_f32 v148, v104, v105
    v_cvt_pk_bf16_f32 v149, v106, v107
    v_cvt_pk_bf16_f32 v150, v108, v109
    v_cvt_pk_bf16_f32 v151, v110, v111
    s_nop 1
    v_permlane32_swap_b32 v144, v146
    v_permlane32_swap_b32 v145, v147
    v_permlane32_swap_b32 v148, v150
    v_permlane32_swap_b32 v149, v151
    buffer_store_dwordx4 v[144:147], v6, s[4:7], s23 offen offset:0
    buffer_store_dwordx4 v[148:151], v6, s[4:7], s23 offen offset:32
    v_cvt_pk_bf16_f32 v152, v112, v113
    v_cvt_pk_bf16_f32 v153, v114, v115
    v_cvt_pk_bf16_f32 v154, v116, v117
    v_cvt_pk_bf16_f32 v155, v118, v119
    v_cvt_pk_bf16_f32 v156, v120, v121
    v_cvt_pk_bf16_f32 v157, v122, v123
    v_cvt_pk_bf16_f32 v158, v124, v125
    v_cvt_pk_bf16_f32 v159, v126, v127
    s_nop 1
    v_permlane32_swap_b32 v152, v154
    v_permlane32_swap_b32 v153, v155
    v_permlane32_swap_b32 v156, v158
    v_permlane32_swap_b32 v157, v159
    buffer_store_dwordx4 v[152:155], v6, s[4:7], s23 offen offset:64
    buffer_store_dwordx4 v[156:159], v6, s[4:7], s23 offen offset:96
k2_w7b:
    s_cmp_eq_u32 s53, 1
    s_cbranch_scc1 k2_slow
    s_branch k2_red2
k2_slow:
    s_setprio 0
    s_waitcnt vmcnt(0)
    buffer_load_dwordx4 v[8:11], v2, s[4:7], s34 offen offset:0
    buffer_load_dwordx4 v[12:15], v2, s[4:7], s34 offen offset:1024
    buffer_load_dwordx4 v[16:19], v2, s[4:7], s34 offen offset:2048
    buffer_load_dwordx4 v[20:23], v2, s[4:7], s34 offen offset:3072
    s_lshl_b32 s36, s48, 4
    s_add_u32 s36, s36, s32
    s_lshl_b32 s36, s36, 11
    s_add_u32 s18, s36, 2097152
    s_add_u32 s19, s36, 4194304
    s_mov_b32 s17, 16
    v_mov_b32 v120, 0
    v_mov_b32 v121, 0
    v_mov_b32 v122, 0
    v_mov_b32 v123, 0
    v_mov_b32 v124, 0
    v_mov_b32 v125, 0
    v_mov_b32 v126, 0
    v_mov_b32 v127, 0
    v_mov_b32 v128, 0
    v_mov_b32 v129, 0
    v_mov_b32 v130, 0
    v_mov_b32 v131, 0
    v_mov_b32 v132, 0
    v_mov_b32 v133, 0
    v_mov_b32 v134, 0
    v_mov_b32 v135, 0
    v_mov_b32 v136, 0
    v_mov_b32 v137, 0
    v_mov_b32 v138, 0
    v_mov_b32 v139, 0
    v_mov_b32 v140, 0
    v_mov_b32 v141, 0
    v_mov_b32 v142, 0
    v_mov_b32 v143, 0
    v_mov_b32 v144, 0
    v_mov_b32 v145, 0
    v_mov_b32 v146, 0
    v_mov_b32 v147, 0
    v_mov_b32 v148, 0
    v_mov_b32 v149, 0
    v_mov_b32 v150, 0
    v_mov_b32 v151, 0
    v_mov_b32 v192, 0xff7fffff
    v_mov_b32 v193, 0xff7fffff
k2_sloop:
    buffer_load_dwordx4 v[40:43], v2, s[4:7], s18 offen
    buffer_load_dwordx4 v[44:47], v2, s[4:7], s18 offen offset:1024
    buffer_load_dwordx4 v[56:59], v2, s[4:7], s19 offen
    buffer_load_dwordx4 v[60:63], v2, s[4:7], s19 offen offset:1024
    s_waitcnt vmcnt(0)
    v_mfma_f32_32x32x16_bf16 v[72:87], v[40:43], v[8:11], 0
    v_mfma_f32_32x32x16_bf16 v[72:87], v[44:47], v[12:15], v[72:87]
    s_nop 7
    s_nop 7
    v_max3_f32 v194, v72, v73, v74
    v_max3_f32 v194, v194, v75, v76
    v_max3_f32 v194, v194, v77, v78
    v_max3_f32 v194, v194, v79, v80
    v_max3_f32 v194, v194, v81, v82
    v_max3_f32 v194, v194, v83, v84
    v_max3_f32 v194, v194, v85, v86
    v_max_f32 v194, v194, v87
    v_mov_b32 v195, v194
    s_nop 1
    v_permlane32_swap_b32 v194, v195
    v_max_f32 v194, v194, v195
    v_max_f32 v194, v194, v192
    v_sub_f32 v195, v192, v194
    v_exp_f32 v195, v195
    v_mov_b32 v192, v194
    v_mul_f32 v120, v120, v195
    v_mul_f32 v121, v121, v195
    v_mul_f32 v122, v122, v195
    v_mul_f32 v123, v123, v195
    v_mul_f32 v124, v124, v195
    v_mul_f32 v125, v125, v195
    v_mul_f32 v126, v126, v195
    v_mul_f32 v127, v127, v195
    v_mul_f32 v128, v128, v195
    v_mul_f32 v129, v129, v195
    v_mul_f32 v130, v130, v195
    v_mul_f32 v131, v131, v195
    v_mul_f32 v132, v132, v195
    v_mul_f32 v133, v133, v195
    v_mul_f32 v134, v134, v195
    v_mul_f32 v135, v135, v195
    v_sub_f32 v72, v72, v194
    v_sub_f32 v73, v73, v194
    v_sub_f32 v74, v74, v194
    v_sub_f32 v75, v75, v194
    v_sub_f32 v76, v76, v194
    v_sub_f32 v77, v77, v194
    v_sub_f32 v78, v78, v194
    v_sub_f32 v79, v79, v194
    v_sub_f32 v80, v80, v194
    v_sub_f32 v81, v81, v194
    v_sub_f32 v82, v82, v194
    v_sub_f32 v83, v83, v194
    v_sub_f32 v84, v84, v194
    v_sub_f32 v85, v85, v194
    v_sub_f32 v86, v86, v194
    v_sub_f32 v87, v87, v194
    v_exp_f32 v72, v72
    v_exp_f32 v73, v73
    v_exp_f32 v74, v74
    v_exp_f32 v75, v75
    v_cvt_pk_bf16_f32 v104, v72, v73
    v_cvt_pk_bf16_f32 v105, v74, v75
    v_exp_f32 v76, v76
    v_exp_f32 v77, v77
    v_exp_f32 v78, v78
    v_exp_f32 v79, v79
    v_cvt_pk_bf16_f32 v106, v76, v77
    v_cvt_pk_bf16_f32 v107, v78, v79
    v_exp_f32 v80, v80
    v_exp_f32 v81, v81
    v_exp_f32 v82, v82
    v_exp_f32 v83, v83
    v_cvt_pk_bf16_f32 v108, v80, v81
    v_cvt_pk_bf16_f32 v109, v82, v83
    v_exp_f32 v84, v84
    v_exp_f32 v85, v85
    v_exp_f32 v86, v86
    v_exp_f32 v87, v87
    v_cvt_pk_bf16_f32 v110, v84, v85
    v_cvt_pk_bf16_f32 v111, v86, v87
    s_nop 1
    v_mfma_f32_32x32x16_bf16 v[120:135], v[56:59], v[104:107], v[120:135]
    v_mfma_f32_32x32x16_bf16 v[120:135], v[60:63], v[108:111], v[120:135]
    v_mfma_f32_32x32x16_bf16 v[88:103], v[40:43], v[16:19], 0
    v_mfma_f32_32x32x16_bf16 v[88:103], v[44:47], v[20:23], v[88:103]
    s_nop 7
    s_nop 7
    v_max3_f32 v194, v88, v89, v90
    v_max3_f32 v194, v194, v91, v92
    v_max3_f32 v194, v194, v93, v94
    v_max3_f32 v194, v194, v95, v96
    v_max3_f32 v194, v194, v97, v98
    v_max3_f32 v194, v194, v99, v100
    v_max3_f32 v194, v194, v101, v102
    v_max_f32 v194, v194, v103
    v_mov_b32 v195, v194
    s_nop 1
    v_permlane32_swap_b32 v194, v195
    v_max_f32 v194, v194, v195
    v_max_f32 v194, v194, v193
    v_sub_f32 v195, v193, v194
    v_exp_f32 v195, v195
    v_mov_b32 v193, v194
    v_mul_f32 v136, v136, v195
    v_mul_f32 v137, v137, v195
    v_mul_f32 v138, v138, v195
    v_mul_f32 v139, v139, v195
    v_mul_f32 v140, v140, v195
    v_mul_f32 v141, v141, v195
    v_mul_f32 v142, v142, v195
    v_mul_f32 v143, v143, v195
    v_mul_f32 v144, v144, v195
    v_mul_f32 v145, v145, v195
    v_mul_f32 v146, v146, v195
    v_mul_f32 v147, v147, v195
    v_mul_f32 v148, v148, v195
    v_mul_f32 v149, v149, v195
    v_mul_f32 v150, v150, v195
    v_mul_f32 v151, v151, v195
    v_sub_f32 v88, v88, v194
    v_sub_f32 v89, v89, v194
    v_sub_f32 v90, v90, v194
    v_sub_f32 v91, v91, v194
    v_sub_f32 v92, v92, v194
    v_sub_f32 v93, v93, v194
    v_sub_f32 v94, v94, v194
    v_sub_f32 v95, v95, v194
    v_sub_f32 v96, v96, v194
    v_sub_f32 v97, v97, v194
    v_sub_f32 v98, v98, v194
    v_sub_f32 v99, v99, v194
    v_sub_f32 v100, v100, v194
    v_sub_f32 v101, v101, v194
    v_sub_f32 v102, v102, v194
    v_sub_f32 v103, v103, v194
    v_exp_f32 v88, v88
    v_exp_f32 v89, v89
    v_exp_f32 v90, v90
    v_exp_f32 v91, v91
    v_cvt_pk_bf16_f32 v112, v88, v89
    v_cvt_pk_bf16_f32 v113, v90, v91
    v_exp_f32 v92, v92
    v_exp_f32 v93, v93
    v_exp_f32 v94, v94
    v_exp_f32 v95, v95
    v_cvt_pk_bf16_f32 v114, v92, v93
    v_cvt_pk_bf16_f32 v115, v94, v95
    v_exp_f32 v96, v96
    v_exp_f32 v97, v97
    v_exp_f32 v98, v98
    v_exp_f32 v99, v99
    v_cvt_pk_bf16_f32 v116, v96, v97
    v_cvt_pk_bf16_f32 v117, v98, v99
    v_exp_f32 v100, v100
    v_exp_f32 v101, v101
    v_exp_f32 v102, v102
    v_exp_f32 v103, v103
    v_cvt_pk_bf16_f32 v118, v100, v101
    v_cvt_pk_bf16_f32 v119, v102, v103
    s_nop 1
    v_mfma_f32_32x32x16_bf16 v[136:151], v[56:59], v[112:115], v[136:151]
    v_mfma_f32_32x32x16_bf16 v[136:151], v[60:63], v[116:119], v[136:151]
    s_nop 7
    s_nop 7
    s_add_u32 s18, s18, 2048
    s_add_u32 s19, s19, 2048
    s_sub_u32 s17, s17, 1
    s_cmp_lg_u32 s17, 0
    s_cbranch_scc1 k2_sloop
    s_lshl_b32 s37, s26, 9
    s_add_u32 s37, s37, 137216
    v_lshlrev_b32 v194, 2, v1
    v_add_u32 v195, s37, v194
    ds_write_b32 v195, v192
    ds_write_b32 v195, v193 offset:256
    s_lshl_b32 s37, s49, 11
    s_add_u32 s37, s37, 137216
    v_add_u32 v195, s37, v194
    s_waitcnt lgkmcnt(0)
    s_barrier
    ds_read_b32 v196, v195 offset:0
    ds_read_b32 v197, v195 offset:512
    ds_read_b32 v198, v195 offset:1024
    ds_read_b32 v199, v195 offset:1536
    s_waitcnt lgkmcnt(0)
    v_max3_f32 v196, v196, v197, v198
    v_max_f32 v196, v196, v199
    v_sub_f32 v196, v192, v196
    v_exp_f32 v196, v196
    s_nop 0
    v_mul_f32 v120, v120, v196
    v_mul_f32 v121, v121, v196
    v_mul_f32 v122, v122, v196
    v_mul_f32 v123, v123, v196
    v_mul_f32 v124, v124, v196
    v_mul_f32 v125, v125, v196
    v_mul_f32 v126, v126, v196
    v_mul_f32 v127, v127, v196
    v_mul_f32 v128, v128, v196
    v_mul_f32 v129, v129, v196
    v_mul_f32 v130, v130, v196
    v_mul_f32 v131, v131, v196
    v_mul_f32 v132, v132, v196
    v_mul_f32 v133, v133, v196
    v_mul_f32 v134, v134, v196
    v_mul_f32 v135, v135, v196
    ds_read_b32 v196, v195 offset:256
    ds_read_b32 v197, v195 offset:768
    ds_read_b32 v198, v195 offset:1280
    ds_read_b32 v199, v195 offset:1792
    s_waitcnt lgkmcnt(0)
    v_max3_f32 v196, v196, v197, v198
    v_max_f32 v196, v196, v199
    v_sub_f32 v196, v193, v196
    v_exp_f32 v196, v196
    s_nop 0
    v_mul_f32 v136, v136, v196
    v_mul_f32 v137, v137, v196
    v_mul_f32 v138, v138, v196
    v_mul_f32 v139, v139, v196
    v_mul_f32 v140, v140, v196
    v_mul_f32 v141, v141, v196
    v_mul_f32 v142, v142, v196
    v_mul_f32 v143, v143, v196
    v_mul_f32 v144, v144, v196
    v_mul_f32 v145, v145, v196
    v_mul_f32 v146, v146, v196
    v_mul_f32 v147, v147, v196
    v_mul_f32 v148, v148, v196
    v_mul_f32 v149, v149, v196
    v_mul_f32 v150, v150, v196
    v_mul_f32 v151, v151, v196
    s_branch k2_red
k2_endcode:

.text
.globl k3_kernel
.p2align 8
.type k3_kernel,@function
k3_kernel:
    s_cmp_ge_u32 s2, 256
    s_cbranch_scc1 k3_end
    s_load_dwordx2 s[4:5], s[0:1], 16
    s_load_dwordx2 s[6:7], s[0:1], 48
    s_load_dwordx2 s[8:9], s[0:1], 64
    s_getpc_b64 s[10:11]
    s_add_u32 s10, s10, TG@rel32@lo+4
    s_addc_u32 s11, s11, TG@rel32@hi+12
    s_and_b32 s40, s2, 7
    s_lshr_b32 s41, s2, 3
    s_lshr_b32 s16, s40, 2
    s_and_b32 s17, s40, 3
    v_lshrrev_b32 v4, 6, v0
    v_and_b32 v1, 63, v0
    v_readfirstlane_b32 s19, v4
    v_and_b32 v2, 31, v1
    v_lshrrev_b32 v3, 5, v1
    v_lshrrev_b32 v6, 3, v1
    v_and_b32 v7, 7, v1
    v_bfe_u32 v8, v1, 4, 1
    v_lshlrev_b32 v8, 2, v8
    v_xor_b32 v7, v7, v8
    v_and_b32 v9, 15, v1
    v_lshrrev_b32 v9, 2, v9
    v_and_b32 v10, 3, v1
    v_bfe_u32 v11, v1, 4, 1
    v_lshlrev_b32 v11, 5, v11
    v_lshl_add_u32 v10, v10, 3, v11
    v_bfe_u32 v11, v9, 1, 1
    v_lshlrev_b32 v11, 2, v11
    v_lshlrev_b32 v4, 4, v1
    s_lshl_b32 s55, s19, 10
    s_cmp_eq_u32 s16, 1
    s_cbranch_scc1 k3_b3
    s_lshl_b32 s20, s17, 2
    s_and_b32 s21, s41, 3
    s_add_u32 s20, s20, s21
    s_lshr_b32 s21, s41, 2
    s_cmp_eq_u32 s21, 7
    s_cbranch_scc1 k3_end
    s_lshl_b32 s22, s20, 2
    s_add_u32 s22, s22, s19
    s_lshl_b32 s46, s22, 15
    s_add_u32 s46, s46, 13631488
    s_movk_i32 s47, 896
    v_mul_lo_u32 v5, v6, s47
    v_lshl_add_u32 v5, v7, 4, v5
    s_mul_i32 s53, s19, 8*896
    v_mov_b32 v8, 0
    v_lshlrev_b32 v12, 2, v0
    ds_write_b32 v12, v8 offset:57344
    v_lshl_add_u32 v12, v3, 2, v9
    v_lshlrev_b32 v12, 7, v12
    v_add_u32 v13, 0, v10
    v_lshrrev_b32 v20, 4, v13
    v_xor_b32 v20, v20, v11
    v_and_b32 v13, 15, v13
    v_lshl_add_u32 v20, v20, 4, v13
    v_add_u32 v14, v20, v12
    v_add_u32 v13, 64, v10
    v_lshrrev_b32 v20, 4, v13
    v_xor_b32 v20, v20, v11
    v_and_b32 v13, 15, v13
    v_lshl_add_u32 v20, v20, 4, v13
    v_add_u32 v15, v20, v12
    s_mul_i32 s22, s19, 4608
    s_add_u32 s22, s22, 58368
    v_mov_b32 v21, 8192
    v_add_u32 v22, 0, v1
    v_mul_u32_u24 v23, v22, v21
    v_lshrrev_b32 v23, 16, v23
    v_mul_u32_u24 v24, 8, v23
    v_sub_u32 v24, v22, v24
    v_mul_u32_u24 v25, 144, v23
    v_lshl_add_u32 v25, v24, 4, v25
    v_add_u32 v192, s22, v25
    v_mul_u32_u24 v25, 0x700, v23
    v_lshl_add_u32 v196, v24, 4, v25
    v_add_u32 v22, 64, v1
    v_mul_u32_u24 v23, v22, v21
    v_lshrrev_b32 v23, 16, v23
    v_mul_u32_u24 v24, 8, v23
    v_sub_u32 v24, v22, v24
    v_mul_u32_u24 v25, 144, v23
    v_lshl_add_u32 v25, v24, 4, v25
    v_add_u32 v193, s22, v25
    v_mul_u32_u24 v25, 0x700, v23
    v_lshl_add_u32 v197, v24, 4, v25
    v_add_u32 v22, 128, v1
    v_mul_u32_u24 v23, v22, v21
    v_lshrrev_b32 v23, 16, v23
    v_mul_u32_u24 v24, 8, v23
    v_sub_u32 v24, v22, v24
    v_mul_u32_u24 v25, 144, v23
    v_lshl_add_u32 v25, v24, 4, v25
    v_add_u32 v194, s22, v25
    v_mul_u32_u24 v25, 0x700, v23
    v_lshl_add_u32 v198, v24, 4, v25
    v_add_u32 v22, 192, v1
    v_mul_u32_u24 v23, v22, v21
    v_lshrrev_b32 v23, 16, v23
    v_mul_u32_u24 v24, 8, v23
    v_sub_u32 v24, v22, v24
    v_mul_u32_u24 v25, 144, v23
    v_lshl_add_u32 v25, v24, 4, v25
    v_add_u32 v195, s22, v25
    v_mul_u32_u24 v25, 0x700, v23
    v_lshl_add_u32 v199, v24, 4, v25
    s_waitcnt lgkmcnt(0)
    s_getpc_b64 s[56:57]
k3a_pcS:
    s_sub_u32 s56, s56, k3a_pcS-k3_kernel
    s_subb_u32 s57, s57, 0
    s_lshr_b32 s58, s2, 3
    s_and_b32 s58, s58, 31
    s_mul_i32 s58, s58, 4
    s_add_u32 s58, s58, s19
    s_mul_i32 s58, s58, 64
    s_min_u32 s58, s58, k3_end-k3_kernel-64
    s_add_u32 s56, s56, s58
    s_addc_u32 s57, s57, 0
    s_load_dwordx16 s[80:95], s[56:57], 0
    s_mov_b32 s28, s8
    s_and_b32 s29, s9, 0xffff
    s_mov_b32 s30, 17825792
    s_mov_b32 s31, 0x20000
    s_lshl_b32 s22, s21, 7
    s_add_u32 s24, s4, s22
    s_addc_u32 s25, s5, 0
    s_sub_u32 s23, 401408, s22
    s_mov_b32 s24, s24
    s_and_b32 s25, s25, 0xffff
    s_mov_b32 s26, s23
    s_mov_b32 s27, 0x20000
    s_mov_b32 m0, s55
    s_nop 0
    buffer_load_dwordx4 v5, s[24:27], s53 offen lds
    s_add_u32 s53, s53, 28672
    s_add_u32 m0, m0, 4096
    buffer_load_dwordx4 v[16:19], v4, s[28:31], s46 offen offset:0
    buffer_load_dwordx4 v5, s[24:27], s53 offen lds
    s_add_u32 s53, s53, 28672
    s_add_u32 m0, m0, 4096
    buffer_load_dwordx4 v[20:23], v4, s[28:31], s46 offen offset:1024
    buffer_load_dwordx4 v[24:27], v4, s[28:31], s46 offen offset:2048
    buffer_load_dwordx4 v[28:31], v4, s[28:31], s46 offen offset:3072
    buffer_load_dwordx4 v5, s[24:27], s53 offen lds
    s_add_u32 s53, s53, 28672
    s_add_u32 m0, m0, 4096
    s_add_u32 s46, s46, 4096
    buffer_load_dwordx4 v[32:35], v4, s[28:31], s46 offen offset:0
    buffer_load_dwordx4 v5, s[24:27], s53 offen lds
    s_add_u32 s53, s53, 28672
    s_add_u32 m0, m0, 4096
    buffer_load_dwordx4 v[36:39], v4, s[28:31], s46 offen offset:1024
    buffer_load_dwordx4 v5, s[24:27], s53 offen lds
    s_add_u32 s53, s53, 28672
    s_add_u32 m0, m0, 4096
    buffer_load_dwordx4 v[40:43], v4, s[28:31], s46 offen offset:2048
    buffer_load_dwordx4 v5, s[24:27], s53 offen lds
    s_add_u32 s53, s53, 28672
    s_add_u32 m0, m0, 4096
    buffer_load_dwordx4 v[44:47], v4, s[28:31], s46 offen offset:3072
    s_waitcnt vmcnt(11)
    s_barrier
    ds_read_b64_tr_b16 v[176:177], v14 offset:0
    ds_read_b64_tr_b16 v[178:179], v14 offset:1024
    ds_read_b64_tr_b16 v[180:181], v15 offset:0
    ds_read_b64_tr_b16 v[182:183], v15 offset:1024
    ds_read_b64_tr_b16 v[184:185], v14 offset:2048
    ds_read_b64_tr_b16 v[186:187], v14 offset:3072
    s_add_u32 s46, s46, 4096
    buffer_load_dwordx4 v[48:51], v4, s[28:31], s46 offen offset:0
    buffer_load_dwordx4 v5, s[24:27], s53 offen lds
    s_add_u32 s53, s53, 28672
    s_add_u32 m0, m0, 4096
    s_waitcnt vmcnt(14)
    s_waitcnt lgkmcnt(4)
    v_mfma_f32_32x32x16_bf16 v[144:159], v[176:179], v[16:19], 0
    ds_read_b64_tr_b16 v[188:189], v15 offset:2048
    ds_read_b64_tr_b16 v[190:191], v15 offset:3072
    s_waitcnt lgkmcnt(4)
    v_mfma_f32_32x32x16_bf16 v[160:175], v[180:183], v[16:19], 0
    ds_read_b64_tr_b16 v[176:177], v14 offset:3584
    ds_read_b64_tr_b16 v[178:179], v14 offset:4608
    buffer_load_dwordx4 v[52:55], v4, s[28:31], s46 offen offset:1024
    buffer_load_dwordx4 v5, s[24:27], s53 offen lds
    s_add_u32 s53, s53, 28672
    s_add_u32 m0, m0, 4096
    s_waitcnt vmcnt(14)
    s_waitcnt lgkmcnt(4)
    v_mfma_f32_32x32x16_bf16 v[144:159], v[184:187], v[20:23], v[144:159]
    ds_read_b64_tr_b16 v[180:181], v15 offset:3584
    ds_read_b64_tr_b16 v[182:183], v15 offset:4608
    s_waitcnt lgkmcnt(4)
    v_mfma_f32_32x32x16_bf16 v[160:175], v[188:191], v[20:23], v[160:175]
    ds_read_b64_tr_b16 v[184:185], v14 offset:5632
    ds_read_b64_tr_b16 v[186:187], v14 offset:6656
    buffer_load_dwordx4 v[56:59], v4, s[28:31], s46 offen offset:2048
    buffer_load_dwordx4 v5, s[24:27], s53 offen lds
    s_add_u32 s53, s53, 28672
    s_add_u32 m0, m0, 4096
    s_waitcnt vmcnt(15)
    s_waitcnt lgkmcnt(4)
    v_mfma_f32_32x32x16_bf16 v[144:159], v[176:179], v[24:27], v[144:159]
    ds_read_b64_tr_b16 v[188:189], v15 offset:5632
    ds_read_b64_tr_b16 v[190:191], v15 offset:6656
    s_waitcnt lgkmcnt(4)
    v_mfma_f32_32x32x16_bf16 v[160:175], v[180:183], v[24:27], v[160:175]
    s_waitcnt vmcnt(7)
    s_barrier
    ds_read_b64_tr_b16 v[176:177], v14 offset:7168
    ds_read_b64_tr_b16 v[178:179], v14 offset:8192
    buffer_load_dwordx4 v[60:63], v4, s[28:31], s46 offen offset:3072
    buffer_load_dwordx4 v5, s[24:27], s53 offen lds
    s_add_u32 s53, s53, 28672
    s_add_u32 m0, m0, 4096
    s_waitcnt vmcnt(16)
    s_waitcnt lgkmcnt(4)
    v_mfma_f32_32x32x16_bf16 v[144:159], v[184:187], v[28:31], v[144:159]
    ds_read_b64_tr_b16 v[180:181], v15 offset:7168
    ds_read_b64_tr_b16 v[182:183], v15 offset:8192
    s_waitcnt lgkmcnt(4)
    v_mfma_f32_32x32x16_bf16 v[160:175], v[188:191], v[28:31], v[160:175]
    ds_read_b64_tr_b16 v[184:185], v14 offset:9216
    ds_read_b64_tr_b16 v[186:187], v14 offset:10240
    s_add_u32 s46, s46, 4096
    buffer_load_dwordx4 v[64:67], v4, s[28:31], s46 offen offset:0
    buffer_load_dwordx4 v5, s[24:27], s53 offen lds
    s_add_u32 s53, s53, 28672
    s_add_u32 m0, m0, 4096
    s_waitcnt vmcnt(16)
    s_waitcnt lgkmcnt(4)
    v_mfma_f32_32x32x16_bf16 v[144:159], v[176:179], v[32:35], v[144:159]
    ds_read_b64_tr_b16 v[188:189], v15 offset:9216
    ds_read_b64_tr_b16 v[190:191], v15 offset:10240
    s_waitcnt lgkmcnt(4)
    v_mfma_f32_32x32x16_bf16 v[160:175], v[180:183], v[32:35], v[160:175]
    ds_read_b64_tr_b16 v[176:177], v14 offset:10752
    ds_read_b64_tr_b16 v[178:179], v14 offset:11776
    buffer_load_dwordx4 v[68:71], v4, s[28:31], s46 offen offset:1024
    buffer_load_dwordx4 v5, s[24:27], s53 offen lds
    s_add_u32 s53, s53, 28672
    s_add_u32 m0, m0, 4096
    s_waitcnt vmcnt(16)
    s_waitcnt lgkmcnt(4)
    v_mfma_f32_32x32x16_bf16 v[144:159], v[184:187], v[36:39], v[144:159]
    ds_read_b64_tr_b16 v[180:181], v15 offset:10752
    ds_read_b64_tr_b16 v[182:183], v15 offset:11776
    s_waitcnt lgkmcnt(4)
    v_mfma_f32_32x32x16_bf16 v[160:175], v[188:191], v[36:39], v[160:175]
    ds_read_b64_tr_b16 v[184:185], v14 offset:12800
    ds_read_b64_tr_b16 v[186:187], v14 offset:13824
    buffer_load_dwordx4 v[72:75], v4, s[28:31], s46 offen offset:2048
    buffer_load_dwordx4 v5, s[24:27], s53 offen lds
    s_add_u32 s53, s53, 28672
    s_add_u32 m0, m0, 4096
    s_waitcnt vmcnt(16)
    s_waitcnt lgkmcnt(4)
    v_mfma_f32_32x32x16_bf16 v[144:159], v[176:179], v[40:43], v[144:159]
    ds_read_b64_tr_b16 v[188:189], v15 offset:12800
    ds_read_b64_tr_b16 v[190:191], v15 offset:13824
    s_waitcnt lgkmcnt(4)
    v_mfma_f32_32x32x16_bf16 v[160:175], v[180:183], v[40:43], v[160:175]
    ds_read_b64_tr_b16 v[176:177], v14 offset:14336
    ds_read_b64_tr_b16 v[178:179], v14 offset:15360
    buffer_load_dwordx4 v[76:79], v4, s[28:31], s46 offen offset:3072
    buffer_load_dwordx4 v5, s[24:27], s53 offen lds
    s_waitcnt vmcnt(16)
    s_waitcnt lgkmcnt(4)
    v_mfma_f32_32x32x16_bf16 v[144:159], v[184:187], v[44:47], v[144:159]
    ds_read_b64_tr_b16 v[180:181], v15 offset:14336
    ds_read_b64_tr_b16 v[182:183], v15 offset:15360
    s_waitcnt lgkmcnt(4)
    v_mfma_f32_32x32x16_bf16 v[160:175], v[188:191], v[44:47], v[160:175]
    ds_read_b64_tr_b16 v[184:185], v14 offset:16384
    ds_read_b64_tr_b16 v[186:187], v14 offset:17408
    s_add_u32 s46, s46, 4096
    buffer_load_dwordx4 v[80:83], v4, s[28:31], s46 offen offset:0
    s_waitcnt vmcnt(16)
    s_waitcnt lgkmcnt(4)
    v_mfma_f32_32x32x16_bf16 v[144:159], v[176:179], v[48:51], v[144:159]
    ds_read_b64_tr_b16 v[188:189], v15 offset:16384
    ds_read_b64_tr_b16 v[190:191], v15 offset:17408
    s_waitcnt lgkmcnt(4)
    v_mfma_f32_32x32x16_bf16 v[160:175], v[180:183], v[48:51], v[160:175]
    ds_read_b64_tr_b16 v[176:177], v14 offset:17920
    ds_read_b64_tr_b16 v[178:179], v14 offset:18944
    buffer_load_dwordx4 v[84:87], v4, s[28:31], s46 offen offset:1024
    s_waitcnt vmcnt(15)
    s_waitcnt lgkmcnt(4)
    v_mfma_f32_32x32x16_bf16 v[144:159], v[184:187], v[52:55], v[144:159]
    ds_read_b64_tr_b16 v[180:181], v15 offset:17920
    ds_read_b64_tr_b16 v[182:183], v15 offset:18944
    s_waitcnt lgkmcnt(4)
    v_mfma_f32_32x32x16_bf16 v[160:175], v[188:191], v[52:55], v[160:175]
    ds_read_b64_tr_b16 v[184:185], v14 offset:19968
    ds_read_b64_tr_b16 v[186:187], v14 offset:20992
    buffer_load_dwordx4 v[88:91], v4, s[28:31], s46 offen offset:2048
    s_waitcnt vmcnt(14)
    s_waitcnt lgkmcnt(4)
    v_mfma_f32_32x32x16_bf16 v[144:159], v[176:179], v[56:59], v[144:159]
    ds_read_b64_tr_b16 v[188:189], v15 offset:19968
    ds_read_b64_tr_b16 v[190:191], v15 offset:20992
    s_waitcnt lgkmcnt(4)
    v_mfma_f32_32x32x16_bf16 v[160:175], v[180:183], v[56:59], v[160:175]
    ds_read_b64_tr_b16 v[176:177], v14 offset:21504
    ds_read_b64_tr_b16 v[178:179], v14 offset:22528
    buffer_load_dwordx4 v[92:95], v4, s[28:31], s46 offen offset:3072
    s_waitcnt vmcnt(13)
    s_waitcnt lgkmcnt(4)
    v_mfma_f32_32x32x16_bf16 v[144:159], v[184:187], v[60:63], v[144:159]
    ds_read_b64_tr_b16 v[180:181], v15 offset:21504
    ds_read_b64_tr_b16 v[182:183], v15 offset:22528
    s_waitcnt lgkmcnt(4)
    v_mfma_f32_32x32x16_bf16 v[160:175], v[188:191], v[60:63], v[160:175]
    s_waitcnt vmcnt(12)
    s_barrier
    ds_read_b64_tr_b16 v[184:185], v14 offset:23552
    ds_read_b64_tr_b16 v[186:187], v14 offset:24576
    s_add_u32 s46, s46, 4096
    buffer_load_dwordx4 v[96:99], v4, s[28:31], s46 offen offset:0
    s_waitcnt vmcnt(12)
    s_waitcnt lgkmcnt(4)
    v_mfma_f32_32x32x16_bf16 v[144:159], v[176:179], v[64:67], v[144:159]
    ds_read_b64_tr_b16 v[188:189], v15 offset:23552
    ds_read_b64_tr_b16 v[190:191], v15 offset:24576
    s_waitcnt lgkmcnt(4)
    v_mfma_f32_32x32x16_bf16 v[160:175], v[180:183], v[64:67], v[160:175]
    ds_read_b64_tr_b16 v[176:177], v14 offset:25088
    ds_read_b64_tr_b16 v[178:179], v14 offset:26112
    buffer_load_dwordx4 v[100:103], v4, s[28:31], s46 offen offset:1024
    s_waitcnt vmcnt(11)
    s_waitcnt lgkmcnt(4)
    v_mfma_f32_32x32x16_bf16 v[144:159], v[184:187], v[68:71], v[144:159]
    ds_read_b64_tr_b16 v[180:181], v15 offset:25088
    ds_read_b64_tr_b16 v[182:183], v15 offset:26112
    s_waitcnt lgkmcnt(4)
    v_mfma_f32_32x32x16_bf16 v[160:175], v[188:191], v[68:71], v[160:175]
    ds_read_b64_tr_b16 v[184:185], v14 offset:27136
    ds_read_b64_tr_b16 v[186:187], v14 offset:28160
    buffer_load_dwordx4 v[104:107], v4, s[28:31], s46 offen offset:2048
    s_waitcnt vmcnt(10)
    s_waitcnt lgkmcnt(4)
    v_mfma_f32_32x32x16_bf16 v[144:159], v[176:179], v[72:75], v[144:159]
    ds_read_b64_tr_b16 v[188:189], v15 offset:27136
    ds_read_b64_tr_b16 v[190:191], v15 offset:28160
    s_waitcnt lgkmcnt(4)
    v_mfma_f32_32x32x16_bf16 v[160:175], v[180:183], v[72:75], v[160:175]
    ds_read_b64_tr_b16 v[176:177], v14 offset:28672
    ds_read_b64_tr_b16 v[178:179], v14 offset:29696
    buffer_load_dwordx4 v[108:111], v4, s[28:31], s46 offen offset:3072
    s_waitcnt vmcnt(9)
    s_waitcnt lgkmcnt(4)
    v_mfma_f32_32x32x16_bf16 v[144:159], v[184:187], v[76:79], v[144:159]
    ds_read_b64_tr_b16 v[180:181], v15 offset:28672
    ds_read_b64_tr_b16 v[182:183], v15 offset:29696
    s_waitcnt lgkmcnt(4)
    v_mfma_f32_32x32x16_bf16 v[160:175], v[188:191], v[76:79], v[160:175]
    ds_read_b64_tr_b16 v[184:185], v14 offset:30720
    ds_read_b64_tr_b16 v[186:187], v14 offset:31744
    s_add_u32 s46, s46, 4096
    buffer_load_dwordx4 v[112:115], v4, s[28:31], s46 offen offset:0
    s_waitcnt vmcnt(8)
    s_waitcnt lgkmcnt(4)
    v_mfma_f32_32x32x16_bf16 v[144:159], v[176:179], v[80:83], v[144:159]
    ds_read_b64_tr_b16 v[188:189], v15 offset:30720
    ds_read_b64_tr_b16 v[190:191], v15 offset:31744
    s_waitcnt lgkmcnt(4)
    v_mfma_f32_32x32x16_bf16 v[160:175], v[180:183], v[80:83], v[160:175]
    ds_read_b64_tr_b16 v[176:177], v14 offset:32256
    ds_read_b64_tr_b16 v[178:179], v14 offset:33280
    buffer_load_dwordx4 v[116:119], v4, s[28:31], s46 offen offset:1024
    s_waitcnt vmcnt(8)
    s_waitcnt lgkmcnt(4)
    v_mfma_f32_32x32x16_bf16 v[144:159], v[184:187], v[84:87], v[144:159]
    ds_read_b64_tr_b16 v[180:181], v15 offset:32256
    ds_read_b64_tr_b16 v[182:183], v15 offset:33280
    s_waitcnt lgkmcnt(4)
    v_mfma_f32_32x32x16_bf16 v[160:175], v[188:191], v[84:87], v[160:175]
    ds_read_b64_tr_b16 v[184:185], v14 offset:34304
    ds_read_b64_tr_b16 v[186:187], v14 offset:35328
    buffer_load_dwordx4 v[120:123], v4, s[28:31], s46 offen offset:2048
    s_waitcnt vmcnt(8)
    s_waitcnt lgkmcnt(4)
    v_mfma_f32_32x32x16_bf16 v[144:159], v[176:179], v[88:91], v[144:159]
    ds_read_b64_tr_b16 v[188:189], v15 offset:34304
    ds_read_b64_tr_b16 v[190:191], v15 offset:35328
    s_waitcnt lgkmcnt(4)
    v_mfma_f32_32x32x16_bf16 v[160:175], v[180:183], v[88:91], v[160:175]
    ds_read_b64_tr_b16 v[176:177], v14 offset:35840
    ds_read_b64_tr_b16 v[178:179], v14 offset:36864
    buffer_load_dwordx4 v[124:127], v4, s[28:31], s46 offen offset:3072
    s_waitcnt vmcnt(8)
    s_waitcnt lgkmcnt(4)
    v_mfma_f32_32x32x16_bf16 v[144:159], v[184:187], v[92:95], v[144:159]
    ds_read_b64_tr_b16 v[180:181], v15 offset:35840
    ds_read_b64_tr_b16 v[182:183], v15 offset:36864
    s_waitcnt lgkmcnt(4)
    v_mfma_f32_32x32x16_bf16 v[160:175], v[188:191], v[92:95], v[160:175]
    ds_read_b64_tr_b16 v[184:185], v14 offset:37888
    ds_read_b64_tr_b16 v[186:187], v14 offset:38912
    s_add_u32 s46, s46, 4096
    buffer_load_dwordx4 v[128:131], v4, s[28:31], s46 offen offset:0
    s_waitcnt vmcnt(8)
    s_waitcnt lgkmcnt(4)
    v_mfma_f32_32x32x16_bf16 v[144:159], v[176:179], v[96:99], v[144:159]
    ds_read_b64_tr_b16 v[188:189], v15 offset:37888
    ds_read_b64_tr_b16 v[190:191], v15 offset:38912
    s_waitcnt lgkmcnt(4)
    v_mfma_f32_32x32x16_bf16 v[160:175], v[180:183], v[96:99], v[160:175]
    s_waitcnt vmcnt(13)
    s_barrier
    ds_read_b64_tr_b16 v[176:177], v14 offset:39424
    ds_read_b64_tr_b16 v[178:179], v14 offset:40448
    buffer_load_dwordx4 v[132:135], v4, s[28:31], s46 offen offset:1024
    s_waitcnt vmcnt(8)
    s_waitcnt lgkmcnt(4)
    v_mfma_f32_32x32x16_bf16 v[144:159], v[184:187], v[100:103], v[144:159]
    ds_read_b64_tr_b16 v[180:181], v15 offset:39424
    ds_read_b64_tr_b16 v[182:183], v15 offset:40448
    s_waitcnt lgkmcnt(4)
    v_mfma_f32_32x32x16_bf16 v[160:175], v[188:191], v[100:103], v[160:175]
    ds_read_b64_tr_b16 v[184:185], v14 offset:41472
    ds_read_b64_tr_b16 v[186:187], v14 offset:42496
    buffer_load_dwordx4 v[136:139], v4, s[28:31], s46 offen offset:2048
    s_waitcnt vmcnt(8)
    s_waitcnt lgkmcnt(4)
    v_mfma_f32_32x32x16_bf16 v[144:159], v[176:179], v[104:107], v[144:159]
    ds_read_b64_tr_b16 v[188:189], v15 offset:41472
    ds_read_b64_tr_b16 v[190:191], v15 offset:42496
    s_waitcnt lgkmcnt(4)
    v_mfma_f32_32x32x16_bf16 v[160:175], v[180:183], v[104:107], v[160:175]
    ds_read_b64_tr_b16 v[176:177], v14 offset:43008
    ds_read_b64_tr_b16 v[178:179], v14 offset:44032
    buffer_load_dwordx4 v[140:143], v4, s[28:31], s46 offen offset:3072
    s_waitcnt vmcnt(8)
    s_waitcnt lgkmcnt(4)
    v_mfma_f32_32x32x16_bf16 v[144:159], v[184:187], v[108:111], v[144:159]
    ds_read_b64_tr_b16 v[180:181], v15 offset:43008
    ds_read_b64_tr_b16 v[182:183], v15 offset:44032
    s_waitcnt lgkmcnt(4)
    v_mfma_f32_32x32x16_bf16 v[160:175], v[188:191], v[108:111], v[160:175]
    ds_read_b64_tr_b16 v[184:185], v14 offset:45056
    ds_read_b64_tr_b16 v[186:187], v14 offset:46080
    s_waitcnt vmcnt(7)
    s_waitcnt lgkmcnt(4)
    v_mfma_f32_32x32x16_bf16 v[144:159], v[176:179], v[112:115], v[144:159]
    ds_read_b64_tr_b16 v[188:189], v15 offset:45056
    ds_read_b64_tr_b16 v[190:191], v15 offset:46080
    s_waitcnt lgkmcnt(4)
    v_mfma_f32_32x32x16_bf16 v[160:175], v[180:183], v[112:115], v[160:175]
    ds_read_b64_tr_b16 v[176:177], v14 offset:46592
    ds_read_b64_tr_b16 v[178:179], v14 offset:47616
    s_waitcnt vmcnt(6)
    s_waitcnt lgkmcnt(4)
    v_mfma_f32_32x32x16_bf16 v[144:159], v[184:187], v[116:119], v[144:159]
    ds_read_b64_tr_b16 v[180:181], v15 offset:46592
    ds_read_b64_tr_b16 v[182:183], v15 offset:47616
    s_waitcnt lgkmcnt(4)
    v_mfma_f32_32x32x16_bf16 v[160:175], v[188:191], v[116:119], v[160:175]
    ds_read_b64_tr_b16 v[184:185], v14 offset:48640
    ds_read_b64_tr_b16 v[186:187], v14 offset:49664
    s_waitcnt vmcnt(5)
    s_waitcnt lgkmcnt(4)
    v_mfma_f32_32x32x16_bf16 v[144:159], v[176:179], v[120:123], v[144:159]
    ds_read_b64_tr_b16 v[188:189], v15 offset:48640
    ds_read_b64_tr_b16 v[190:191], v15 offset:49664
    s_waitcnt lgkmcnt(4)
    v_mfma_f32_32x32x16_bf16 v[160:175], v[180:183], v[120:123], v[160:175]
    ds_read_b64_tr_b16 v[176:177], v14 offset:50176
    ds_read_b64_tr_b16 v[178:179], v14 offset:51200
    s_waitcnt vmcnt(4)
    s_waitcnt lgkmcnt(4)
    v_mfma_f32_32x32x16_bf16 v[144:159], v[184:187], v[124:127], v[144:159]
    ds_read_b64_tr_b16 v[180:181], v15 offset:50176
    ds_read_b64_tr_b16 v[182:183], v15 offset:51200
    s_waitcnt lgkmcnt(4)
    v_mfma_f32_32x32x16_bf16 v[160:175], v[188:191], v[124:127], v[160:175]
    ds_read_b64_tr_b16 v[184:185], v14 offset:52224
    ds_read_b64_tr_b16 v[186:187], v14 offset:53248
    s_waitcnt vmcnt(3)
    s_waitcnt lgkmcnt(4)
    v_mfma_f32_32x32x16_bf16 v[144:159], v[176:179], v[128:131], v[144:159]
    ds_read_b64_tr_b16 v[188:189], v15 offset:52224
    ds_read_b64_tr_b16 v[190:191], v15 offset:53248
    s_waitcnt lgkmcnt(4)
    v_mfma_f32_32x32x16_bf16 v[160:175], v[180:183], v[128:131], v[160:175]
    ds_read_b64_tr_b16 v[176:177], v14 offset:53760
    ds_read_b64_tr_b16 v[178:179], v14 offset:54784
    s_waitcnt vmcnt(2)
    s_waitcnt lgkmcnt(4)
    v_mfma_f32_32x32x16_bf16 v[144:159], v[184:187], v[132:135], v[144:159]
    ds_read_b64_tr_b16 v[180:181], v15 offset:53760
    ds_read_b64_tr_b16 v[182:183], v15 offset:54784
    s_waitcnt lgkmcnt(4)
    v_mfma_f32_32x32x16_bf16 v[160:175], v[188:191], v[132:135], v[160:175]
    ds_read_b64_tr_b16 v[184:185], v14 offset:55808
    ds_read_b64_tr_b16 v[186:187], v14 offset:56832
    s_waitcnt vmcnt(1)
    s_waitcnt lgkmcnt(4)
    v_mfma_f32_32x32x16_bf16 v[144:159], v[176:179], v[136:139], v[144:159]
    ds_read_b64_tr_b16 v[188:189], v15 offset:55808
    ds_read_b64_tr_b16 v[190:191], v15 offset:56832
    s_waitcnt lgkmcnt(4)
    v_mfma_f32_32x32x16_bf16 v[160:175], v[180:183], v[136:139], v[160:175]
    s_waitcnt vmcnt(0)
    s_waitcnt lgkmcnt(2)
    v_mfma_f32_32x32x16_bf16 v[144:159], v[184:187], v[140:143], v[144:159]
    s_waitcnt lgkmcnt(0)
    v_mfma_f32_32x32x16_bf16 v[160:175], v[188:191], v[140:143], v[160:175]
    s_mov_b32 s32, s6
    s_and_b32 s33, s7, 0xffff
    s_mov_b32 s34, 3670016
    s_mov_b32 s35, 0x20000
    s_mul_i32 s22, s19, 4608
    s_add_u32 s22, s22, 58368
    v_mul_u32_u24 v5, 144, v2
    v_lshl_add_u32 v5, v3, 3, v5
    v_add_u32 v5, s22, v5
    s_nop 4
    v_cvt_pk_bf16_f32 v16, v144, v145
    v_cvt_pk_bf16_f32 v17, v146, v147
    v_cvt_pk_bf16_f32 v18, v148, v149
    v_cvt_pk_bf16_f32 v19, v150, v151
    v_cvt_pk_bf16_f32 v20, v152, v153
    v_cvt_pk_bf16_f32 v21, v154, v155
    v_cvt_pk_bf16_f32 v22, v156, v157
    v_cvt_pk_bf16_f32 v23, v158, v159
    v_cvt_pk_bf16_f32 v24, v160, v161
    v_cvt_pk_bf16_f32 v25, v162, v163
    v_cvt_pk_bf16_f32 v26, v164, v165
    v_cvt_pk_bf16_f32 v27, v166, v167
    v_cvt_pk_bf16_f32 v28, v168, v169
    v_cvt_pk_bf16_f32 v29, v170, v171
    v_cvt_pk_bf16_f32 v30, v172, v173
    v_cvt_pk_bf16_f32 v31, v174, v175
    ds_write_b64 v5, v[16:17] offset:0
    ds_write_b64 v5, v[18:19] offset:16
    ds_write_b64 v5, v[20:21] offset:32
    ds_write_b64 v5, v[22:23] offset:48
    ds_write_b64 v5, v[24:25] offset:64
    ds_write_b64 v5, v[26:27] offset:80
    ds_write_b64 v5, v[28:29] offset:96
    ds_write_b64 v5, v[30:31] offset:112
    s_lshl_b32 s23, s20, 7
    s_lshl_b32 s24, s19, 5
    s_add_u32 s23, s23, s24
    s_mul_i32 s45, s23, 1792
    s_lshl_b32 s23, s21, 7
    s_add_u32 s45, s45, s23
    s_waitcnt lgkmcnt(0)
    ds_read_b128 v[48:51], v192
    ds_read_b128 v[52:55], v193
    ds_read_b128 v[56:59], v194
    ds_read_b128 v[60:63], v195
    s_waitcnt lgkmcnt(3)
    buffer_store_dwordx4 v[48:51], v196, s[32:35], s45 offen
    s_waitcnt lgkmcnt(2)
    buffer_store_dwordx4 v[52:55], v197, s[32:35], s45 offen
    s_waitcnt lgkmcnt(1)
    buffer_store_dwordx4 v[56:59], v198, s[32:35], s45 offen
    s_waitcnt lgkmcnt(0)
    buffer_store_dwordx4 v[60:63], v199, s[32:35], s45 offen
    s_endpgm
k3_b3:
    s_lshl_b32 s20, s17, 3
    s_and_b32 s21, s41, 7
    s_add_u32 s20, s20, s21
    s_lshr_b32 s21, s41, 3
    s_lshl_b32 s22, s21, 2
    s_add_u32 s22, s22, s19
    s_mul_i32 s46, s22, 28*1024
    v_mul_u32_u24 v5, 4224, v6
    v_lshl_add_u32 v5, v7, 4, v5
    s_mul_i32 s53, s19, 33792
    v_lshl_add_u32 v12, v3, 3, v9
    v_lshlrev_b32 v12, 7, v12
    v_add_u32 v13, 0, v10
    v_lshrrev_b32 v20, 4, v13
    v_xor_b32 v20, v20, v11
    v_and_b32 v13, 15, v13
    v_lshl_add_u32 v20, v20, 4, v13
    v_add_u32 v14, v20, v12
    v_add_u32 v13, 64, v10
    v_lshrrev_b32 v20, 4, v13
    v_xor_b32 v20, v20, v11
    v_and_b32 v13, 15, v13
    v_lshl_add_u32 v20, v20, 4, v13
    v_add_u32 v15, v20, v12
    s_mul_i32 s22, s19, 4352
    s_add_u32 s22, s22, 58368
    v_mov_b32 v21, 4682
    v_add_u32 v22, 0, v1
    v_mul_u32_u24 v23, v22, v21
    v_lshrrev_b32 v23, 16, v23
    v_mul_u32_u24 v24, 14, v23
    v_sub_u32 v24, v22, v24
    v_mul_u32_u24 v25, 272, v23
    v_lshl_add_u32 v25, v24, 4, v25
    v_add_u32 v192, s22, v25
    v_mul_u32_u24 v25, 0x700, v23
    v_lshl_add_u32 v196, v24, 4, v25
    v_add_u32 v22, 64, v1
    v_mul_u32_u24 v23, v22, v21
    v_lshrrev_b32 v23, 16, v23
    v_mul_u32_u24 v24, 14, v23
    v_sub_u32 v24, v22, v24
    v_mul_u32_u24 v25, 272, v23
    v_lshl_add_u32 v25, v24, 4, v25
    v_add_u32 v193, s22, v25
    v_mul_u32_u24 v25, 0x700, v23
    v_lshl_add_u32 v197, v24, 4, v25
    v_add_u32 v22, 128, v1
    v_mul_u32_u24 v23, v22, v21
    v_lshrrev_b32 v23, 16, v23
    v_mul_u32_u24 v24, 14, v23
    v_sub_u32 v24, v22, v24
    v_mul_u32_u24 v25, 272, v23
    v_lshl_add_u32 v25, v24, 4, v25
    v_add_u32 v194, s22, v25
    v_mul_u32_u24 v25, 0x700, v23
    v_lshl_add_u32 v198, v24, 4, v25
    v_add_u32 v22, 192, v1
    v_mul_u32_u24 v23, v22, v21
    v_lshrrev_b32 v23, 16, v23
    v_mul_u32_u24 v24, 14, v23
    v_sub_u32 v24, v22, v24
    v_mul_u32_u24 v25, 272, v23
    v_lshl_add_u32 v25, v24, 4, v25
    v_add_u32 v195, s22, v25
    v_mul_u32_u24 v25, 0x700, v23
    v_lshl_add_u32 v199, v24, 4, v25
    v_mov_b32 v22, 0x40000000
    v_cmp_gt_u32 vcc, 32, v1
    s_nop 1
    v_cndmask_b32 v199, v22, v199, vcc
    s_waitcnt lgkmcnt(0)
    s_getpc_b64 s[56:57]
k3b_pcS:
    s_sub_u32 s56, s56, k3b_pcS-k3_kernel
    s_subb_u32 s57, s57, 0
    s_lshr_b32 s58, s2, 3
    s_and_b32 s58, s58, 31
    s_mul_i32 s58, s58, 4
    s_add_u32 s58, s58, s19
    s_mul_i32 s58, s58, 64
    s_min_u32 s58, s58, k3_end-k3_kernel-64
    s_add_u32 s56, s56, s58
    s_addc_u32 s57, s57, 0
    s_load_dwordx16 s[80:95], s[56:57], 0
    s_lshl_b32 s22, s20, 7
    s_add_u32 s22, s22, 15728640
    s_add_u32 s24, s8, s22
    s_addc_u32 s25, s9, 0
    s_sub_u32 s23, 17825792, s22
    s_mov_b32 s24, s24
    s_and_b32 s25, s25, 0xffff
    s_mov_b32 s26, s23
    s_mov_b32 s27, 0x20000
    s_mov_b32 s36, s10
    s_and_b32 s37, s11, 0xffff
    s_mov_b32 s38, 458752
    s_mov_b32 s39, 0x20000
    s_mov_b32 m0, s55
    s_nop 0
    buffer_load_dwordx4 v5, s[24:27], s53 offen lds
    s_add_u32 s53, s53, 135168
    s_add_u32 m0, m0, 4096
    buffer_load_dwordx4 v[16:19], v4, s[36:39], s46 offen offset:0
    buffer_load_dwordx4 v5, s[24:27], s53 offen lds
    s_add_u32 s53, s53, 135168
    s_add_u32 m0, m0, 4096
    buffer_load_dwordx4 v[20:23], v4, s[36:39], s46 offen offset:1024
    buffer_load_dwordx4 v[24:27], v4, s[36:39], s46 offen offset:2048
    buffer_load_dwordx4 v[28:31], v4, s[36:39], s46 offen offset:3072
    buffer_load_dwordx4 v5, s[24:27], s53 offen lds
    s_add_u32 s53, s53, 135168
    s_add_u32 m0, m0, 4096
    s_add_u32 s46, s46, 4096
    buffer_load_dwordx4 v[32:35], v4, s[36:39], s46 offen offset:0
    buffer_load_dwordx4 v5, s[24:27], s53 offen lds
    s_add_u32 s53, s53, 135168
    s_add_u32 m0, m0, 4096
    buffer_load_dwordx4 v[36:39], v4, s[36:39], s46 offen offset:1024
    buffer_load_dwordx4 v5, s[24:27], s53 offen lds
    s_add_u32 s53, s53, 135168
    s_add_u32 m0, m0, 4096
    buffer_load_dwordx4 v[40:43], v4, s[36:39], s46 offen offset:2048
    buffer_load_dwordx4 v5, s[24:27], s53 offen lds
    s_add_u32 s53, s53, 135168
    s_add_u32 m0, m0, 4096
    buffer_load_dwordx4 v[44:47], v4, s[36:39], s46 offen offset:3072
    s_waitcnt vmcnt(11)
    s_barrier
    ds_read_b64_tr_b16 v[176:177], v14 offset:0
    ds_read_b64_tr_b16 v[178:179], v14 offset:512
    ds_read_b64_tr_b16 v[180:181], v15 offset:0
    ds_read_b64_tr_b16 v[182:183], v15 offset:512
    ds_read_b64_tr_b16 v[184:185], v14 offset:2048
    ds_read_b64_tr_b16 v[186:187], v14 offset:2560
    s_add_u32 s46, s46, 4096
    buffer_load_dwordx4 v[48:51], v4, s[36:39], s46 offen offset:0
    buffer_load_dwordx4 v5, s[24:27], s53 offen lds
    s_add_u32 s53, s53, 135168
    s_add_u32 m0, m0, 4096
    s_waitcnt vmcnt(14)
    s_waitcnt lgkmcnt(4)
    v_mfma_f32_32x32x16_bf16 v[144:159], v[16:19], v[176:179], 0
    ds_read_b64_tr_b16 v[188:189], v15 offset:2048
    ds_read_b64_tr_b16 v[190:191], v15 offset:2560
    s_waitcnt lgkmcnt(4)
    v_mfma_f32_32x32x16_bf16 v[160:175], v[16:19], v[180:183], 0
    ds_read_b64_tr_b16 v[176:177], v14 offset:4096
    ds_read_b64_tr_b16 v[178:179], v14 offset:4608
    buffer_load_dwordx4 v[52:55], v4, s[36:39], s46 offen offset:1024
    buffer_load_dwordx4 v5, s[24:27], s53 offen lds
    s_add_u32 s53, s53, 135168
    s_add_u32 m0, m0, 4096
    s_waitcnt vmcnt(14)
    s_waitcnt lgkmcnt(4)
    v_mfma_f32_32x32x16_bf16 v[144:159], v[20:23], v[184:187], v[144:159]
    ds_read_b64_tr_b16 v[180:181], v15 offset:4096
    ds_read_b64_tr_b16 v[182:183], v15 offset:4608
    s_waitcnt lgkmcnt(4)
    v_mfma_f32_32x32x16_bf16 v[160:175], v[20:23], v[188:191], v[160:175]
    ds_read_b64_tr_b16 v[184:185], v14 offset:6144
    ds_read_b64_tr_b16 v[186:187], v14 offset:6656
    buffer_load_dwordx4 v[56:59], v4, s[36:39], s46 offen offset:2048
    buffer_load_dwordx4 v5, s[24:27], s53 offen lds
    s_add_u32 s53, s53, 135168
    s_add_u32 m0, m0, 4096
    s_waitcnt vmcnt(15)
    s_waitcnt lgkmcnt(4)
    v_mfma_f32_32x32x16_bf16 v[144:159], v[24:27], v[176:179], v[144:159]
    ds_read_b64_tr_b16 v[188:189], v15 offset:6144
    ds_read_b64_tr_b16 v[190:191], v15 offset:6656
    s_waitcnt lgkmcnt(4)
    v_mfma_f32_32x32x16_bf16 v[160:175], v[24:27], v[180:183], v[160:175]
    s_waitcnt vmcnt(7)
    s_barrier
    ds_read_b64_tr_b16 v[176:177], v14 offset:8192
    ds_read_b64_tr_b16 v[178:179], v14 offset:8704
    buffer_load_dwordx4 v[60:63], v4, s[36:39], s46 offen offset:3072
    buffer_load_dwordx4 v5, s[24:27], s53 offen lds
    s_add_u32 s53, s53, 135168
    s_add_u32 m0, m0, 4096
    s_waitcnt vmcnt(16)
    s_waitcnt lgkmcnt(4)
    v_mfma_f32_32x32x16_bf16 v[144:159], v[28:31], v[184:187], v[144:159]
    ds_read_b64_tr_b16 v[180:181], v15 offset:8192
    ds_read_b64_tr_b16 v[182:183], v15 offset:8704
    s_waitcnt lgkmcnt(4)
    v_mfma_f32_32x32x16_bf16 v[160:175], v[28:31], v[188:191], v[160:175]
    ds_read_b64_tr_b16 v[184:185], v14 offset:10240
    ds_read_b64_tr_b16 v[186:187], v14 offset:10752
    s_add_u32 s46, s46, 4096
    buffer_load_dwordx4 v[64:67], v4, s[36:39], s46 offen offset:0
    buffer_load_dwordx4 v5, s[24:27], s53 offen lds
    s_add_u32 s53, s53, 135168
    s_add_u32 m0, m0, 4096
    s_waitcnt vmcnt(16)
    s_waitcnt lgkmcnt(4)
    v_mfma_f32_32x32x16_bf16 v[144:159], v[32:35], v[176:179], v[144:159]
    ds_read_b64_tr_b16 v[188:189], v15 offset:10240
    ds_read_b64_tr_b16 v[190:191], v15 offset:10752
    s_waitcnt lgkmcnt(4)
    v_mfma_f32_32x32x16_bf16 v[160:175], v[32:35], v[180:183], v[160:175]
    ds_read_b64_tr_b16 v[176:177], v14 offset:12288
    ds_read_b64_tr_b16 v[178:179], v14 offset:12800
    buffer_load_dwordx4 v[68:71], v4, s[36:39], s46 offen offset:1024
    buffer_load_dwordx4 v5, s[24:27], s53 offen lds
    s_add_u32 s53, s53, 135168
    s_add_u32 m0, m0, 4096
    s_waitcnt vmcnt(16)
    s_waitcnt lgkmcnt(4)
    v_mfma_f32_32x32x16_bf16 v[144:159], v[36:39], v[184:187], v[144:159]
    ds_read_b64_tr_b16 v[180:181], v15 offset:12288
    ds_read_b64_tr_b16 v[182:183], v15 offset:12800
    s_waitcnt lgkmcnt(4)
    v_mfma_f32_32x32x16_bf16 v[160:175], v[36:39], v[188:191], v[160:175]
    ds_read_b64_tr_b16 v[184:185], v14 offset:14336
    ds_read_b64_tr_b16 v[186:187], v14 offset:14848
    buffer_load_dwordx4 v[72:75], v4, s[36:39], s46 offen offset:2048
    buffer_load_dwordx4 v5, s[24:27], s53 offen lds
    s_add_u32 s53, s53, 135168
    s_add_u32 m0, m0, 4096
    s_waitcnt vmcnt(16)
    s_waitcnt lgkmcnt(4)
    v_mfma_f32_32x32x16_bf16 v[144:159], v[40:43], v[176:179], v[144:159]
    ds_read_b64_tr_b16 v[188:189], v15 offset:14336
    ds_read_b64_tr_b16 v[190:191], v15 offset:14848
    s_waitcnt lgkmcnt(4)
    v_mfma_f32_32x32x16_bf16 v[160:175], v[40:43], v[180:183], v[160:175]
    ds_read_b64_tr_b16 v[176:177], v14 offset:16384
    ds_read_b64_tr_b16 v[178:179], v14 offset:16896
    buffer_load_dwordx4 v[76:79], v4, s[36:39], s46 offen offset:3072
    buffer_load_dwordx4 v5, s[24:27], s53 offen lds
    s_waitcnt vmcnt(16)
    s_waitcnt lgkmcnt(4)
    v_mfma_f32_32x32x16_bf16 v[144:159], v[44:47], v[184:187], v[144:159]
    ds_read_b64_tr_b16 v[180:181], v15 offset:16384
    ds_read_b64_tr_b16 v[182:183], v15 offset:16896
    s_waitcnt lgkmcnt(4)
    v_mfma_f32_32x32x16_bf16 v[160:175], v[44:47], v[188:191], v[160:175]
    ds_read_b64_tr_b16 v[184:185], v14 offset:18432
    ds_read_b64_tr_b16 v[186:187], v14 offset:18944
    s_add_u32 s46, s46, 4096
    buffer_load_dwordx4 v[80:83], v4, s[36:39], s46 offen offset:0
    s_waitcnt vmcnt(16)
    s_waitcnt lgkmcnt(4)
    v_mfma_f32_32x32x16_bf16 v[144:159], v[48:51], v[176:179], v[144:159]
    ds_read_b64_tr_b16 v[188:189], v15 offset:18432
    ds_read_b64_tr_b16 v[190:191], v15 offset:18944
    s_waitcnt lgkmcnt(4)
    v_mfma_f32_32x32x16_bf16 v[160:175], v[48:51], v[180:183], v[160:175]
    ds_read_b64_tr_b16 v[176:177], v14 offset:20480
    ds_read_b64_tr_b16 v[178:179], v14 offset:20992
    buffer_load_dwordx4 v[84:87], v4, s[36:39], s46 offen offset:1024
    s_waitcnt vmcnt(15)
    s_waitcnt lgkmcnt(4)
    v_mfma_f32_32x32x16_bf16 v[144:159], v[52:55], v[184:187], v[144:159]
    ds_read_b64_tr_b16 v[180:181], v15 offset:20480
    ds_read_b64_tr_b16 v[182:183], v15 offset:20992
    s_waitcnt lgkmcnt(4)
    v_mfma_f32_32x32x16_bf16 v[160:175], v[52:55], v[188:191], v[160:175]
    ds_read_b64_tr_b16 v[184:185], v14 offset:22528
    ds_read_b64_tr_b16 v[186:187], v14 offset:23040
    buffer_load_dwordx4 v[88:91], v4, s[36:39], s46 offen offset:2048
    s_waitcnt vmcnt(14)
    s_waitcnt lgkmcnt(4)
    v_mfma_f32_32x32x16_bf16 v[144:159], v[56:59], v[176:179], v[144:159]
    ds_read_b64_tr_b16 v[188:189], v15 offset:22528
    ds_read_b64_tr_b16 v[190:191], v15 offset:23040
    s_waitcnt lgkmcnt(4)
    v_mfma_f32_32x32x16_bf16 v[160:175], v[56:59], v[180:183], v[160:175]
    s_waitcnt vmcnt(11)
    s_barrier
    ds_read_b64_tr_b16 v[176:177], v14 offset:24576
    ds_read_b64_tr_b16 v[178:179], v14 offset:25088
    buffer_load_dwordx4 v[92:95], v4, s[36:39], s46 offen offset:3072
    s_waitcnt vmcnt(13)
    s_waitcnt lgkmcnt(4)
    v_mfma_f32_32x32x16_bf16 v[144:159], v[60:63], v[184:187], v[144:159]
    ds_read_b64_tr_b16 v[180:181], v15 offset:24576
    ds_read_b64_tr_b16 v[182:183], v15 offset:25088
    s_waitcnt lgkmcnt(4)
    v_mfma_f32_32x32x16_bf16 v[160:175], v[60:63], v[188:191], v[160:175]
    ds_read_b64_tr_b16 v[184:185], v14 offset:26624
    ds_read_b64_tr_b16 v[186:187], v14 offset:27136
    s_add_u32 s46, s46, 4096
    buffer_load_dwordx4 v[96:99], v4, s[36:39], s46 offen offset:0
    s_waitcnt vmcnt(12)
    s_waitcnt lgkmcnt(4)
    v_mfma_f32_32x32x16_bf16 v[144:159], v[64:67], v[176:179], v[144:159]
    ds_read_b64_tr_b16 v[188:189], v15 offset:26624
    ds_read_b64_tr_b16 v[190:191], v15 offset:27136
    s_waitcnt lgkmcnt(4)
    v_mfma_f32_32x32x16_bf16 v[160:175], v[64:67], v[180:183], v[160:175]
    ds_read_b64_tr_b16 v[176:177], v14 offset:28672
    ds_read_b64_tr_b16 v[178:179], v14 offset:29184
    buffer_load_dwordx4 v[100:103], v4, s[36:39], s46 offen offset:1024
    s_waitcnt vmcnt(11)
    s_waitcnt lgkmcnt(4)
    v_mfma_f32_32x32x16_bf16 v[144:159], v[68:71], v[184:187], v[144:159]
    ds_read_b64_tr_b16 v[180:181], v15 offset:28672
    ds_read_b64_tr_b16 v[182:183], v15 offset:29184
    s_waitcnt lgkmcnt(4)
    v_mfma_f32_32x32x16_bf16 v[160:175], v[68:71], v[188:191], v[160:175]
    ds_read_b64_tr_b16 v[184:185], v14 offset:30720
    ds_read_b64_tr_b16 v[186:187], v14 offset:31232
    buffer_load_dwordx4 v[104:107], v4, s[36:39], s46 offen offset:2048
    s_waitcnt vmcnt(10)
    s_waitcnt lgkmcnt(4)
    v_mfma_f32_32x32x16_bf16 v[144:159], v[72:75], v[176:179], v[144:159]
    ds_read_b64_tr_b16 v[188:189], v15 offset:30720
    ds_read_b64_tr_b16 v[190:191], v15 offset:31232
    s_waitcnt lgkmcnt(4)
    v_mfma_f32_32x32x16_bf16 v[160:175], v[72:75], v[180:183], v[160:175]
    ds_read_b64_tr_b16 v[176:177], v14 offset:32768
    ds_read_b64_tr_b16 v[178:179], v14 offset:33280
    buffer_load_dwordx4 v[108:111], v4, s[36:39], s46 offen offset:3072
    s_waitcnt vmcnt(9)
    s_waitcnt lgkmcnt(4)
    v_mfma_f32_32x32x16_bf16 v[144:159], v[76:79], v[184:187], v[144:159]
    ds_read_b64_tr_b16 v[180:181], v15 offset:32768
    ds_read_b64_tr_b16 v[182:183], v15 offset:33280
    s_waitcnt lgkmcnt(4)
    v_mfma_f32_32x32x16_bf16 v[160:175], v[76:79], v[188:191], v[160:175]
    ds_read_b64_tr_b16 v[184:185], v14 offset:34816
    ds_read_b64_tr_b16 v[186:187], v14 offset:35328
    s_add_u32 s46, s46, 4096
    buffer_load_dwordx4 v[112:115], v4, s[36:39], s46 offen offset:0
    s_waitcnt vmcnt(8)
    s_waitcnt lgkmcnt(4)
    v_mfma_f32_32x32x16_bf16 v[144:159], v[80:83], v[176:179], v[144:159]
    ds_read_b64_tr_b16 v[188:189], v15 offset:34816
    ds_read_b64_tr_b16 v[190:191], v15 offset:35328
    s_waitcnt lgkmcnt(4)
    v_mfma_f32_32x32x16_bf16 v[160:175], v[80:83], v[180:183], v[160:175]
    ds_read_b64_tr_b16 v[176:177], v14 offset:36864
    ds_read_b64_tr_b16 v[178:179], v14 offset:37376
    buffer_load_dwordx4 v[116:119], v4, s[36:39], s46 offen offset:1024
    s_waitcnt vmcnt(8)
    s_waitcnt lgkmcnt(4)
    v_mfma_f32_32x32x16_bf16 v[144:159], v[84:87], v[184:187], v[144:159]
    ds_read_b64_tr_b16 v[180:181], v15 offset:36864
    ds_read_b64_tr_b16 v[182:183], v15 offset:37376
    s_waitcnt lgkmcnt(4)
    v_mfma_f32_32x32x16_bf16 v[160:175], v[84:87], v[188:191], v[160:175]
    ds_read_b64_tr_b16 v[184:185], v14 offset:38912
    ds_read_b64_tr_b16 v[186:187], v14 offset:39424
    buffer_load_dwordx4 v[120:123], v4, s[36:39], s46 offen offset:2048
    s_waitcnt vmcnt(8)
    s_waitcnt lgkmcnt(4)
    v_mfma_f32_32x32x16_bf16 v[144:159], v[88:91], v[176:179], v[144:159]
    ds_read_b64_tr_b16 v[188:189], v15 offset:38912
    ds_read_b64_tr_b16 v[190:191], v15 offset:39424
    s_waitcnt lgkmcnt(4)
    v_mfma_f32_32x32x16_bf16 v[160:175], v[88:91], v[180:183], v[160:175]
    s_waitcnt vmcnt(11)
    s_barrier
    ds_read_b64_tr_b16 v[176:177], v14 offset:40960
    ds_read_b64_tr_b16 v[178:179], v14 offset:41472
    buffer_load_dwordx4 v[124:127], v4, s[36:39], s46 offen offset:3072
    s_waitcnt vmcnt(8)
    s_waitcnt lgkmcnt(4)
    v_mfma_f32_32x32x16_bf16 v[144:159], v[92:95], v[184:187], v[144:159]
    ds_read_b64_tr_b16 v[180:181], v15 offset:40960
    ds_read_b64_tr_b16 v[182:183], v15 offset:41472
    s_waitcnt lgkmcnt(4)
    v_mfma_f32_32x32x16_bf16 v[160:175], v[92:95], v[188:191], v[160:175]
    ds_read_b64_tr_b16 v[184:185], v14 offset:43008
    ds_read_b64_tr_b16 v[186:187], v14 offset:43520
    s_waitcnt vmcnt(7)
    s_waitcnt lgkmcnt(4)
    v_mfma_f32_32x32x16_bf16 v[144:159], v[96:99], v[176:179], v[144:159]
    ds_read_b64_tr_b16 v[188:189], v15 offset:43008
    ds_read_b64_tr_b16 v[190:191], v15 offset:43520
    s_waitcnt lgkmcnt(4)
    v_mfma_f32_32x32x16_bf16 v[160:175], v[96:99], v[180:183], v[160:175]
    ds_read_b64_tr_b16 v[176:177], v14 offset:45056
    ds_read_b64_tr_b16 v[178:179], v14 offset:45568
    s_waitcnt vmcnt(6)
    s_waitcnt lgkmcnt(4)
    v_mfma_f32_32x32x16_bf16 v[144:159], v[100:103], v[184:187], v[144:159]
    ds_read_b64_tr_b16 v[180:181], v15 offset:45056
    ds_read_b64_tr_b16 v[182:183], v15 offset:45568
    s_waitcnt lgkmcnt(4)
    v_mfma_f32_32x32x16_bf16 v[160:175], v[100:103], v[188:191], v[160:175]
    ds_read_b64_tr_b16 v[184:185], v14 offset:47104
    ds_read_b64_tr_b16 v[186:187], v14 offset:47616
    s_waitcnt vmcnt(5)
    s_waitcnt lgkmcnt(4)
    v_mfma_f32_32x32x16_bf16 v[144:159], v[104:107], v[176:179], v[144:159]
    ds_read_b64_tr_b16 v[188:189], v15 offset:47104
    ds_read_b64_tr_b16 v[190:191], v15 offset:47616
    s_waitcnt lgkmcnt(4)
    v_mfma_f32_32x32x16_bf16 v[160:175], v[104:107], v[180:183], v[160:175]
    ds_read_b64_tr_b16 v[176:177], v14 offset:49152
    ds_read_b64_tr_b16 v[178:179], v14 offset:49664
    s_waitcnt vmcnt(4)
    s_waitcnt lgkmcnt(4)
    v_mfma_f32_32x32x16_bf16 v[144:159], v[108:111], v[184:187], v[144:159]
    ds_read_b64_tr_b16 v[180:181], v15 offset:49152
    ds_read_b64_tr_b16 v[182:183], v15 offset:49664
    s_waitcnt lgkmcnt(4)
    v_mfma_f32_32x32x16_bf16 v[160:175], v[108:111], v[188:191], v[160:175]
    ds_read_b64_tr_b16 v[184:185], v14 offset:51200
    ds_read_b64_tr_b16 v[186:187], v14 offset:51712
    s_waitcnt vmcnt(3)
    s_waitcnt lgkmcnt(4)
    v_mfma_f32_32x32x16_bf16 v[144:159], v[112:115], v[176:179], v[144:159]
    ds_read_b64_tr_b16 v[188:189], v15 offset:51200
    ds_read_b64_tr_b16 v[190:191], v15 offset:51712
    s_waitcnt lgkmcnt(4)
    v_mfma_f32_32x32x16_bf16 v[160:175], v[112:115], v[180:183], v[160:175]
    ds_read_b64_tr_b16 v[176:177], v14 offset:53248
    ds_read_b64_tr_b16 v[178:179], v14 offset:53760
    s_waitcnt vmcnt(2)
    s_waitcnt lgkmcnt(4)
    v_mfma_f32_32x32x16_bf16 v[144:159], v[116:119], v[184:187], v[144:159]
    ds_read_b64_tr_b16 v[180:181], v15 offset:53248
    ds_read_b64_tr_b16 v[182:183], v15 offset:53760
    s_waitcnt lgkmcnt(4)
    v_mfma_f32_32x32x16_bf16 v[160:175], v[116:119], v[188:191], v[160:175]
    ds_read_b64_tr_b16 v[184:185], v14 offset:55296
    ds_read_b64_tr_b16 v[186:187], v14 offset:55808
    s_waitcnt vmcnt(1)
    s_waitcnt lgkmcnt(4)
    v_mfma_f32_32x32x16_bf16 v[144:159], v[120:123], v[176:179], v[144:159]
    ds_read_b64_tr_b16 v[188:189], v15 offset:55296
    ds_read_b64_tr_b16 v[190:191], v15 offset:55808
    s_waitcnt lgkmcnt(4)
    v_mfma_f32_32x32x16_bf16 v[160:175], v[120:123], v[180:183], v[160:175]
    s_waitcnt vmcnt(0)
    s_waitcnt lgkmcnt(2)
    v_mfma_f32_32x32x16_bf16 v[144:159], v[124:127], v[184:187], v[144:159]
    s_waitcnt lgkmcnt(0)
    v_mfma_f32_32x32x16_bf16 v[160:175], v[124:127], v[188:191], v[160:175]
    s_mov_b32 s32, s6
    s_and_b32 s33, s7, 0xffff
    s_mov_b32 s34, 3670016
    s_mov_b32 s35, 0x20000
    s_mul_i32 s22, s19, 56
    s_add_u32 s22, s22, 58368
    v_mul_u32_u24 v5, 272, v2
    v_lshl_add_u32 v5, v3, 3, v5
    v_add_u32 v5, s22, v5
    s_nop 5
    v_cvt_pk_bf16_f32 v16, v144, v145
    v_cvt_pk_bf16_f32 v17, v146, v147
    v_cvt_pk_bf16_f32 v18, v148, v149
    v_cvt_pk_bf16_f32 v19, v150, v151
    v_cvt_pk_bf16_f32 v20, v152, v153
    v_cvt_pk_bf16_f32 v21, v154, v155
    v_cvt_pk_bf16_f32 v22, v156, v157
    v_cvt_pk_bf16_f32 v23, v158, v159
    v_cvt_pk_bf16_f32 v24, v160, v161
    v_cvt_pk_bf16_f32 v25, v162, v163
    v_cvt_pk_bf16_f32 v26, v164, v165
    v_cvt_pk_bf16_f32 v27, v166, v167
    v_cvt_pk_bf16_f32 v28, v168, v169
    v_cvt_pk_bf16_f32 v29, v170, v171
    v_cvt_pk_bf16_f32 v30, v172, v173
    v_cvt_pk_bf16_f32 v31, v174, v175
    ds_write_b64 v5, v[16:17] offset:0
    ds_write_b64 v5, v[18:19] offset:16
    ds_write_b64 v5, v[20:21] offset:32
    s_mov_b32 exec_hi, 0
    ds_write_b64 v5, v[22:23] offset:48
    s_mov_b32 exec_hi, -1
    ds_write_b64 v5, v[24:25] offset:8704
    ds_write_b64 v5, v[26:27] offset:8720
    ds_write_b64 v5, v[28:29] offset:8736
    s_mov_b32 exec_hi, 0
    ds_write_b64 v5, v[30:31] offset:8752
    s_mov_b32 exec_hi, -1
    s_lshl_b32 s23, s20, 6
    s_lshl_b32 s24, s19, 4
    s_add_u32 s23, s23, s24
    s_mul_i32 s45, s23, 1792
    s_mul_i32 s23, s21, 224
    s_add_u32 s45, s45, s23
    s_add_u32 s45, s45, 896
    s_waitcnt lgkmcnt(0)
    s_barrier
    ds_read_b128 v[48:51], v192
    ds_read_b128 v[52:55], v193
    ds_read_b128 v[56:59], v194
    ds_read_b128 v[60:63], v195
    s_waitcnt lgkmcnt(3)
    buffer_store_dwordx4 v[48:51], v196, s[32:35], s45 offen
    s_waitcnt lgkmcnt(2)
    buffer_store_dwordx4 v[52:55], v197, s[32:35], s45 offen
    s_waitcnt lgkmcnt(1)
    buffer_store_dwordx4 v[56:59], v198, s[32:35], s45 offen
    s_waitcnt lgkmcnt(0)
    buffer_store_dwordx4 v[60:63], v199, s[32:35], s45 offen
k3_end:
    s_endpgm

.section .rodata,"a"
.p2align 6
.amdhsa_kernel k1_kernel
  .amdhsa_next_free_vgpr 240
  .amdhsa_next_free_sgpr 102
  .amdhsa_accum_offset 240
  .amdhsa_group_segment_fixed_size 0
  .amdhsa_kernarg_size 72
  .amdhsa_user_sgpr_count 2
  .amdhsa_user_sgpr_kernarg_segment_ptr 1
  .amdhsa_system_sgpr_workgroup_id_x 1
  .amdhsa_float_denorm_mode_32 3
.end_amdhsa_kernel

.section .rodata,"a"
.p2align 6
.amdhsa_kernel k2_kernel
  .amdhsa_next_free_vgpr 256
  .amdhsa_next_free_sgpr 102
  .amdhsa_accum_offset 256
  .amdhsa_group_segment_fixed_size 0
  .amdhsa_kernarg_size 72
  .amdhsa_user_sgpr_count 2
  .amdhsa_user_sgpr_kernarg_segment_ptr 1
  .amdhsa_system_sgpr_workgroup_id_x 1
  .amdhsa_float_denorm_mode_32 3
.end_amdhsa_kernel

.section .rodata,"a"
.p2align 6
.amdhsa_kernel k3_kernel
  .amdhsa_next_free_vgpr 200
  .amdhsa_next_free_sgpr 102
  .amdhsa_accum_offset 200
  .amdhsa_group_segment_fixed_size 0
  .amdhsa_kernarg_size 72
  .amdhsa_user_sgpr_count 2
  .amdhsa_user_sgpr_kernarg_segment_ptr 1
  .amdhsa_system_sgpr_workgroup_id_x 1
  .amdhsa_float_denorm_mode_32 3
.end_amdhsa_kernel
.section .rodata,"a"
.p2align 8
.set C0, 16256
.set C1, 16256
.set C2, 16256
.set C3, 16256
.set C4, 16256
.set C5, 16255
.set C6, 16255
.set C7, 16255
.set C8, 16254
.set C9, 16254
.set C10, 16253
.set C11, 16253
.set C12, 16252
.set C13, 16252
.set C14, 16251
.set C15, 16250
.set C16, 16250
.set C17, 16249
.set C18, 16248
.set C19, 16247
.set C20, 16246
.set C21, 16245
.set C22, 16244
.set C23, 16243
.set C24, 16242
.set C25, 16240
.set C26, 16239
.set C27, 16238
.set C28, 16237
.set C29, 16235
.set C30, 16234
.set C31, 16232
.set C32, 16231
.set C33, 16229
.set C34, 16227
.set C35, 16226
.set C36, 16224
.set C37, 16222
.set C38, 16220
.set C39, 16219
.set C40, 16217
.set C41, 16215
.set C42, 16213
.set C43, 16211
.set C44, 16209
.set C45, 16207
.set C46, 16205
.set C47, 16202
.set C48, 16200
.set C49, 16198
.set C50, 16196
.set C51, 16193
.set C52, 16191
.set C53, 16188
.set C54, 16186
.set C55, 16184
.set C56, 16181
.set C57, 16178
.set C58, 16176
.set C59, 16173
.set C60, 16171
.set C61, 16168
.set C62, 16165
.set C63, 16162
.set C64, 16160
.set C65, 16157
.set C66, 16154
.set C67, 16151
.set C68, 16148
.set C69, 16145
.set C70, 16142
.set C71, 16139
.set C72, 16136
.set C73, 16133
.set C74, 16130
.set C75, 16126
.set C76, 16120
.set C77, 16113
.set C78, 16107
.set C79, 16101
.set C80, 16094
.set C81, 16088
.set C82, 16081
.set C83, 16075
.set C84, 16068
.set C85, 16061
.set C86, 16055
.set C87, 16048
.set C88, 16041
.set C89, 16034
.set C90, 16027
.set C91, 16021
.set C92, 16014
.set C93, 16007
.set C94, 16000
.set C95, 15986
.set C96, 15972
.set C97, 15958
.set C98, 15944
.set C99, 15930
.set C100, 15916
.set C101, 15901
.set C102, 15887
.set C103, 15873
.set C104, 15845
.set C105, 15817
.set C106, 15788
.set C107, 15759
.set C108, 15718
.set C109, 15660
.set C110, 15590
.set C111, 15462
.set C112, 9357
.set C113, 48230
.set C114, 48358
.set C115, 48428
.set C116, 48486
.set C117, 48527
.set C118, 48556
.set C119, 48585
.set C120, 48613
.set C121, 48641
.set C122, 48655
.set C123, 48669
.set C124, 48684
.set C125, 48698
.set C126, 48712
.set C127, 48726
.set C128, 48740
.set C129, 48754
.set C130, 48768
.set C131, 48775
.set C132, 48782
.set C133, 48789
.set C134, 48795
.set C135, 48802
.set C136, 48809
.set C137, 48816
.set C138, 48823
.set C139, 48829
.set C140, 48836
.set C141, 48843
.set C142, 48849
.set C143, 48856
.set C144, 48862
.set C145, 48869
.set C146, 48875
.set C147, 48881
.set C148, 48888
.set C149, 48894
.set C150, 48898
.set C151, 48901
.set C152, 48904
.set C153, 48907
.set C154, 48910
.set C155, 48913
.set C156, 48916
.set C157, 48919
.set C158, 48922
.set C159, 48925
.set C160, 48928
.set C161, 48930
.set C162, 48933
.set C163, 48936
.set C164, 48939
.set C165, 48941
.set C166, 48944
.set C167, 48946
.set C168, 48949
.set C169, 48952
.set C170, 48954
.set C171, 48956
.set C172, 48959
.set C173, 48961
.set C174, 48964
.set C175, 48966
.set C176, 48968
.set C177, 48970
.set C178, 48973
.set C179, 48975
.set C180, 48977
.set C181, 48979
.set C182, 48981
.set C183, 48983
.set C184, 48985
.set C185, 48987
.set C186, 48988
.set C187, 48990
.set C188, 48992
.set C189, 48994
.set C190, 48995
.set C191, 48997
.set C192, 48999
.set C193, 49000
.set C194, 49002
.set C195, 49003
.set C196, 49005
.set C197, 49006
.set C198, 49007
.set C199, 49008
.set C200, 49010
.set C201, 49011
.set C202, 49012
.set C203, 49013
.set C204, 49014
.set C205, 49015
.set C206, 49016
.set C207, 49017
.set C208, 49018
.set C209, 49018
.set C210, 49019
.set C211, 49020
.set C212, 49020
.set C213, 49021
.set C214, 49021
.set C215, 49022
.set C216, 49022
.set C217, 49023
.set C218, 49023
.set C219, 49023
.set C220, 49024
.set C221, 49024
.set C222, 49024
.set C223, 49024
.set C224, 49024
.set C225, 49024
.set C226, 49024
.set C227, 49024
.set C228, 49024
.set C229, 49023
.set C230, 49023
.set C231, 49023
.set C232, 49022
.set C233, 49022
.set C234, 49021
.set C235, 49021
.set C236, 49020
.set C237, 49020
.set C238, 49019
.set C239, 49018
.set C240, 49018
.set C241, 49017
.set C242, 49016
.set C243, 49015
.set C244, 49014
.set C245, 49013
.set C246, 49012
.set C247, 49011
.set C248, 49010
.set C249, 49008
.set C250, 49007
.set C251, 49006
.set C252, 49005
.set C253, 49003
.set C254, 49002
.set C255, 49000
.set C256, 48999
.set C257, 48997
.set C258, 48995
.set C259, 48994
.set C260, 48992
.set C261, 48990
.set C262, 48988
.set C263, 48987
.set C264, 48985
.set C265, 48983
.set C266, 48981
.set C267, 48979
.set C268, 48977
.set C269, 48975
.set C270, 48973
.set C271, 48970
.set C272, 48968
.set C273, 48966
.set C274, 48964
.set C275, 48961
.set C276, 48959
.set C277, 48956
.set C278, 48954
.set C279, 48952
.set C280, 48949
.set C281, 48946
.set C282, 48944
.set C283, 48941
.set C284, 48939
.set C285, 48936
.set C286, 48933
.set C287, 48930
.set C288, 48928
.set C289, 48925
.set C290, 48922
.set C291, 48919
.set C292, 48916
.set C293, 48913
.set C294, 48910
.set C295, 48907
.set C296, 48904
.set C297, 48901
.set C298, 48898
.set C299, 48894
.set C300, 48888
.set C301, 48881
.set C302, 48875
.set C303, 48869
.set C304, 48862
.set C305, 48856
.set C306, 48849
.set C307, 48843
.set C308, 48836
.set C309, 48829
.set C310, 48823
.set C311, 48816
.set C312, 48809
.set C313, 48802
.set C314, 48795
.set C315, 48789
.set C316, 48782
.set C317, 48775
.set C318, 48768
.set C319, 48754
.set C320, 48740
.set C321, 48726
.set C322, 48712
.set C323, 48698
.set C324, 48684
.set C325, 48669
.set C326, 48655
.set C327, 48641
.set C328, 48613
.set C329, 48585
.set C330, 48556
.set C331, 48527
.set C332, 48486
.set C333, 48428
.set C334, 48358
.set C335, 48230
.set C336, 42324
.set C337, 15462
.set C338, 15590
.set C339, 15660
.set C340, 15718
.set C341, 15759
.set C342, 15788
.set C343, 15817
.set C344, 15845
.set C345, 15873
.set C346, 15887
.set C347, 15901
.set C348, 15916
.set C349, 15930
.set C350, 15944
.set C351, 15958
.set C352, 15972
.set C353, 15986
.set C354, 16000
.set C355, 16007
.set C356, 16014
.set C357, 16021
.set C358, 16027
.set C359, 16034
.set C360, 16041
.set C361, 16048
.set C362, 16055
.set C363, 16061
.set C364, 16068
.set C365, 16075
.set C366, 16081
.set C367, 16088
.set C368, 16094
.set C369, 16101
.set C370, 16107
.set C371, 16113
.set C372, 16120
.set C373, 16126
.set C374, 16130
.set C375, 16133
.set C376, 16136
.set C377, 16139
.set C378, 16142
.set C379, 16145
.set C380, 16148
.set C381, 16151
.set C382, 16154
.set C383, 16157
.set C384, 16160
.set C385, 16162
.set C386, 16165
.set C387, 16168
.set C388, 16171
.set C389, 16173
.set C390, 16176
.set C391, 16178
.set C392, 16181
.set C393, 16184
.set C394, 16186
.set C395, 16188
.set C396, 16191
.set C397, 16193
.set C398, 16196
.set C399, 16198
.set C400, 16200
.set C401, 16202
.set C402, 16205
.set C403, 16207
.set C404, 16209
.set C405, 16211
.set C406, 16213
.set C407, 16215
.set C408, 16217
.set C409, 16219
.set C410, 16220
.set C411, 16222
.set C412, 16224
.set C413, 16226
.set C414, 16227
.set C415, 16229
.set C416, 16231
.set C417, 16232
.set C418, 16234
.set C419, 16235
.set C420, 16237
.set C421, 16238
.set C422, 16239
.set C423, 16240
.set C424, 16242
.set C425, 16243
.set C426, 16244
.set C427, 16245
.set C428, 16246
.set C429, 16247
.set C430, 16248
.set C431, 16249
.set C432, 16250
.set C433, 16250
.set C434, 16251
.set C435, 16252
.set C436, 16252
.set C437, 16253
.set C438, 16253
.set C439, 16254
.set C440, 16254
.set C441, 16255
.set C442, 16255
.set C443, 16255
.set C444, 16256
.set C445, 16256
.set C446, 16256
.set C447, 16256
.altmacro
.macro EMIT2 a, b
.long C\a | (C\b << 16)
.endm
TF:
.set d, 0
.rept 448
 .set cb, 0
 .rept 4
  .set c, 56*cb
  .rept 56
   .if c == 0
    EMIT2 0, %((224*d) % 448)
   .else
    EMIT2 %((c*d) % 448), %((c*d+112) % 448)
   .endif
   .set c, c+1
  .endr
  .fill 8, 4, 0
  .set cb, cb+1
 .endr
 .set d, d+1
.endr
.p2align 8
TG:
.set grp, 0
.rept 16
 .set ks, 0
 .rept 28
  .set l, 0
  .rept 64
   .set d, 28*grp + (l % 32)
   .set j2, 8*ks + 4*(l / 32)
   .if (l % 32) >= 28
    .long 0, 0, 0, 0
   .else
    .if j2 == 0
     .long 0x3f00 | ((0x3f00 | ((d % 2) << 15)) << 16)
    .else
     EMIT2 %((j2*d) % 448), %((j2*d+112) % 448)
    .endif
    EMIT2 %(((j2+1)*d) % 448), %(((j2+1)*d+112) % 448)
    EMIT2 %(((j2+2)*d) % 448), %(((j2+2)*d+112) % 448)
    EMIT2 %(((j2+3)*d) % 448), %(((j2+3)*d+112) % 448)
   .endif
   .set l, l+1
  .endr
  .set ks, ks+1
 .endr
 .set grp, grp+1
.endr
.noaltmacro
.p2align 8
TB2:
.quad 0x3f803f803f803f80,0x3f803f803f803f80,0x3f553f6d3f7b3f80,0xbf0ebec4be48248d,0x3ec43f353f6d3f80,0xbec4bf35bf6dbf80,0xbe483ec43f553f80,0x3f7b3f6d3f0ea554
.quad 0xbf35248d3f353f80,0xbf3525b03f353f80,0xbf7bbec43f0e3f80,0xbe48bf6dbf5525b0,0xbf6dbf353ec43f80,0x3f6d3f35bec4bf80,0xbf0ebf6d3e483f80,0xbf553ec43f7ba5f7
.quad 0xa554bf80248d3f80,0xa731bf80261f3f80,0x3f0ebf6dbe483f80,0x3f553ec4bf7b261f,0x3f6dbf35bec43f80,0xbf6d3f353ec4bf80,0x3f7bbec4bf0e3f80,0x3e48bf6d3f55a731
.quad 0x3f35a554bf353f80,0x3f35a742bf353f80,0x3e483ec4bf553f80,0xbf7b3f6dbf0ea68d,0xbec43f35bf6d3f80,0x3ec4bf353f6dbf80,0xbf553f6dbf7b3f80,0x3f0ebec43e48a742
.quad 0xbf803f80bf803f80,0xbf803f80bf803f80,0xbf553f6dbf7b3f80,0x3f0ebec43e48a654,0xbec43f35bf6d3f80,0x3ec4bf353f6dbf80,0x3e483ec4bf553f80,0xbf7b3f6dbf0ea754
.quad 0x3f3525b0bf353f80,0x3f35a58ebf353f80,0x3f7bbec4bf0e3f80,0x3e48bf6d3f55a60d,0x3f6dbf35bec43f80,0xbf6d3f353ec4bf80,0x3f0ebf6dbe483f80,0x3f553ec4bf7ba765
.quad 0x261fbf80a5543f80,0x258dbf80a7773f80,0xbf0ebf6d3e483f80,0xbf553ec43f7ba58e,0xbf6dbf353ec43f80,0x3f6d3f35bec4bf80,0xbf7bbec43f0e3f80,0xbe48bf6dbf55a777
.quad 0xbf35a5f73f353f80,0xbf35a78d3f353f80,0xbe483ec43f553f80,0x3f7b3f6d3f0ea137,0x3ec43f353f6d3f80,0xbec4bf35bf6dbf80,0x3f553f6d3f7b3f80,0xbf0ebec4be48a784
.quad 0x3f803f803f803f80,0x3f803f803f803f80,0x3e483ec43f0e3f35,0xbf7bbf6dbf55bf35,0xbf6dbf35bec4248d,0x3f6d3f353ec4a554,0xbf0ebf6dbf7bbf35,0xbf55bec43e483f35
.quad 0x3f35a554bf35bf80,0x3f35a5f7bf35bf80,0x3f553f6d3e48bf35,0xbf0e3ec43f7b3f35,0xbec43f353f6da554,0x3ec4bf35bf6d261f,0xbf7bbec43f553f35,0xbe483f6d3f0ebf35
.quad 0xa5f7bf8025b03f80,0xa742bf80a68d3f80,0x3f7bbec4bf553f35,0x3e483f6dbf0ebf35,0x3ec43f35bf6d25b0,0xbec4bf353f6da742,0xbf553f6dbe48bf35,0x3f0e3ec4bf7b3f35
.quad 0xbf35261f3f35bf80,0xbf35a60d3f35bf80,0x3f0ebf6d3f7bbf35,0x3f55bec4be483f35,0x3f6dbf353ec4a5f7,0xbf6d3f35bec4a60d,0xbe483ec4bf0e3f35,0x3f7bbf6d3f55bf35
.quad 0xbf803f80bf803f80,0xbf803f80bf803f80,0xbe483ec4bf0e3f35,0x3f7bbf6d3f55bf35,0x3f6dbf353ec4261f,0xbf6d3f35bec4a777,0x3f0ebf6d3f7bbf35,0x3f55bec4be483f35
.quad 0xbf35a7423f35bf80,0xbf35a78d3f35bf80,0xbf553f6dbe48bf35,0x3f0e3ec4bf7b3f35,0x3ec43f35bf6da731,0xbec4bf353f6d258d,0x3f7bbec4bf553f35,0x3e483f6dbf0ebf35
.quad 0xa60dbf80a7423f80,0x268dbf80a7963f80,0xbf7bbec43f553f35,0xbe483f6d3f0ebf35,0xbec43f353f6da68d,0x3ec4bf35bf6da796,0x3f553f6d3e48bf35,0xbf0e3ec43f7b3f35
.quad 0x3f35a60dbf35bf80,0x3f352816bf35bf80,0xbf0ebf6dbf7bbf35,0xbf55bec43e483f35,0xbf6dbf35bec4a742,0x3f6d3f353ec4268d,0x3e483ec43f0e3f35,0xbf7bbf6dbf55bf35
.quad 0x3f803f803f803f80,0x3f803f803f803f80,0xbf55bf6dbf7bbf80,0x3f0e3ec43e48a554,0x3ec43f353f6d3f80,0xbec4bf35bf6dbf80,0x3e48bec4bf55bf80,0xbf7bbf6dbf0e261f
.quad 0xbf35261f3f353f80,0xbf35a68d3f353f80,0x3f7b3ec4bf0ebf80,0x3e483f6d3f55a742,0xbf6dbf353ec43f80,0x3f6d3f35bec4bf80,0x3f0e3f6dbe48bf80,0x3f55bec4bf7ba60d
.quad 0xa754bf80a6543f80,0xa777bf80a58e3f80,0xbf0e3f6d3e48bf80,0xbf55bec43f7ba777,0x3f6dbf35bec43f80,0xbf6d3f353ec4bf80,0xbf7b3ec43f0ebf80,0xbe483f6dbf55258d
.quad 0x3f35a777bf353f80,0x3f35a796bf353f80,0xbe48bec43f55bf80,0x3f7bbf6d3f0ea796,0xbec43f35bf6d3f80,0x3ec4bf353f6dbf80,0x3f55bf6d3f7bbf80,0xbf0e3ec4be48268d
.quad 0xbf803f80bf803f80,0xbf803f80bf803f80,0x3f55bf6d3f7bbf80,0xbf0e3ec4be48a7b1,0xbec43f35bf6d3f80,0x3ec4bf353f6dbf80,0xbe48bec43f55bf80,0x3f7bbf6d3f0e281f
.quad 0x3f35268dbf353f80,0x3f352828bf353f80,0xbf7b3ec43f0ebf80,0xbe483f6dbf5526d4,0x3f6dbf35bec43f80,0xbf6d3f353ec4bf80,0xbf0e3f6d3e48bf80,0xbf55bec43f7b2730
.quad 0x281fbf80a7b13f80,0x2839bf80a7e53f80,0x3f0e3f6dbe48bf80,0x3f55bec4bf7ba7e5,0xbf6dbf353ec43f80,0x3f6d3f35bec4bf80,0x3f7b3ec4bf0ebf80,0x3e483f6d3f552839
.quad 0xbf3526d43f353f80,0xbf35a8043f353f80,0x3e48bec4bf55bf80,0xbf7bbf6dbf0ea880,0x3ec43f353f6d3f80,0xbec4bf35bf6dbf80,0xbf55bf6dbf7bbf80,0x3f0e3ec43e4828a3
.quad 0x3f803f803f803f80,0x3f803f803f803f80,0xbe48bec4bf0ebf35,0x3f7b3f6d3f553f35,0xbf6dbf35bec425b0,0x3f6d3f353ec4a5f7,0x3f0e3f6d3f7b3f35,0x3f553ec4be48bf35
.quad 0x3f35a731bf35bf80,0x3f35a742bf35bf80,0xbf55bf6dbe483f35,0x3f0ebec4bf7bbf35,0xbec43f353f6da742,0x3ec4bf35bf6da60d,0x3f7b3ec4bf55bf35,0x3e48bf6dbf0e3f35
.quad 0xa765bf80a60d3f80,0xa784bf80a1373f80,0xbf7b3ec43f55bf35,0xbe48bf6d3f0e3f35,0x3ec43f35bf6da58e,0xbec4bf353f6da78d,0x3f55bf6d3e483f35,0xbf0ebec43f7bbf35
.quad 0xbf35258d3f35bf80,0xbf35268d3f35bf80,0xbf0e3f6dbf7b3f35,0xbf553ec43e48bf35,0x3f6dbf353ec4a78d,0xbf6d3f35bec42816,0x3e48bec43f0ebf35,0xbf7b3f6dbf553f35
.quad 0xbf803f80bf803f80,0xbf803f80bf803f80,0x3e48bec43f0ebf35,0xbf7b3f6dbf553f35,0x3f6dbf353ec4268d,0xbf6d3f35bec426d4,0xbf0e3f6dbf7b3f35,0xbf553ec43e48bf35
.quad 0xbf35270d3f35bf80,0xbf35a7e53f35bf80,0x3f55bf6d3e483f35,0xbf0ebec43f7bbf35,0x3ec43f35bf6d270d,0xbec4bf353f6d2754,0xbf7b3ec43f55bf35,0xbe48bf6d3f0e3f35
.quad 0x2730bf8026d43f80,0x28a3bf80a8803f80,0x3f7b3ec4bf55bf35,0x3e48bf6dbf0e3f35,0xbec43f353f6d2828,0x3ec4bf35bf6da804,0xbf55bf6dbe483f35,0x3f0ebec4bf7bbf35
.quad 0x3f352754bf35bf80,0x3f35a731bf35bf80,0x3f0e3f6d3f7b3f35,0x3f553ec4be48bf35,0xbf6dbf35bec4a7e5,0x3f6d3f353ec4a731,0xbe48bec4bf0ebf35,0x3f7b3f6d3f553f35
.quad 0x8000800080008000,0x8000800080008000,0xbf0ebec4be488000,0xbf55bf6dbf7bbf80,0xbf6dbf35bec48000,0x3f6d3f353ec4a50d,0xbf7bbf6dbf0e8000,0xbe483ec43f553f80
.quad 0xbf35bf80bf358000,0xbf35bf80bf35258d,0xbe48bf6dbf558000,0x3f7b3ec4bf0ebf80,0x3ec4bf35bf6d8000,0xbec43f353f6da5d4,0x3f55bec4bf7b8000,0xbf0ebf6d3e483f80
.quad 0x3f80a50dbf808000,0x3f80a630bf80260d,0x3f553ec4bf7b8000,0xbf0e3f6d3e48bf80,0x3ec43f35bf6d8000,0xbec4bf353f6da630,0xbe483f6dbf558000,0x3f7bbec4bf0e3f80
.quad 0xbf353f80bf358000,0xbf353f80bf352654,0xbf7b3f6dbf0e8000,0xbe48bec43f55bf80,0xbf6d3f35bec48000,0x3f6dbf353ec4a677,0xbf0e3ec4be488000,0xbf553f6dbf7b3f80
.quad 0xa5d4258da50d8000,0xa7b126b0a69f268d,0x3f0ebec43e488000,0x3f55bf6d3f7bbf80,0x3f6dbf353ec48000,0xbf6d3f35bec4a69f,0x3f7bbf6d3f0e8000,0x3e483ec4bf553f80
.quad 0x3f35bf803f358000,0x3f35bf803f3526b0,0x3e48bf6d3f558000,0xbf7b3ec43f0ebf80,0xbec4bf353f6d8000,0x3ec43f35bf6da7b1,0xbf55bec43f7b8000,0x3f0ebf6dbe483f80
.quad 0xbf80a5d43f808000,0xbf80a7c23f8026d4,0xbf553ec43f7b8000,0x3f0e3f6dbe48bf80,0xbec43f353f6d8000,0x3ec4bf35bf6d270d,0x3e483f6d3f558000,0xbf7bbec43f0e3f80
.quad 0x3f353f803f358000,0x3f353f803f3526f7,0x3f7b3f6d3f0e8000,0x3e48bec4bf55bf80,0x3f6d3f353ec48000,0xbf6dbf35bec4a7c2,0x3f0e3ec43e488000,0x3f553f6d3f7b3f80
.quad 0x8000800080008000,0x8000800080008000,0xbf7bbf6dbf55bf35,0xbe48bec4bf0ebf35,0xbec4bf35bf6dbf80,0x3ec43f353f6d3f80,0x3f553ec4be48bf35,0xbf0ebf6dbf7bbf35
.quad 0x3f353f803f35a50d,0x3f353f803f35a5d4,0xbf0e3ec43f7b3f35,0xbf55bf6dbe483f35,0xbf6dbf353ec43f80,0x3f6d3f35bec4bf80,0x3e48bf6dbf0e3f35,0xbf7bbec43f553f35
.quad 0x3f80a5d4bf80258d,0x3f80a677bf802654,0x3e483f6dbf0ebf35,0xbf7b3ec43f55bf35,0xbf6d3f353ec4bf80,0x3f6dbf35bec43f80,0xbf0ebec43f7bbf35,0xbf553f6dbe48bf35
.quad 0x3f35bf803f35a5d4,0x3f35bf803f35a69f,0x3f55bec4be483f35,0xbf0e3f6dbf7b3f35,0xbec43f35bf6d3f80,0x3ec4bf353f6dbf80,0xbf7b3f6dbf553f35,0xbe483ec4bf0e3f35
.quad 0xa6772654a630260d,0xa7c226f7270d26d4,0x3f7bbf6d3f55bf35,0x3e48bec43f0ebf35,0x3ec4bf353f6dbf80,0xbec43f35bf6d3f80,0xbf553ec43e48bf35,0x3f0ebf6d3f7bbf35
.quad 0xbf353f80bf35a630,0xbf353f80bf35a7c2,0x3f0e3ec4bf7b3f35,0x3f55bf6d3e483f35,0x3f6dbf35bec43f80,0xbf6d3f353ec4bf80,0xbe48bf6d3f0e3f35,0x3f7bbec4bf553f35
.quad 0xbf80a69f3f802654,0xbf80268d3f80271f,0xbe483f6d3f0ebf35,0x3f7b3ec4bf55bf35,0x3f6d3f35bec4bf80,0xbf6dbf353ec43f80,0x3f0ebec4bf7bbf35,0x3f553f6d3e48bf35
.quad 0xbf35bf80bf35a677,0xbf35bf80bf35268d,0xbf55bec43e483f35,0x3f0e3f6d3f7b3f35,0x3ec43f353f6d3f80,0xbec4bf35bf6dbf80,0x3f7b3f6d3f553f35,0x3e483ec43f0e3f35
.quad 0x8000800080008000,0x8000800080008000,0x3f0e3ec43e48a50d,0x3f553f6d3f7b3f80,0xbf6dbf35bec4258d,0x3f6d3f353ec4a5d4,0x3f7b3f6d3f0ea5d4,0x3e48bec4bf55bf80
.quad 0xbf35bf80bf35260d,0xbf35bf80bf352654,0x3e483f6d3f55a630,0xbf7bbec43f0e3f80,0x3ec4bf35bf6d2654,0xbec43f353f6da69f,0xbf553ec43f7ba677,0x3f0e3f6dbe48bf80
.quad 0x3f80a69fbf80268d,0x3f80270dbf8026d4,0xbf55bec43f7ba69f,0x3f0ebf6dbe483f80,0x3ec43f35bf6d26b0,0xbec4bf353f6da7c2,0x3e48bf6d3f55a7b1,0xbf7b3ec43f0ebf80
.quad 0xbf353f80bf3526d4,0xbf353f80bf35271f,0x3f7bbf6d3f0e270d,0x3e483ec4bf553f80,0xbf6d3f35bec426f7,0x3f6dbf353ec4268d,0x3f0ebec43e48a7c2,0x3f55bf6d3f7bbf80
.quad 0xa7d4271f26d4270d,0xa7f7a78d260e2754,0xbf0e3ec4be4826d4,0xbf553f6dbf7b3f80,0x3f6dbf353ec4271f,0xbf6d3f35bec4a7f7,0xbf7b3f6dbf0ea7d4,0xbe48bec43f55bf80
.quad 0x3f35bf803f352730,0x3f35bf803f352842,0xbe483f6dbf55268d,0x3f7bbec4bf0e3f80,0xbec4bf353f6d2831,0x3ec43f35bf6da60d,0x3f553ec4bf7ba7e5,0xbf0e3f6d3e48bf80
.quad 0xbf80a7f73f802754,0xbf80a8163f80279f,0x3f55bec4bf7b260e,0xbf0ebf6d3e483f80,0xbec43f353f6da78d,0x3ec4bf35bf6da816,0xbe48bf6dbf55a7f7,0x3f7b3ec4bf0ebf80
.quad 0x3f353f803f352777,0x3f353f803f35a70d,0xbf7bbf6dbf0e21b7,0xbe483ec43f553f80,0x3f6d3f353ec42842,0xbf6dbf35bec4a70d,0xbf0ebec4be48a804,0xbf55bf6dbf7bbf80
.quad 0x8000800080008000,0x8000800080008000,0x3f7b3f6d3f553f35,0x3e483ec43f0e3f35,0xbec4bf35bf6dbf80,0x3ec43f353f6d3f80,0xbf55bec43e483f35,0x3f0e3f6d3f7b3f35
.quad 0x3f353f803f35a630,0x3f353f803f35a677,0x3f0ebec4bf7bbf35,0x3f553f6d3e48bf35,0xbf6dbf353ec43f80,0x3f6d3f35bec4bf80,0xbe483f6d3f0ebf35,0x3f7b3ec4bf55bf35
.quad 0x3f80a7b1bf8026b0,0x3f80a7c2bf8026f7,0xbe48bf6d3f0e3f35,0x3f7bbec4bf553f35,0xbf6d3f353ec4bf80,0x3f6dbf35bec43f80,0x3f0e3ec4bf7b3f35,0x3f55bf6d3e483f35
.quad 0x3f35bf803f35a7c2,0x3f35bf803f35268d,0xbf553ec43e48bf35,0x3f0ebf6d3f7bbf35,0xbec43f35bf6d3f80,0x3ec4bf353f6dbf80,0x3f7bbf6d3f55bf35,0x3e48bec43f0ebf35
.quad 0xa7e52831268d2730,0xa804284221b72777,0xbf7b3f6dbf553f35,0xbe483ec4bf0e3f35,0x3ec4bf353f6dbf80,0xbec43f35bf6d3f80,0x3f55bec4be483f35,0xbf0e3f6dbf7b3f35
.quad 0xbf353f80bf35260e,0xbf353f80bf35a80d,0xbf0ebec43f7bbf35,0xbf553f6dbe48bf35,0x3f6dbf35bec43f80,0xbf6d3f353ec4bf80,0x3e483f6dbf0ebf35,0xbf7b3ec43f55bf35
.quad 0xbf80a60d3f802842,0xbf80a70d3f80a70d,0x3e48bf6dbf0e3f35,0xbf7bbec43f553f35,0x3f6d3f35bec4bf80,0xbf6dbf353ec43f80,0xbf0e3ec43f7b3f35,0xbf55bf6dbe483f35
.quad 0xbf35bf80bf35a80d,0xbf35bf80bf35a896,0x3f553ec4be48bf35,0xbf0ebf6dbf7bbf35,0x3ec43f353f6d3f80,0xbec4bf35bf6dbf80,0xbf7bbf6dbf55bf35,0xbe48bec4bf0ebf35
.quad 0x0,0x0,0x3f0e3ec43e480000,0x3f553f6d3f7b3f80,0x3f6d3f353ec40000,0xbf6dbf35bec4250d,0x3f7b3f6d3f0e0000,0x3e48bec4bf55bf80
.quad 0x3f353f803f350000,0x3f353f803f35a58d,0x3e483f6d3f550000,0xbf7bbec43f0e3f80,0xbec43f353f6d0000,0x3ec4bf35bf6d25d4,0xbf553ec43f7b0000,0x3f0e3f6dbe48bf80
.quad 0xbf80250d3f800000,0xbf8026303f80a60d,0xbf55bec43f7b0000,0x3f0ebf6dbe483f80,0xbec4bf353f6d0000,0x3ec43f35bf6d2630,0x3e48bf6d3f550000,0xbf7b3ec43f0ebf80
.quad 0x3f35bf803f350000,0x3f35bf803f35a654,0x3f7bbf6d3f0e0000,0x3e483ec4bf553f80,0x3f6dbf353ec40000,0xbf6d3f35bec42677,0x3f0ebec43e480000,0x3f55bf6d3f7bbf80
.quad 0x25d4a58d250d0000,0x27b1a6b0269fa68d,0xbf0e3ec4be480000,0xbf553f6dbf7b3f80,0xbf6d3f35bec40000,0x3f6dbf353ec4269f,0xbf7b3f6dbf0e0000,0xbe48bec43f55bf80
.quad 0xbf353f80bf350000,0xbf353f80bf35a6b0,0xbe483f6dbf550000,0x3f7bbec4bf0e3f80,0x3ec43f35bf6d0000,0xbec4bf353f6d27b1,0x3f553ec4bf7b0000,0xbf0e3f6d3e48bf80
.quad 0x3f8025d4bf800000,0x3f8027c2bf80a6d4,0x3f55bec4bf7b0000,0xbf0ebf6d3e483f80,0x3ec4bf35bf6d0000,0xbec43f353f6da70d,0xbe48bf6dbf550000,0x3f7b3ec4bf0ebf80
.quad 0xbf35bf80bf350000,0xbf35bf80bf35a6f7,0xbf7bbf6dbf0e0000,0xbe483ec43f553f80,0xbf6dbf35bec40000,0x3f6d3f353ec427c2,0xbf0ebec4be480000,0xbf55bf6dbf7bbf80
.quad 0x0,0x0,0x3f7b3f6d3f553f35,0x3e483ec43f0e3f35,0x3ec43f353f6d3f80,0xbec4bf35bf6dbf80,0xbf55bec43e483f35,0x3f0e3f6d3f7b3f35
.quad 0xbf35bf80bf35250d,0xbf35bf80bf3525d4,0x3f0ebec4bf7bbf35,0x3f553f6d3e48bf35,0x3f6d3f35bec4bf80,0xbf6dbf353ec43f80,0xbe483f6d3f0ebf35,0x3f7b3ec4bf55bf35
.quad 0xbf8025d43f80a58d,0xbf8026773f80a654,0xbe48bf6d3f0e3f35,0x3f7bbec4bf553f35,0x3f6dbf35bec43f80,0xbf6d3f353ec4bf80,0x3f0e3ec4bf7b3f35,0x3f55bf6d3e483f35
.quad 0xbf353f80bf3525d4,0xbf353f80bf35269f,0xbf553ec43e48bf35,0x3f0ebf6d3f7bbf35,0x3ec4bf353f6dbf80,0xbec43f35bf6d3f80,0x3f7bbf6d3f55bf35,0x3e48bec43f0ebf35
.quad 0x2677a6542630a60d,0x27c2a6f7a70da6d4,0xbf7b3f6dbf553f35,0xbe483ec4bf0e3f35,0xbec43f35bf6d3f80,0x3ec4bf353f6dbf80,0x3f55bec4be483f35,0xbf0e3f6dbf7b3f35
.quad 0x3f35bf803f352630,0x3f35bf803f3527c2,0xbf0ebec43f7bbf35,0xbf553f6dbe48bf35,0xbf6d3f353ec4bf80,0x3f6dbf35bec43f80,0x3e483f6dbf0ebf35,0xbf7b3ec43f55bf35
.quad 0x3f80269fbf80a654,0x3f80a68dbf80a71f,0x3e48bf6dbf0e3f35,0xbf7bbec43f553f35,0xbf6dbf353ec43f80,0x3f6d3f35bec4bf80,0xbf0e3ec43f7b3f35,0xbf55bf6dbe483f35
.quad 0x3f353f803f352677,0x3f353f803f35a68d,0x3f553ec4be48bf35,0xbf0ebf6dbf7bbf35,0xbec4bf35bf6dbf80,0x3ec43f353f6d3f80,0xbf7bbf6dbf55bf35,0xbe48bec4bf0ebf35
.quad 0x0,0x0,0xbf0ebec4be48250d,0xbf55bf6dbf7bbf80,0x3f6d3f353ec4a58d,0xbf6dbf35bec425d4,0xbf7bbf6dbf0e25d4,0xbe483ec43f553f80
.quad 0x3f353f803f35a60d,0x3f353f803f35a654,0xbe48bf6dbf552630,0x3f7b3ec4bf0ebf80,0xbec43f353f6da654,0x3ec4bf35bf6d269f,0x3f55bec4bf7b2677,0xbf0ebf6d3e483f80
.quad 0xbf80269f3f80a68d,0xbf80a70d3f80a6d4,0x3f553ec4bf7b269f,0xbf0e3f6d3e48bf80,0xbec4bf353f6da6b0,0x3ec43f35bf6d27c2,0xbe483f6dbf5527b1,0x3f7bbec4bf0e3f80
.quad 0x3f35bf803f35a6d4,0x3f35bf803f35a71f,0xbf7b3f6dbf0ea70d,0xbe48bec43f55bf80,0x3f6dbf353ec4a6f7,0xbf6d3f35bec4a68d,0xbf0e3ec4be4827c2,0xbf553f6dbf7b3f80
.quad 0x27d4a71fa6d4a70d,0x27f7278da60ea754,0x3f0ebec43e48a6d4,0x3f55bf6d3f7bbf80,0xbf6d3f35bec4a71f,0x3f6dbf353ec427f7,0x3f7bbf6d3f0e27d4,0x3e483ec4bf553f80
.quad 0xbf353f80bf35a730,0xbf353f80bf35a842,0x3e48bf6d3f55a68d,0xbf7b3ec43f0ebf80,0x3ec43f35bf6da831,0xbec4bf353f6d260d,0xbf55bec43f7b27e5,0x3f0ebf6dbe483f80
.quad 0x3f8027f7bf80a754,0x3f802816bf80a79f,0xbf553ec43f7ba60e,0x3f0e3f6dbe48bf80,0x3ec4bf35bf6d278d,0xbec43f353f6d2816,0x3e483f6d3f5527f7,0xbf7bbec43f0e3f80
.quad 0xbf35bf80bf35a777,0xbf35bf80bf35270d,0x3f7b3f6d3f0ea1b7,0x3e48bec4bf55bf80,0xbf6dbf35bec4a842,0x3f6d3f353ec4270d,0x3f0e3ec43e482804,0x3f553f6d3f7b3f80
.quad 0x0,0x0,0xbf7bbf6dbf55bf35,0xbe48bec4bf0ebf35,0x3ec43f353f6d3f80,0xbec4bf35bf6dbf80,0x3f553ec4be48bf35,0xbf0ebf6dbf7bbf35
.quad 0xbf35bf80bf352630,0xbf35bf80bf352677,0xbf0e3ec43f7b3f35,0xbf55bf6dbe483f35,0x3f6d3f35bec4bf80,0xbf6dbf353ec43f80,0x3e48bf6dbf0e3f35,0xbf7bbec43f553f35
.quad 0xbf8027b13f80a6b0,0xbf8027c23f80a6f7,0x3e483f6dbf0ebf35,0xbf7b3ec43f55bf35,0x3f6dbf35bec43f80,0xbf6d3f353ec4bf80,0xbf0ebec43f7bbf35,0xbf553f6dbe48bf35
.quad 0xbf353f80bf3527c2,0xbf353f80bf35a68d,0x3f55bec4be483f35,0xbf0e3f6dbf7b3f35,0x3ec4bf353f6dbf80,0xbec43f35bf6d3f80,0xbf7b3f6dbf553f35,0xbe483ec4bf0e3f35
.quad 0x27e5a831a68da730,0x2804a842a1b7a777,0x3f7bbf6d3f55bf35,0x3e48bec43f0ebf35,0xbec43f35bf6d3f80,0x3ec4bf353f6dbf80,0xbf553ec43e48bf35,0x3f0ebf6d3f7bbf35
.quad 0x3f35bf803f35a60e,0x3f35bf803f35280d,0x3f0e3ec4bf7b3f35,0x3f55bf6d3e483f35,0xbf6d3f353ec4bf80,0x3f6dbf35bec43f80,0xbe48bf6d3f0e3f35,0x3f7bbec4bf553f35
.quad 0x3f80260dbf80a842,0x3f80270dbf80270d,0xbe483f6d3f0ebf35,0x3f7b3ec4bf55bf35,0xbf6dbf353ec43f80,0x3f6d3f35bec4bf80,0x3f0ebec4bf7bbf35,0x3f553f6d3e48bf35
.quad 0x3f353f803f35280d,0x3f353f803f352896,0xbf55bec43e483f35,0x3f0e3f6d3f7b3f35,0xbec4bf35bf6dbf80,0x3ec43f353f6d3f80,0x3f7b3f6d3f553f35,0x3e483ec43f0e3f35
.quad 0x3f803f803f803f80,0x3f803f803f803f80,0x3f753f7b3f7f3f80,0x3ef13f0e3f223f35,0x3f553f6d3f7b3f80,0xbf0ebec4be48248d,0x3f223f553f753f80,0xbf7fbf7bbf62bf35
.quad 0x3ec43f353f6d3f80,0xbec4bf35bf6dbf80,0x3dc93f0e3f623f80,0x3f223e48be95bf35,0xbe483ec43f553f80,0x3f7b3f6d3f0ea554,0xbef13e483f463f80,0x3e953f553f7f3f35
.quad 0xbf35248d3f353f80,0xbf3525b03f353f80,0xbf62be483f223f80,0xbf75bf55bdc93f35,0xbf7bbec43f0e3f80,0xbe48bf6dbf5525b0,0xbf7fbf0e3ef13f80,0x3f46be48bf75bf35
.quad 0xbf6dbf353ec43f80,0x3f6d3f35bec4bf80,0xbf46bf553e953f80,0x3dc93f7b3ef1bf35,0xbf0ebf6d3e483f80,0xbf553ec43f7ba5f7,0xbe95bf7b3dc93f80,0xbf62bf0e3f463f35
.quad 0xa554bf80248d3f80,0xa731bf80261f3f80,0x3e95bf7bbdc93f80,0x3f62bf0ebf463f35,0x3f0ebf6dbe483f80,0x3f553ec4bf7b261f,0x3f46bf55be953f80,0xbdc93f7bbef1bf35
.quad 0x3f6dbf35bec43f80,0xbf6d3f353ec4bf80,0x3f7fbf0ebef13f80,0xbf46be483f75bf35,0x3f7bbec4bf0e3f80,0x3e48bf6d3f55a731,0x3f62be48bf223f80,0x3f75bf553dc93f35
.quad 0x3f35a554bf353f80,0x3f35a742bf353f80,0x3ef13e48bf463f80,0xbe953f55bf7f3f35,0x3e483ec4bf553f80,0xbf7b3f6dbf0ea68d,0xbdc93f0ebf623f80,0xbf223e483e95bf35
.quad 0xbec43f35bf6d3f80,0x3ec4bf353f6dbf80,0xbf223f55bf753f80,0x3f7fbf7b3f62bf35,0xbf553f6dbf7b3f80,0x3f0ebec43e48a742,0xbf753f7bbf7f3f80,0xbef13f0ebf223f35
.quad 0x3f803f803f803f80,0x3f803f803f803f80,0x3f463f553f623f6d,0x3dc93e483e953ec4,0x3e483ec43f0e3f35,0xbf7bbf6dbf55bf35,0xbef1be483dc93ec4,0xbe95bf0ebf46bf6d
.quad 0xbf6dbf35bec4248d,0x3f6d3f353ec4a554,0xbf75bf7bbf46bec4,0x3ef13f553f7f3f6d,0xbf0ebf6dbf7bbf35,0xbf55bec43e483f35,0x3dc9bf0ebf75bf6d,0xbf22bf7bbf62bec4
.quad 0x3f35a554bf35bf80,0x3f35a5f7bf35bf80,0x3f7f3f0ebe95bf6d,0x3f463f7b3ef1bec4,0x3f553f6d3e48bf35,0xbf0e3ec43f7b3f35,0x3e953f7b3f22bec4,0xbf62bf553dc93f6d
.quad 0xbec43f353f6da554,0x3ec4bf35bf6d261f,0xbf623e483f7f3ec4,0x3f753f0ebf22bf6d,0xbf7bbec43f553f35,0xbe483f6d3f0ebf35,0xbf22bf553ef13f6d,0xbf7fbe483f753ec4
.quad 0xa5f7bf8025b03f80,0xa742bf80a68d3f80,0x3f22bf55bef13f6d,0x3f7fbe48bf753ec4,0x3f7bbec4bf553f35,0x3e483f6dbf0ebf35,0x3f623e48bf7f3ec4,0xbf753f0e3f22bf6d
.quad 0x3ec43f35bf6d25b0,0xbec4bf353f6da742,0xbe953f7bbf22bec4,0x3f62bf55bdc93f6d,0xbf553f6dbe48bf35,0x3f0e3ec4bf7b3f35,0xbf7f3f0e3e95bf6d,0xbf463f7bbef1bec4
.quad 0xbf35261f3f35bf80,0xbf35a60d3f35bf80,0xbdc9bf0e3f75bf6d,0x3f22bf7b3f62bec4,0x3f0ebf6d3f7bbf35,0x3f55bec4be483f35,0x3f75bf7b3f46bec4,0xbef13f55bf7f3f6d
.quad 0x3f6dbf353ec4a5f7,0xbf6d3f35bec4a60d,0x3ef1be48bdc93ec4,0x3e95bf0e3f46bf6d,0xbe483ec4bf0e3f35,0x3f7bbf6d3f55bf35,0xbf463f55bf623f6d,0xbdc93e48be953ec4
.quad 0x8000800080008000,0x8000800080008000,0xbe95be48bdc98000,0xbf62bf55bf46bf35,0xbf0ebec4be488000,0xbf55bf6dbf7bbf80,0xbf46bf0ebe958000,0x3dc9be48bef1bf35
.quad 0xbf6dbf35bec48000,0x3f6d3f353ec4a50d,0xbf7fbf55bef18000,0x3f463f7b3f753f35,0xbf7bbf6dbf0e8000,0xbe483ec43f553f80,0xbf62bf7bbf228000,0xbf75bf0e3dc93f35
.quad 0xbf35bf80bf358000,0xbf35bf80bf35258d,0xbef1bf7bbf468000,0x3e95bf0ebf7fbf35,0xbe48bf6dbf558000,0x3f7b3ec4bf0ebf80,0x3dc9bf55bf628000,0x3f223f7b3e95bf35
.quad 0x3ec4bf35bf6d8000,0xbec43f353f6da5d4,0x3f22bf0ebf758000,0xbf7fbe483f623f35,0x3f55bec4bf7b8000,0xbf0ebf6d3e483f80,0x3f75be48bf7f8000,0x3ef1bf55bf223f35
.quad 0x3f80a50dbf808000,0x3f80a630bf80260d,0x3f753e48bf7f8000,0x3ef13f55bf22bf35,0x3f553ec4bf7b8000,0xbf0e3f6d3e48bf80,0x3f223f0ebf758000,0xbf7f3e483f62bf35
.quad 0x3ec43f35bf6d8000,0xbec4bf353f6da630,0x3dc93f55bf628000,0x3f22bf7b3e953f35,0xbe483f6dbf558000,0x3f7bbec4bf0e3f80,0xbef13f7bbf468000,0x3e953f0ebf7f3f35
.quad 0xbf353f80bf358000,0xbf353f80bf352654,0xbf623f7bbf228000,0xbf753f0e3dc9bf35,0xbf7b3f6dbf0e8000,0xbe48bec43f55bf80,0xbf7f3f55bef18000,0x3f46bf7b3f75bf35
.quad 0xbf6d3f35bec48000,0x3f6dbf353ec4a677,0xbf463f0ebe958000,0x3dc93e48bef13f35,0xbf0e3ec4be488000,0xbf553f6dbf7b3f80,0xbe953e48bdc98000,0xbf623f55bf463f35
.quad 0x8000800080008000,0x8000800080008000,0xbf22bf0ebef1bec4,0xbf7fbf7bbf75bf6d,0xbf7bbf6dbf55bf35,0xbe48bec4bf0ebf35,0xbf62bf7bbf7fbf6d,0x3f753f553f223ec4
.quad 0xbec4bf35bf6dbf80,0x3ec43f353f6d3f80,0x3e95be48bf22bf6d,0xbf62bf0ebdc93ec4,0x3f553ec4be48bf35,0xbf0ebf6dbf7bbf35,0x3f7f3f553e95bec4,0x3f463e48bef1bf6d
.quad 0x3f353f803f35a50d,0x3f353f803f35a5d4,0x3dc93f553f753ec4,0xbf223e483f623f6d,0xbf0e3ec43f7b3f35,0xbf55bf6dbe483f35,0xbf75be483f463f6d,0x3ef1bf0ebf7fbec4
.quad 0xbf6dbf353ec43f80,0x3f6d3f35bec4bf80,0xbef1bf7bbdc93f6d,0xbe953f553f46bec4,0x3e48bf6dbf0e3f35,0xbf7bbec43f553f35,0x3f46bf0ebf623ec4,0x3dc9bf7bbe953f6d
.quad 0x3f80a5d4bf80258d,0x3f80a677bf802654,0x3f463f0ebf62bec4,0x3dc93f7bbe95bf6d,0x3e483f6dbf0ebf35,0xbf7b3ec43f55bf35,0xbef13f7bbdc9bf6d,0xbe95bf553f463ec4
.quad 0xbf6d3f353ec4bf80,0x3f6dbf35bec43f80,0xbf753e483f46bf6d,0x3ef13f0ebf7f3ec4,0xbf0ebec43f7bbf35,0xbf553f6dbe48bf35,0x3dc9bf553f75bec4,0xbf22be483f62bf6d
.quad 0x3f35bf803f35a5d4,0x3f35bf803f35a69f,0x3f7fbf553e953ec4,0x3f46be48bef13f6d,0x3f55bec4be483f35,0xbf0e3f6dbf7b3f35,0x3e953e48bf223f6d,0xbf623f0ebdc9bec4
.quad 0xbec43f35bf6d3f80,0x3ec4bf353f6dbf80,0xbf623f7bbf7f3f6d,0x3f75bf553f22bec4,0xbf7b3f6dbf553f35,0xbe483ec4bf0e3f35,0xbf223f0ebef13ec4,0xbf7f3f7bbf753f6d
.quad 0x0,0x0,0x3e953e483dc90000,0x3f623f553f463f35,0x3f0e3ec43e480000,0x3f553f6d3f7b3f80,0x3f463f0e3e950000,0xbdc93e483ef13f35
.quad 0x3f6d3f353ec40000,0xbf6dbf35bec4250d,0x3f7f3f553ef10000,0xbf46bf7bbf75bf35,0x3f7b3f6d3f0e0000,0x3e48bec4bf55bf80,0x3f623f7b3f220000,0x3f753f0ebdc9bf35
.quad 0x3f353f803f350000,0x3f353f803f35a58d,0x3ef13f7b3f460000,0xbe953f0e3f7f3f35,0x3e483f6d3f550000,0xbf7bbec43f0e3f80,0xbdc93f553f620000,0xbf22bf7bbe953f35
.quad 0xbec43f353f6d0000,0x3ec4bf35bf6d25d4,0xbf223f0e3f750000,0x3f7f3e48bf62bf35,0xbf553ec43f7b0000,0x3f0e3f6dbe48bf80,0xbf753e483f7f0000,0xbef13f553f22bf35
.quad 0xbf80250d3f800000,0xbf8026303f80a60d,0xbf75be483f7f0000,0xbef1bf553f223f35,0xbf55bec43f7b0000,0x3f0ebf6dbe483f80,0xbf22bf0e3f750000,0x3f7fbe48bf623f35
.quad 0xbec4bf353f6d0000,0x3ec43f35bf6d2630,0xbdc9bf553f620000,0xbf223f7bbe95bf35,0x3e48bf6d3f550000,0xbf7b3ec43f0ebf80,0x3ef1bf7b3f460000,0xbe95bf0e3f7fbf35
.quad 0x3f35bf803f350000,0x3f35bf803f35a654,0x3f62bf7b3f220000,0x3f75bf0ebdc93f35,0x3f7bbf6d3f0e0000,0x3e483ec4bf553f80,0x3f7fbf553ef10000,0xbf463f7bbf753f35
.quad 0x3f6dbf353ec40000,0xbf6d3f35bec42677,0x3f46bf0e3e950000,0xbdc9be483ef1bf35,0x3f0ebec43e480000,0x3f55bf6d3f7bbf80,0x3e95be483dc90000,0x3f62bf553f46bf35
.quad 0x0,0x0,0x3f223f0e3ef13ec4,0x3f7f3f7b3f753f6d,0x3f7b3f6d3f553f35,0x3e483ec43f0e3f35,0x3f623f7b3f7f3f6d,0xbf75bf55bf22bec4
.quad 0x3ec43f353f6d3f80,0xbec4bf35bf6dbf80,0xbe953e483f223f6d,0x3f623f0e3dc9bec4,0xbf55bec43e483f35,0x3f0e3f6d3f7b3f35,0xbf7fbf55be953ec4,0xbf46be483ef13f6d
.quad 0xbf35bf80bf35250d,0xbf35bf80bf3525d4,0xbdc9bf55bf75bec4,0x3f22be48bf62bf6d,0x3f0ebec4bf7bbf35,0x3f553f6d3e48bf35,0x3f753e48bf46bf6d,0xbef13f0e3f7f3ec4
.quad 0x3f6d3f35bec4bf80,0xbf6dbf353ec43f80,0x3ef13f7b3dc9bf6d,0x3e95bf55bf463ec4,0xbe483f6d3f0ebf35,0x3f7b3ec4bf55bf35,0xbf463f0e3f62bec4,0xbdc93f7b3e95bf6d
.quad 0xbf8025d43f80a58d,0xbf8026773f80a654,0xbf46bf0e3f623ec4,0xbdc9bf7b3e953f6d,0xbe48bf6d3f0e3f35,0x3f7bbec4bf553f35,0x3ef1bf7b3dc93f6d,0x3e953f55bf46bec4
.quad 0x3f6dbf35bec43f80,0xbf6d3f353ec4bf80,0x3f75be48bf463f6d,0xbef1bf0e3f7fbec4,0x3f0e3ec4bf7b3f35,0x3f55bf6d3e483f35,0xbdc93f55bf753ec4,0x3f223e48bf623f6d
.quad 0xbf353f80bf3525d4,0xbf353f80bf35269f,0xbf7f3f55be95bec4,0xbf463e483ef1bf6d,0xbf553ec43e48bf35,0x3f0ebf6d3f7bbf35,0xbe95be483f22bf6d,0x3f62bf0e3dc93ec4
.quad 0x3ec4bf353f6dbf80,0xbec43f35bf6d3f80,0x3f62bf7b3f7fbf6d,0xbf753f55bf223ec4,0x3f7bbf6d3f55bf35,0x3e48bec43f0ebf35,0x3f22bf0e3ef1bec4,0x3f7fbf7b3f75bf6d
.quad 0x3f803f803f803f80,0x3f803f803f803f80,0xbe95be48bdc9248d,0xbf62bf55bf46bf35,0xbf55bf6dbf7bbf80,0x3f0e3ec43e48a554,0x3f463f0e3e95a554,0xbdc93e483ef13f35
.quad 0x3ec43f353f6d3f80,0xbec4bf35bf6dbf80,0xbf7fbf55bef125b0,0x3f463f7b3f753f35,0x3e48bec4bf55bf80,0xbf7bbf6dbf0e261f,0x3f623f7b3f22a5f7,0x3f753f0ebdc9bf35
.quad 0xbf35261f3f353f80,0xbf35a68d3f353f80,0xbef1bf7bbf46261f,0x3e95bf0ebf7fbf35,0x3f7b3ec4bf0ebf80,0x3e483f6d3f55a742,0xbdc93f553f62a731,0xbf22bf7bbe953f35
.quad 0xbf6dbf353ec43f80,0x3f6d3f35bec4bf80,0x3f22bf0ebf75a68d,0xbf7fbe483f623f35,0x3f0e3f6dbe48bf80,0x3f55bec4bf7ba60d,0xbf753e483f7fa742,0xbef13f553f22bf35
.quad 0xa754bf80a6543f80,0xa777bf80a58e3f80,0x3f753e48bf7fa654,0x3ef13f55bf22bf35,0xbf0e3f6d3e48bf80,0xbf55bec43f7ba777,0xbf22bf0e3f75a754,0x3f7fbe48bf623f35
.quad 0x3f6dbf35bec43f80,0xbf6d3f353ec4bf80,0x3dc93f55bf62a60d,0x3f22bf7b3e953f35,0xbf7b3ec43f0ebf80,0xbe483f6dbf55258d,0x3ef1bf7b3f46a765,0xbe95bf0e3f7fbf35
.quad 0x3f35a777bf353f80,0x3f35a796bf353f80,0xbf623f7bbf22a58e,0xbf753f0e3dc9bf35,0xbe48bec43f55bf80,0x3f7bbf6d3f0ea796,0x3f7fbf553ef1a777,0xbf463f7bbf753f35
.quad 0xbec43f35bf6d3f80,0x3ec4bf353f6dbf80,0xbf463f0ebe95a137,0x3dc93e48bef13f35,0x3f55bf6d3f7bbf80,0xbf0e3ec4be48268d,0x3e95be483dc9a784,0x3f62bf553f46bf35
.quad 0x3f803f803f803f80,0x3f803f803f803f80,0xbf22bf0ebef1bec4,0xbf7fbf7bbf75bf6d,0xbe48bec4bf0ebf35,0x3f7b3f6d3f553f35,0x3f623f7b3f7f3f6d,0xbf75bf55bf22bec4
.quad 0xbf6dbf35bec425b0,0x3f6d3f353ec4a5f7,0x3e95be48bf22bf6d,0xbf62bf0ebdc93ec4,0x3f0e3f6d3f7b3f35,0x3f553ec4be48bf35,0xbf7fbf55be953ec4,0xbf46be483ef13f6d
.quad 0x3f35a731bf35bf80,0x3f35a742bf35bf80,0x3dc93f553f753ec4,0xbf223e483f623f6d,0xbf55bf6dbe483f35,0x3f0ebec4bf7bbf35,0x3f753e48bf46bf6d,0xbef13f0e3f7f3ec4
.quad 0xbec43f353f6da742,0x3ec4bf35bf6da60d,0xbef1bf7bbdc93f6d,0xbe953f553f46bec4,0x3f7b3ec4bf55bf35,0x3e48bf6dbf0e3f35,0xbf463f0e3f62bec4,0xbdc93f7b3e95bf6d
.quad 0xa765bf80a60d3f80,0xa784bf80a1373f80,0x3f463f0ebf62bec4,0x3dc93f7bbe95bf6d,0xbf7b3ec43f55bf35,0xbe48bf6d3f0e3f35,0x3ef1bf7b3dc93f6d,0x3e953f55bf46bec4
.quad 0x3ec43f35bf6da58e,0xbec4bf353f6da78d,0xbf753e483f46bf6d,0x3ef13f0ebf7f3ec4,0x3f55bf6d3e483f35,0xbf0ebec43f7bbf35,0xbdc93f55bf753ec4,0x3f223e48bf623f6d
.quad 0xbf35258d3f35bf80,0xbf35268d3f35bf80,0x3f7fbf553e953ec4,0x3f46be48bef13f6d,0xbf0e3f6dbf7b3f35,0xbf553ec43e48bf35,0xbe95be483f22bf6d,0x3f62bf0e3dc93ec4
.quad 0x3f6dbf353ec4a78d,0xbf6d3f35bec42816,0xbf623f7bbf7f3f6d,0x3f75bf553f22bec4,0x3e48bec43f0ebf35,0xbf7b3f6dbf553f35,0x3f22bf0e3ef1bec4,0x3f7fbf7b3f75bf6d
.quad 0x8000800080008000,0x8000800080008000,0xbf75bf7bbf7fbf80,0xbef1bf0ebf22bf35,0x3f0e3ec43e48a50d,0x3f553f6d3f7b3f80,0x3f223f553f753f80,0xbf7fbf7bbf62bf35
.quad 0xbf6dbf35bec4258d,0x3f6d3f353ec4a5d4,0xbdc9bf0ebf62bf80,0xbf22be483e953f35,0x3f7b3f6d3f0ea5d4,0x3e48bec4bf55bf80,0xbef13e483f463f80,0x3e953f553f7f3f35
.quad 0xbf35bf80bf35260d,0xbf35bf80bf352654,0x3f623e48bf22bf80,0x3f753f553dc9bf35,0x3e483f6d3f55a630,0xbf7bbec43f0e3f80,0xbf7fbf0e3ef13f80,0x3f46be48bf75bf35
.quad 0x3ec4bf35bf6d2654,0xbec43f353f6da69f,0x3f463f55be95bf80,0xbdc9bf7bbef13f35,0xbf553ec43f7ba677,0x3f0e3f6dbe48bf80,0xbe95bf7b3dc93f80,0xbf62bf0e3f463f35
.quad 0x3f80a69fbf80268d,0x3f80270dbf8026d4,0xbe953f7b3dc9bf80,0xbf623f0e3f46bf35,0xbf55bec43f7ba69f,0x3f0ebf6dbe483f80,0x3f46bf55be953f80,0xbdc93f7bbef1bf35
.quad 0x3ec43f35bf6d26b0,0xbec4bf353f6da7c2,0xbf7f3f0e3ef1bf80,0x3f463e48bf753f35,0x3e48bf6d3f55a7b1,0xbf7b3ec43f0ebf80,0x3f62be48bf223f80,0x3f75bf553dc93f35
.quad 0xbf353f80bf3526d4,0xbf353f80bf35271f,0xbef1be483f46bf80,0x3e95bf553f7fbf35,0x3f7bbf6d3f0e270d,0x3e483ec4bf553f80,0xbdc93f0ebf623f80,0xbf223e483e95bf35
.quad 0xbf6d3f35bec426f7,0x3f6dbf353ec4268d,0x3f22bf553f75bf80,0xbf7f3f7bbf623f35,0x3f0ebec43e48a7c2,0x3f55bf6d3f7bbf80,0xbf753f7bbf7f3f80,0xbef13f0ebf223f35
.quad 0x8000800080008000,0x8000800080008000,0xbf46bf55bf62bf6d,0xbdc9be48be95bec4,0x3f7b3f6d3f553f35,0x3e483ec43f0e3f35,0xbef1be483dc93ec4,0xbe95bf0ebf46bf6d
.quad 0xbec4bf35bf6dbf80,0x3ec43f353f6d3f80,0x3f753f7b3f463ec4,0xbef1bf55bf7fbf6d,0xbf55bec43e483f35,0x3f0e3f6d3f7b3f35,0x3dc9bf0ebf75bf6d,0xbf22bf7bbf62bec4
.quad 0x3f353f803f35a630,0x3f353f803f35a677,0xbf7fbf0e3e953f6d,0xbf46bf7bbef13ec4,0x3f0ebec4bf7bbf35,0x3f553f6d3e48bf35,0x3e953f7b3f22bec4,0xbf62bf553dc93f6d
.quad 0xbf6dbf353ec43f80,0x3f6d3f35bec4bf80,0x3f62be48bf7fbec4,0xbf75bf0e3f223f6d,0xbe483f6d3f0ebf35,0x3f7b3ec4bf55bf35,0xbf22bf553ef13f6d,0xbf7fbe483f753ec4
.quad 0x3f80a7b1bf8026b0,0x3f80a7c2bf8026f7,0xbf223f553ef1bf6d,0xbf7f3e483f75bec4,0xbe48bf6d3f0e3f35,0x3f7bbec4bf553f35,0x3f623e48bf7f3ec4,0xbf753f0e3f22bf6d
.quad 0xbf6d3f353ec4bf80,0x3f6dbf35bec43f80,0x3e95bf7b3f223ec4,0xbf623f553dc9bf6d,0x3f0e3ec4bf7b3f35,0x3f55bf6d3e483f35,0xbf7f3f0e3e95bf6d,0xbf463f7bbef1bec4
.quad 0x3f35bf803f35a7c2,0x3f35bf803f35268d,0x3dc93f0ebf753f6d,0xbf223f7bbf623ec4,0xbf553ec43e48bf35,0x3f0ebf6d3f7bbf35,0x3f75bf7b3f46bec4,0xbef13f55bf7f3f6d
.quad 0xbec43f35bf6d3f80,0x3ec4bf353f6dbf80,0xbef13e483dc9bec4,0xbe953f0ebf463f6d,0x3f7bbf6d3f55bf35,0x3e48bec43f0ebf35,0xbf463f55bf623f6d,0xbdc93e48be953ec4
.quad 0x0,0x0,0x3f753f7b3f7f3f80,0x3ef13f0e3f223f35,0xbf0ebec4be48250d,0xbf55bf6dbf7bbf80,0xbf22bf55bf75bf80,0x3f7f3f7b3f623f35
.quad 0x3f6d3f353ec4a58d,0xbf6dbf35bec425d4,0x3dc93f0e3f623f80,0x3f223e48be95bf35,0xbf7bbf6dbf0e25d4,0xbe483ec43f553f80,0x3ef1be48bf46bf80,0xbe95bf55bf7fbf35
.quad 0x3f353f803f35a60d,0x3f353f803f35a654,0xbf62be483f223f80,0xbf75bf55bdc93f35,0xbe48bf6dbf552630,0x3f7b3ec4bf0ebf80,0x3f7f3f0ebef1bf80,0xbf463e483f753f35
.quad 0xbec43f353f6da654,0x3ec4bf35bf6d269f,0xbf46bf553e953f80,0x3dc93f7b3ef1bf35,0x3f55bec4bf7b2677,0xbf0ebf6d3e483f80,0x3e953f7bbdc9bf80,0x3f623f0ebf46bf35
.quad 0xbf80269f3f80a68d,0xbf80a70d3f80a6d4,0x3e95bf7bbdc93f80,0x3f62bf0ebf463f35,0x3f553ec4bf7b269f,0xbf0e3f6d3e48bf80,0xbf463f553e95bf80,0x3dc9bf7b3ef13f35
.quad 0xbec4bf353f6da6b0,0x3ec43f35bf6d27c2,0x3f7fbf0ebef13f80,0xbf46be483f75bf35,0xbe483f6dbf5527b1,0x3f7bbec4bf0e3f80,0xbf623e483f22bf80,0xbf753f55bdc9bf35
.quad 0x3f35bf803f35a6d4,0x3f35bf803f35a71f,0x3ef13e48bf463f80,0xbe953f55bf7f3f35,0xbf7b3f6dbf0ea70d,0xbe48bec43f55bf80,0x3dc9bf0e3f62bf80,0x3f22be48be953f35
.quad 0x3f6dbf353ec4a6f7,0xbf6d3f35bec4a68d,0xbf223f55bf753f80,0x3f7fbf7b3f62bf35,0xbf0e3ec4be4827c2,0xbf553f6dbf7b3f80,0x3f75bf7b3f7fbf80,0x3ef1bf0e3f22bf35
.quad 0x0,0x0,0x3f463f553f623f6d,0x3dc93e483e953ec4,0xbf7bbf6dbf55bf35,0xbe48bec4bf0ebf35,0x3ef13e48bdc9bec4,0x3e953f0e3f463f6d
.quad 0x3ec43f353f6d3f80,0xbec4bf35bf6dbf80,0xbf75bf7bbf46bec4,0x3ef13f553f7f3f6d,0x3f553ec4be48bf35,0xbf0ebf6dbf7bbf35,0xbdc93f0e3f753f6d,0x3f223f7b3f623ec4
.quad 0xbf35bf80bf352630,0xbf35bf80bf352677,0x3f7f3f0ebe95bf6d,0x3f463f7b3ef1bec4,0xbf0e3ec43f7b3f35,0xbf55bf6dbe483f35,0xbe95bf7bbf223ec4,0x3f623f55bdc9bf6d
.quad 0x3f6d3f35bec4bf80,0xbf6dbf353ec43f80,0xbf623e483f7f3ec4,0x3f753f0ebf22bf6d,0x3e48bf6dbf0e3f35,0xbf7bbec43f553f35,0x3f223f55bef1bf6d,0x3f7f3e48bf75bec4
.quad 0xbf8027b13f80a6b0,0xbf8027c23f80a6f7,0x3f22bf55bef13f6d,0x3f7fbe48bf753ec4,0x3e483f6dbf0ebf35,0xbf7b3ec43f55bf35,0xbf62be483f7fbec4,0x3f75bf0ebf223f6d
.quad 0x3f6dbf35bec43f80,0xbf6d3f353ec4bf80,0xbe953f7bbf22bec4,0x3f62bf55bdc93f6d,0xbf0ebec43f7bbf35,0xbf553f6dbe48bf35,0x3f7fbf0ebe953f6d,0x3f46bf7b3ef13ec4
.quad 0xbf353f80bf3527c2,0xbf353f80bf35a68d,0xbdc9bf0e3f75bf6d,0x3f22bf7b3f62bec4,0x3f55bec4be483f35,0xbf0e3f6dbf7b3f35,0xbf753f7bbf463ec4,0x3ef1bf553f7fbf6d
.quad 0x3ec4bf353f6dbf80,0xbec43f35bf6d3f80,0x3ef1be48bdc93ec4,0x3e95bf0e3f46bf6d,0xbf7b3f6dbf553f35,0xbe483ec4bf0e3f35,0x3f46bf553f62bf6d,0x3dc9be483e95bec4
.quad 0x3f803f803f803f80,0x3f803f803f803f80,0xbf75bf7bbf7fbf80,0xbef1bf0ebf22bf35,0x3f553f6d3f7b3f80,0xbf0ebec4be4825b0,0xbf22bf55bf75bf80,0x3f7f3f7b3f623f35
.quad 0x3ec43f353f6d3f80,0xbec4bf35bf6dbf80,0xbdc9bf0ebf62bf80,0xbf22be483e953f35,0xbe483ec43f553f80,0x3f7b3f6d3f0ea742,0x3ef1be48bf46bf80,0xbe95bf55bf7fbf35
.quad 0xbf35a6543f353f80,0xbf35a60d3f353f80,0x3f623e48bf22bf80,0x3f753f553dc9bf35,0xbf7bbec43f0e3f80,0xbe48bf6dbf55a58e,0x3f7f3f0ebef1bf80,0xbf463e483f753f35
.quad 0xbf6dbf353ec43f80,0x3f6d3f35bec4bf80,0x3f463f55be95bf80,0xbdc9bf7bbef13f35,0xbf0ebf6d3e483f80,0xbf553ec43f7ba78d,0x3e953f7bbdc9bf80,0x3f623f0ebf46bf35
.quad 0xa78dbf80258d3f80,0xa79fbf80280d3f80,0xbe953f7b3dc9bf80,0xbf623f0e3f46bf35,0x3f0ebf6dbe483f80,0x3f553ec4bf7b268d,0xbf463f553e95bf80,0x3dc9bf7b3ef13f35
.quad 0x3f6dbf35bec43f80,0xbf6d3f353ec4bf80,0xbf7f3f0e3ef1bf80,0x3f463e48bf753f35,0x3f7bbec4bf0e3f80,0x3e48bf6d3f55270d,0xbf623e483f22bf80,0xbf753f55bdc9bf35
.quad 0x3f35a7b1bf353f80,0x3f3526d4bf353f80,0xbef1be483f46bf80,0x3e95bf553f7fbf35,0x3e483ec4bf553f80,0xbf7b3f6dbf0e2828,0x3dc9bf0e3f62bf80,0x3f22be48be953f35
.quad 0xbec43f35bf6d3f80,0x3ec4bf353f6dbf80,0x3f22bf553f75bf80,0xbf7f3f7bbf623f35,0xbf553f6dbf7b3f80,0x3f0ebec43e48a7e5,0x3f75bf7b3f7fbf80,0x3ef1bf0e3f22bf35
.quad 0x3f803f803f803f80,0x3f803f803f803f80,0xbf46bf55bf62bf6d,0xbdc9be48be95bec4,0x3e483ec43f0e3f35,0xbf7bbf6dbf55bf35,0x3ef13e48bdc9bec4,0x3e953f0e3f463f6d
.quad 0xbf6dbf35bec4261f,0x3f6d3f353ec4a731,0x3f753f7b3f463ec4,0xbef1bf55bf7fbf6d,0xbf0ebf6dbf7bbf35,0xbf55bec43e483f35,0xbdc93f0e3f753f6d,0x3f223f7b3f623ec4
.quad 0x3f35a754bf35bf80,0x3f35a765bf35bf80,0xbf7fbf0e3e953f6d,0xbf46bf7bbef13ec4,0x3f553f6d3e48bf35,0xbf0e3ec43f7b3f35,0xbe95bf7bbf223ec4,0x3f623f55bdc9bf6d
.quad 0xbec43f353f6da777,0x3ec4bf35bf6d258d,0x3f62be48bf7fbec4,0xbf75bf0e3f223f6d,0xbf7bbec43f553f35,0xbe483f6d3f0ebf35,0x3f223f55bef1bf6d,0x3f7f3e48bf75bec4
.quad 0xa796bf80260d3f80,0x2731bf80268d3f80,0xbf223f553ef1bf6d,0xbf7f3e483f75bec4,0x3f7bbec4bf553f35,0x3e483f6dbf0ebf35,0xbf62be483f7fbec4,0x3f75bf0ebf223f6d
.quad 0x3ec43f35bf6d268d,0xbec4bf353f6d270d,0x3e95bf7b3f223ec4,0xbf623f553dc9bf6d,0xbf553f6dbe48bf35,0x3f0e3ec4bf7b3f35,0x3f7fbf0ebe953f6d,0x3f46bf7b3ef13ec4
.quad 0xbf35281f3f35bf80,0xbf3527303f35bf80,0x3dc93f0ebf753f6d,0xbf223f7bbf623ec4,0x3f0ebf6d3f7bbf35,0x3f55bec4be483f35,0xbf753f7bbf463ec4,0x3ef1bf553f7fbf6d
.quad 0x3f6dbf353ec426d4,0xbf6d3f35bec42754,0xbef13e483dc9bec4,0xbe953f0ebf463f6d,0xbe483ec4bf0e3f35,0x3f7bbf6d3f55bf35,0x3f46bf553f62bf6d,0x3dc9be483e95bec4
.quad 0x8000800080008000,0x8000800080008000,0x3e953e483dc9a50d,0x3f623f553f463f35,0xbf0ebec4be48258d,0xbf55bf6dbf7bbf80,0x3f463f0e3e95a5d4,0xbdc93e483ef13f35
.quad 0xbf6dbf35bec4260d,0x3f6d3f353ec4a630,0x3f7f3f553ef1a630,0xbf46bf7bbf75bf35,0xbf7bbf6dbf0e2654,0xbe483ec43f553f80,0x3f623f7b3f22a677,0x3f753f0ebdc9bf35
.quad 0xbf35bf80bf35268d,0xbf35bf80bf3526b0,0x3ef13f7b3f46a69f,0xbe953f0e3f7f3f35,0xbe48bf6dbf5526b0,0x3f7b3ec4bf0ebf80,0xbdc93f553f62a7b1,0xbf22bf7bbe953f35
.quad 0x3ec4bf35bf6d26d4,0xbec43f353f6da7c2,0xbf223f0e3f75270d,0x3f7f3e48bf62bf35,0x3f55bec4bf7b26f7,0xbf0ebf6d3e483f80,0xbf753e483f7fa7c2,0xbef13f553f22bf35
.quad 0x3f8026d4bf80270d,0x3f80268dbf802730,0xbf75be483f7f26d4,0xbef1bf553f223f35,0x3f553ec4bf7b271f,0xbf0e3f6d3e48bf80,0xbf22bf0e3f75a7d4,0x3f7fbe48bf623f35
.quad 0x3ec43f35bf6d2730,0xbec4bf353f6d260e,0xbdc9bf553f62268d,0xbf223f7bbe95bf35,0xbe483f6dbf552831,0x3f7bbec4bf0e3f80,0x3ef1bf7b3f46a7e5,0xbe95bf0e3f7fbf35
.quad 0xbf353f80bf352754,0xbf353f80bf352842,0x3f62bf7b3f22260e,0x3f75bf0ebdc93f35,0xbf7b3f6dbf0ea78d,0xbe48bec43f55bf80,0x3f7fbf553ef1a7f7,0xbf463f7bbf753f35
.quad 0xbf6d3f35bec42777,0x3f6dbf353ec4a80d,0x3f46bf0e3e9521b7,0xbdc9be483ef1bf35,0xbf0e3ec4be482842,0xbf553f6dbf7b3f80,0x3e95be483dc9a804,0x3f62bf553f46bf35
.quad 0x8000800080008000,0x8000800080008000,0x3f223f0e3ef13ec4,0x3f7f3f7b3f753f6d,0xbf7bbf6dbf55bf35,0xbe48bec4bf0ebf35,0x3f623f7b3f7f3f6d,0xbf75bf55bf22bec4
.quad 0xbec4bf35bf6dbf80,0x3ec43f353f6d3f80,0xbe953e483f223f6d,0x3f623f0e3dc9bec4,0x3f553ec4be48bf35,0xbf0ebf6dbf7bbf35,0xbf7fbf55be953ec4,0xbf46be483ef13f6d
.quad 0x3f353f803f35a69f,0x3f353f803f35a7b1,0xbdc9bf55bf75bec4,0x3f22be48bf62bf6d,0xbf0e3ec43f7b3f35,0xbf55bf6dbe483f35,0x3f753e48bf46bf6d,0xbef13f0e3f7f3ec4
.quad 0xbf6dbf353ec43f80,0x3f6d3f35bec4bf80,0x3ef13f7b3dc9bf6d,0x3e95bf55bf463ec4,0x3e48bf6dbf0e3f35,0xbf7bbec43f553f35,0xbf463f0e3f62bec4,0xbdc93f7b3e95bf6d
.quad 0x3f80a7d4bf80271f,0x3f80a7e5bf802831,0xbf46bf0e3f623ec4,0xbdc9bf7b3e953f6d,0x3e483f6dbf0ebf35,0xbf7b3ec43f55bf35,0x3ef1bf7b3dc93f6d,0x3e953f55bf46bec4
.quad 0xbf6d3f353ec4bf80,0x3f6dbf35bec43f80,0x3f75be48bf463f6d,0xbef1bf0e3f7fbec4,0xbf0ebec43f7bbf35,0xbf553f6dbe48bf35,0xbdc93f55bf753ec4,0x3f223e48bf623f6d
.quad 0x3f35bf803f35a7f7,0x3f35bf803f35a60d,0xbf7f3f55be95bec4,0xbf463e483ef1bf6d,0x3f55bec4be483f35,0xbf0e3f6dbf7b3f35,0xbe95be483f22bf6d,0x3f62bf0e3dc93ec4
.quad 0xbec43f35bf6d3f80,0x3ec4bf353f6dbf80,0x3f62bf7b3f7fbf6d,0xbf753f55bf223ec4,0xbf7b3f6dbf553f35,0xbe483ec4bf0e3f35,0x3f22bf0e3ef1bec4,0x3f7fbf7b3f75bf6d
.quad 0x0,0x0,0xbe95be48bdc9250d,0xbf62bf55bf46bf35,0x3f0e3ec43e48a58d,0x3f553f6d3f7b3f80,0xbf46bf0ebe9525d4,0x3dc9be48bef1bf35
.quad 0x3f6d3f353ec4a60d,0xbf6dbf35bec42630,0xbf7fbf55bef12630,0x3f463f7b3f753f35,0x3f7b3f6d3f0ea654,0x3e48bec4bf55bf80,0xbf62bf7bbf222677,0xbf75bf0e3dc93f35
.quad 0x3f353f803f35a68d,0x3f353f803f35a6b0,0xbef1bf7bbf46269f,0x3e95bf0ebf7fbf35,0x3e483f6d3f55a6b0,0xbf7bbec43f0e3f80,0x3dc9bf55bf6227b1,0x3f223f7b3e95bf35
.quad 0xbec43f353f6da6d4,0x3ec4bf35bf6d27c2,0x3f22bf0ebf75a70d,0xbf7fbe483f623f35,0xbf553ec43f7ba6f7,0x3f0e3f6dbe48bf80,0x3f75be48bf7f27c2,0x3ef1bf55bf223f35
.quad 0xbf80a6d43f80a70d,0xbf80a68d3f80a730,0x3f753e48bf7fa6d4,0x3ef13f55bf22bf35,0xbf55bec43f7ba71f,0x3f0ebf6dbe483f80,0x3f223f0ebf7527d4,0xbf7f3e483f62bf35
.quad 0xbec4bf353f6da730,0x3ec43f35bf6da60e,0x3dc93f55bf62a68d,0x3f22bf7b3e953f35,0x3e48bf6d3f55a831,0xbf7b3ec43f0ebf80,0xbef13f7bbf4627e5,0x3e953f0ebf7f3f35
.quad 0x3f35bf803f35a754,0x3f35bf803f35a842,0xbf623f7bbf22a60e,0xbf753f0e3dc9bf35,0x3f7bbf6d3f0e278d,0x3e483ec4bf553f80,0xbf7f3f55bef127f7,0x3f46bf7b3f75bf35
.quad 0x3f6dbf353ec4a777,0xbf6d3f35bec4280d,0xbf463f0ebe95a1b7,0x3dc93e48bef13f35,0x3f0ebec43e48a842,0x3f55bf6d3f7bbf80,0xbe953e48bdc92804,0xbf623f55bf463f35
.quad 0x0,0x0,0xbf22bf0ebef1bec4,0xbf7fbf7bbf75bf6d,0x3f7b3f6d3f553f35,0x3e483ec43f0e3f35,0xbf62bf7bbf7fbf6d,0x3f753f553f223ec4
.quad 0x3ec43f353f6d3f80,0xbec4bf35bf6dbf80,0x3e95be48bf22bf6d,0xbf62bf0ebdc93ec4,0xbf55bec43e483f35,0x3f0e3f6d3f7b3f35,0x3f7f3f553e95bec4,0x3f463e48bef1bf6d
.quad 0xbf35bf80bf35269f,0xbf35bf80bf3527b1,0x3dc93f553f753ec4,0xbf223e483f623f6d,0x3f0ebec4bf7bbf35,0x3f553f6d3e48bf35,0xbf75be483f463f6d,0x3ef1bf0ebf7fbec4
.quad 0x3f6d3f35bec4bf80,0xbf6dbf353ec43f80,0xbef1bf7bbdc93f6d,0xbe953f553f46bec4,0xbe483f6d3f0ebf35,0x3f7b3ec4bf55bf35,0x3f46bf0ebf623ec4,0x3dc9bf7bbe953f6d
.quad 0xbf8027d43f80a71f,0xbf8027e53f80a831,0x3f463f0ebf62bec4,0x3dc93f7bbe95bf6d,0xbe48bf6d3f0e3f35,0x3f7bbec4bf553f35,0xbef13f7bbdc9bf6d,0xbe95bf553f463ec4
.quad 0x3f6dbf35bec43f80,0xbf6d3f353ec4bf80,0xbf753e483f46bf6d,0x3ef13f0ebf7f3ec4,0x3f0e3ec4bf7b3f35,0x3f55bf6d3e483f35,0x3dc9bf553f75bec4,0xbf22be483f62bf6d
.quad 0xbf353f80bf3527f7,0xbf353f80bf35260d,0x3f7fbf553e953ec4,0x3f46be48bef13f6d,0xbf553ec43e48bf35,0x3f0ebf6d3f7bbf35,0x3e953e48bf223f6d,0xbf623f0ebdc9bec4
.quad 0x3ec4bf353f6dbf80,0xbec43f35bf6d3f80,0xbf623f7bbf7f3f6d,0x3f75bf553f22bec4,0x3f7bbf6d3f55bf35,0x3e48bec43f0ebf35,0xbf223f0ebef13ec4,0xbf7f3f7bbf753f6d
.quad 0x3f803f803f803f80,0x3f803f803f803f80,0x3e953e483dc9a554,0x3f623f553f463f35,0xbf55bf6dbf7bbf80,0x3f0e3ec43e48a5f7,0xbf46bf0ebe95261f,0x3dc9be48bef1bf35
.quad 0x3ec43f353f6d3f80,0xbec4bf35bf6dbf80,0x3f7f3f553ef1a742,0xbf46bf7bbf75bf35,0x3e48bec4bf55bf80,0xbf7bbf6dbf0ea60d,0xbf62bf7bbf22a60d,0xbf75bf0e3dc93f35
.quad 0xbf35a58e3f353f80,0xbf35a1373f353f80,0x3ef13f7b3f46a777,0xbe953f0e3f7f3f35,0x3f7b3ec4bf0ebf80,0x3e483f6d3f55a78d,0x3dc9bf55bf62258d,0x3f223f7b3e95bf35
.quad 0xbf6dbf353ec43f80,0x3f6d3f35bec4bf80,0xbf223f0e3f75a796,0x3f7f3e48bf62bf35,0x3f0e3f6dbe48bf80,0x3f55bec4bf7b2816,0x3f75be48bf7f268d,0x3ef1bf55bf223f35
.quad 0xa7b1bf8028163f80,0xa7c2bf80281f3f80,0xbf75be483f7fa7b1,0xbef1bf553f223f35,0xbf0e3f6d3e48bf80,0xbf55bec43f7b26d4,0x3f223f0ebf75281f,0xbf7f3e483f62bf35
.quad 0x3f6dbf35bec43f80,0xbf6d3f353ec4bf80,0xbdc9bf553f6226d4,0xbf223f7bbe95bf35,0xbf7b3ec43f0ebf80,0xbe483f6dbf552754,0xbef13f7bbf462730,0x3e953f0ebf7f3f35
.quad 0x3f35a7e5bf353f80,0x3f35a880bf353f80,0x3f62bf7b3f22a7e5,0x3f75bf0ebdc93f35,0xbe48bec43f55bf80,0x3f7bbf6d3f0ea804,0xbf7f3f55bef12839,0x3f46bf7b3f75bf35
.quad 0xbec43f35bf6d3f80,0x3ec4bf353f6dbf80,0x3f46bf0e3e95a880,0xbdc9be483ef1bf35,0x3f55bf6d3f7bbf80,0xbf0e3ec4be48a731,0xbe953e48bdc928a3,0xbf623f55bf463f35
.quad 0x3f803f803f803f80,0x3f803f803f803f80,0x3f223f0e3ef13ec4,0x3f7f3f7b3f753f6d,0xbe48bec4bf0ebf35,0x3f7b3f6d3f553f35,0xbf62bf7bbf7fbf6d,0x3f753f553f223ec4
.quad 0xbf6dbf35bec4a68d,0x3f6d3f353ec4a742,0xbe953e483f223f6d,0x3f623f0e3dc9bec4,0x3f0e3f6d3f7b3f35,0x3f553ec4be48bf35,0x3f7f3f553e95bec4,0x3f463e48bef1bf6d
.quad 0x3f35a777bf35bf80,0x3f35a784bf35bf80,0xbdc9bf55bf75bec4,0x3f22be48bf62bf6d,0xbf55bf6dbe483f35,0x3f0ebec4bf7bbf35,0xbf75be483f463f6d,0x3ef1bf0ebf7fbec4
.quad 0xbec43f353f6da796,0x3ec4bf35bf6d268d,0x3ef13f7b3dc9bf6d,0x3e95bf55bf463ec4,0x3f7b3ec4bf55bf35,0x3e48bf6dbf0e3f35,0x3f46bf0ebf623ec4,0x3dc9bf7bbe953f6d
.quad 0x270dbf8026d43f80,0x26d4bf80270d3f80,0xbf46bf0e3f623ec4,0xbdc9bf7b3e953f6d,0xbf7b3ec43f55bf35,0xbe48bf6d3f0e3f35,0xbef13f7bbdc9bf6d,0xbe95bf553f463ec4
.quad 0x3ec43f35bf6d2828,0xbec4bf353f6da7e5,0x3f75be48bf463f6d,0xbef1bf0e3f7fbec4,0x3f55bf6d3e483f35,0xbf0ebec43f7bbf35,0x3dc9bf553f75bec4,0xbf22be483f62bf6d
.quad 0xbf3528393f35bf80,0xbf3528a33f35bf80,0xbf7f3f55be95bec4,0xbf463e483ef1bf6d,0xbf0e3f6dbf7b3f35,0xbf553ec43e48bf35,0x3e953e48bf223f6d,0xbf623f0ebdc9bec4
.quad 0x3f6dbf353ec4a804,0xbf6d3f35bec4a731,0x3f62bf7b3f7fbf6d,0xbf753f55bf223ec4,0x3e48bec43f0ebf35,0xbf7b3f6dbf553f35,0xbf223f0ebef13ec4,0xbf7f3f7bbf753f6d
.quad 0x8000800080008000,0x8000800080008000,0x3f753f7b3f7f3f80,0x3ef13f0e3f223f35,0x3f0e3ec43e48a5d4,0x3f553f6d3f7b3f80,0xbf22bf55bf75bf80,0x3f7f3f7b3f623f35
.quad 0xbf6dbf35bec42654,0x3f6d3f353ec4a677,0x3dc93f0e3f623f80,0x3f223e48be95bf35,0x3f7b3f6d3f0ea69f,0x3e48bec4bf55bf80,0x3ef1be48bf46bf80,0xbe95bf55bf7fbf35
.quad 0xbf35bf80bf3526d4,0xbf35bf80bf3526f7,0xbf62be483f223f80,0xbf75bf55bdc93f35,0x3e483f6d3f55a7c2,0xbf7bbec43f0e3f80,0x3f7f3f0ebef1bf80,0xbf463e483f753f35
.quad 0x3ec4bf35bf6d271f,0xbec43f353f6d268d,0xbf46bf553e953f80,0x3dc93f7b3ef1bf35,0xbf553ec43f7b268d,0x3f0e3f6dbe48bf80,0x3e953f7bbdc9bf80,0x3f623f0ebf46bf35
.quad 0x3f80260ebf802754,0x3f8021b7bf802777,0x3e95bf7bbdc93f80,0x3f62bf0ebf463f35,0xbf55bec43f7ba7f7,0x3f0ebf6dbe483f80,0xbf463f553e95bf80,0x3dc9bf7b3ef13f35
.quad 0x3ec43f35bf6d2842,0xbec4bf353f6da80d,0x3f7fbf0ebef13f80,0xbf46be483f75bf35,0x3e48bf6d3f55a60d,0xbf7b3ec43f0ebf80,0xbf623e483f22bf80,0xbf753f55bdc9bf35
.quad 0xbf353f80bf35279f,0xbf353f80bf35a70d,0x3ef13e48bf463f80,0xbe953f55bf7f3f35,0x3f7bbf6d3f0ea816,0x3e483ec4bf553f80,0x3dc9bf0e3f62bf80,0x3f22be48be953f35
.quad 0xbf6d3f35bec4a70d,0x3f6dbf353ec4a896,0xbf223f55bf753f80,0x3f7fbf7b3f62bf35,0x3f0ebec43e48a70d,0x3f55bf6d3f7bbf80,0x3f75bf7b3f7fbf80,0x3ef1bf0e3f22bf35
.quad 0x8000800080008000,0x8000800080008000,0x3f463f553f623f6d,0x3dc93e483e953ec4,0x3f7b3f6d3f553f35,0x3e483ec43f0e3f35,0x3ef13e48bdc9bec4,0x3e953f0e3f463f6d
.quad 0xbec4bf35bf6dbf80,0x3ec43f353f6d3f80,0xbf75bf7bbf46bec4,0x3ef13f553f7f3f6d,0xbf55bec43e483f35,0x3f0e3f6d3f7b3f35,0xbdc93f0e3f753f6d,0x3f223f7b3f623ec4
.quad 0x3f353f803f35270d,0x3f353f803f35a7c2,0x3f7f3f0ebe95bf6d,0x3f463f7b3ef1bec4,0x3f0ebec4bf7bbf35,0x3f553f6d3e48bf35,0xbe95bf7bbf223ec4,0x3f623f55bdc9bf6d
.quad 0xbf6dbf353ec43f80,0x3f6d3f35bec4bf80,0xbf623e483f7f3ec4,0x3f753f0ebf22bf6d,0xbe483f6d3f0ebf35,0x3f7b3ec4bf55bf35,0x3f223f55bef1bf6d,0x3f7f3e48bf75bec4
.quad 0x3f80a7f7bf80a78d,0x3f80a804bf802842,0x3f22bf55bef13f6d,0x3f7fbe48bf753ec4,0xbe48bf6d3f0e3f35,0x3f7bbec4bf553f35,0xbf62be483f7fbec4,0x3f75bf0ebf223f6d
.quad 0xbf6d3f353ec4bf80,0x3f6dbf35bec43f80,0xbe953f7bbf22bec4,0x3f62bf55bdc93f6d,0x3f0e3ec4bf7b3f35,0x3f55bf6d3e483f35,0x3f7fbf0ebe953f6d,0x3f46bf7b3ef13ec4
.quad 0x3f35bf803f35a816,0x3f35bf803f35a70d,0xbdc9bf0e3f75bf6d,0x3f22bf7b3f62bec4,0xbf553ec43e48bf35,0x3f0ebf6d3f7bbf35,0xbf753f7bbf463ec4,0x3ef1bf553f7fbf6d
.quad 0xbec43f35bf6d3f80,0x3ec4bf353f6dbf80,0x3ef1be48bdc93ec4,0x3e95bf0e3f46bf6d,0x3f7bbf6d3f55bf35,0x3e48bec43f0ebf35,0x3f46bf553f62bf6d,0x3dc9be483e95bec4
.quad 0x0,0x0,0xbf75bf7bbf7fbf80,0xbef1bf0ebf22bf35,0xbf0ebec4be4825d4,0xbf55bf6dbf7bbf80,0x3f223f553f753f80,0xbf7fbf7bbf62bf35
.quad 0x3f6d3f353ec4a654,0xbf6dbf35bec42677,0xbdc9bf0ebf62bf80,0xbf22be483e953f35,0xbf7bbf6dbf0e269f,0xbe483ec43f553f80,0xbef13e483f463f80,0x3e953f553f7f3f35
.quad 0x3f353f803f35a6d4,0x3f353f803f35a6f7,0x3f623e48bf22bf80,0x3f753f553dc9bf35,0xbe48bf6dbf5527c2,0x3f7b3ec4bf0ebf80,0xbf7fbf0e3ef13f80,0x3f46be48bf75bf35
.quad 0xbec43f353f6da71f,0x3ec4bf35bf6da68d,0x3f463f55be95bf80,0xbdc9bf7bbef13f35,0x3f55bec4bf7ba68d,0xbf0ebf6d3e483f80,0xbe95bf7b3dc93f80,0xbf62bf0e3f463f35
.quad 0xbf80a60e3f80a754,0xbf80a1b73f80a777,0xbe953f7b3dc9bf80,0xbf623f0e3f46bf35,0x3f553ec4bf7b27f7,0xbf0e3f6d3e48bf80,0x3f46bf55be953f80,0xbdc93f7bbef1bf35
.quad 0xbec4bf353f6da842,0x3ec43f35bf6d280d,0xbf7f3f0e3ef1bf80,0x3f463e48bf753f35,0xbe483f6dbf55260d,0x3f7bbec4bf0e3f80,0x3f62be48bf223f80,0x3f75bf553dc93f35
.quad 0x3f35bf803f35a79f,0x3f35bf803f35270d,0xbef1be483f46bf80,0x3e95bf553f7fbf35,0xbf7b3f6dbf0e2816,0xbe48bec43f55bf80,0xbdc93f0ebf623f80,0xbf223e483e95bf35
.quad 0x3f6dbf353ec4270d,0xbf6d3f35bec42896,0x3f22bf553f75bf80,0xbf7f3f7bbf623f35,0xbf0e3ec4be48270d,0xbf553f6dbf7b3f80,0xbf753f7bbf7f3f80,0xbef13f0ebf223f35
.quad 0x0,0x0,0xbf46bf55bf62bf6d,0xbdc9be48be95bec4,0xbf7bbf6dbf55bf35,0xbe48bec4bf0ebf35,0xbef1be483dc93ec4,0xbe95bf0ebf46bf6d
.quad 0x3ec43f353f6d3f80,0xbec4bf35bf6dbf80,0x3f753f7b3f463ec4,0xbef1bf55bf7fbf6d,0x3f553ec4be48bf35,0xbf0ebf6dbf7bbf35,0x3dc9bf0ebf75bf6d,0xbf22bf7bbf62bec4
.quad 0xbf35bf80bf35a70d,0xbf35bf80bf3527c2,0xbf7fbf0e3e953f6d,0xbf46bf7bbef13ec4,0xbf0e3ec43f7b3f35,0xbf55bf6dbe483f35,0x3e953f7b3f22bec4,0xbf62bf553dc93f6d
.quad 0x3f6d3f35bec4bf80,0xbf6dbf353ec43f80,0x3f62be48bf7fbec4,0xbf75bf0e3f223f6d,0x3e48bf6dbf0e3f35,0xbf7bbec43f553f35,0xbf22bf553ef13f6d,0xbf7fbe483f753ec4
.quad 0xbf8027f73f80278d,0xbf8028043f80a842,0xbf223f553ef1bf6d,0xbf7f3e483f75bec4,0x3e483f6dbf0ebf35,0xbf7b3ec43f55bf35,0x3f623e48bf7f3ec4,0xbf753f0e3f22bf6d
.quad 0x3f6dbf35bec43f80,0xbf6d3f353ec4bf80,0x3e95bf7b3f223ec4,0xbf623f553dc9bf6d,0xbf0ebec43f7bbf35,0xbf553f6dbe48bf35,0xbf7f3f0e3e95bf6d,0xbf463f7bbef1bec4
.quad 0xbf353f80bf352816,0xbf353f80bf35270d,0x3dc93f0ebf753f6d,0xbf223f7bbf623ec4,0x3f55bec4be483f35,0xbf0e3f6dbf7b3f35,0x3f75bf7b3f46bec4,0xbef13f55bf7f3f6d
.quad 0x3ec4bf353f6dbf80,0xbec43f35bf6d3f80,0xbef13e483dc9bec4,0xbe953f0ebf463f6d,0xbf7b3f6dbf553f35,0xbe483ec4bf0e3f35,0xbf463f55bf623f6d,0xbdc93e48be953ec4
.quad 0xbf803f80bf803f80,0xbf803f80bf803f80,0xbf753f7bbf7f3f80,0xbef13f0ebf223f35,0xbf553f6dbf7b3f80,0x3f0ebec43e48a654,0xbf223f55bf753f80,0x3f7fbf7b3f62bf35
.quad 0xbec43f35bf6d3f80,0x3ec4bf353f6dbf80,0xbdc93f0ebf623f80,0xbf223e483e95bf35,0x3e483ec4bf553f80,0xbf7b3f6dbf0ea754,0x3ef13e48bf463f80,0xbe953f55bf7f3f35
.quad 0x3f3525b0bf353f80,0x3f35a58ebf353f80,0x3f62be48bf223f80,0x3f75bf553dc93f35,0x3f7bbec4bf0e3f80,0x3e48bf6d3f55a60d,0x3f7fbf0ebef13f80,0xbf46be483f75bf35
.quad 0x3f6dbf35bec43f80,0xbf6d3f353ec4bf80,0x3f46bf55be953f80,0xbdc93f7bbef1bf35,0x3f0ebf6dbe483f80,0x3f553ec4bf7ba765,0x3e95bf7bbdc93f80,0x3f62bf0ebf463f35
.quad 0x261fbf80a5543f80,0x258dbf80a7773f80,0xbe95bf7b3dc93f80,0xbf62bf0e3f463f35,0xbf0ebf6d3e483f80,0xbf553ec43f7ba58e,0xbf46bf553e953f80,0x3dc93f7b3ef1bf35
.quad 0xbf6dbf353ec43f80,0x3f6d3f35bec4bf80,0xbf7fbf0e3ef13f80,0x3f46be48bf75bf35,0xbf7bbec43f0e3f80,0xbe48bf6dbf55a777,0xbf62be483f223f80,0xbf75bf55bdc93f35
.quad 0xbf35a5f73f353f80,0xbf35a78d3f353f80,0xbef13e483f463f80,0x3e953f553f7f3f35,0xbe483ec43f553f80,0x3f7b3f6d3f0ea137,0x3dc93f0e3f623f80,0x3f223e48be95bf35
.quad 0x3ec43f353f6d3f80,0xbec4bf35bf6dbf80,0x3f223f553f753f80,0xbf7fbf7bbf62bf35,0x3f553f6d3f7b3f80,0xbf0ebec4be48a784,0x3f753f7b3f7f3f80,0x3ef13f0e3f223f35
.quad 0xbf803f80bf803f80,0xbf803f80bf803f80,0xbf463f55bf623f6d,0xbdc93e48be953ec4,0xbe483ec4bf0e3f35,0x3f7bbf6d3f55bf35,0x3ef1be48bdc93ec4,0x3e95bf0e3f46bf6d
.quad 0x3f6dbf353ec4261f,0xbf6d3f35bec4a777,0x3f75bf7b3f46bec4,0xbef13f55bf7f3f6d,0x3f0ebf6d3f7bbf35,0x3f55bec4be483f35,0xbdc9bf0e3f75bf6d,0x3f22bf7b3f62bec4
.quad 0xbf35a7423f35bf80,0xbf35a78d3f35bf80,0xbf7f3f0e3e95bf6d,0xbf463f7bbef1bec4,0xbf553f6dbe48bf35,0x3f0e3ec4bf7b3f35,0xbe953f7bbf22bec4,0x3f62bf55bdc93f6d
.quad 0x3ec43f35bf6da731,0xbec4bf353f6d258d,0x3f623e48bf7f3ec4,0xbf753f0e3f22bf6d,0x3f7bbec4bf553f35,0x3e483f6dbf0ebf35,0x3f22bf55bef13f6d,0x3f7fbe48bf753ec4
.quad 0xa60dbf80a7423f80,0x268dbf80a7963f80,0xbf22bf553ef13f6d,0xbf7fbe483f753ec4,0xbf7bbec43f553f35,0xbe483f6d3f0ebf35,0xbf623e483f7f3ec4,0x3f753f0ebf22bf6d
.quad 0xbec43f353f6da68d,0x3ec4bf35bf6da796,0x3e953f7b3f22bec4,0xbf62bf553dc93f6d,0x3f553f6d3e48bf35,0xbf0e3ec43f7b3f35,0x3f7f3f0ebe95bf6d,0x3f463f7b3ef1bec4
.quad 0x3f35a60dbf35bf80,0x3f352816bf35bf80,0x3dc9bf0ebf75bf6d,0xbf22bf7bbf62bec4,0xbf0ebf6dbf7bbf35,0xbf55bec43e483f35,0xbf75bf7bbf46bec4,0x3ef13f553f7f3f6d
.quad 0xbf6dbf35bec4a742,0x3f6d3f353ec4268d,0xbef1be483dc93ec4,0xbe95bf0ebf46bf6d,0x3e483ec43f0e3f35,0xbf7bbf6dbf55bf35,0x3f463f553f623f6d,0x3dc93e483e953ec4
.quad 0xa5d4258da50d8000,0xa7b126b0a69f268d,0x3e95be483dc98000,0x3f62bf553f46bf35,0x3f0ebec43e488000,0x3f55bf6d3f7bbf80,0x3f46bf0e3e958000,0xbdc9be483ef1bf35
.quad 0x3f6dbf353ec48000,0xbf6d3f35bec4a69f,0x3f7fbf553ef18000,0xbf463f7bbf753f35,0x3f7bbf6d3f0e8000,0x3e483ec4bf553f80,0x3f62bf7b3f228000,0x3f75bf0ebdc93f35
.quad 0x3f35bf803f358000,0x3f35bf803f3526b0,0x3ef1bf7b3f468000,0xbe95bf0e3f7fbf35,0x3e48bf6d3f558000,0xbf7b3ec43f0ebf80,0xbdc9bf553f628000,0xbf223f7bbe95bf35
.quad 0xbec4bf353f6d8000,0x3ec43f35bf6da7b1,0xbf22bf0e3f758000,0x3f7fbe48bf623f35,0xbf55bec43f7b8000,0x3f0ebf6dbe483f80,0xbf75be483f7f8000,0xbef1bf553f223f35
.quad 0xbf80a5d43f808000,0xbf80a7c23f8026d4,0xbf753e483f7f8000,0xbef13f553f22bf35,0xbf553ec43f7b8000,0x3f0e3f6dbe48bf80,0xbf223f0e3f758000,0x3f7f3e48bf62bf35
.quad 0xbec43f353f6d8000,0x3ec4bf35bf6d270d,0xbdc93f553f628000,0xbf22bf7bbe953f35,0x3e483f6d3f558000,0xbf7bbec43f0e3f80,0x3ef13f7b3f468000,0xbe953f0e3f7f3f35
.quad 0x3f353f803f358000,0x3f353f803f3526f7,0x3f623f7b3f228000,0x3f753f0ebdc9bf35,0x3f7b3f6d3f0e8000,0x3e48bec4bf55bf80,0x3f7f3f553ef18000,0xbf46bf7bbf75bf35
.quad 0x3f6d3f353ec48000,0xbf6dbf35bec4a7c2,0x3f463f0e3e958000,0xbdc93e483ef13f35,0x3f0e3ec43e488000,0x3f553f6d3f7b3f80,0x3e953e483dc98000,0x3f623f553f463f35
.quad 0xa6772654a630260d,0xa7c226f7270d26d4,0x3f22bf0e3ef1bec4,0x3f7fbf7b3f75bf6d,0x3f7bbf6d3f55bf35,0x3e48bec43f0ebf35,0x3f62bf7b3f7fbf6d,0xbf753f55bf223ec4
.quad 0x3ec4bf353f6dbf80,0xbec43f35bf6d3f80,0xbe95be483f22bf6d,0x3f62bf0e3dc93ec4,0xbf553ec43e48bf35,0x3f0ebf6d3f7bbf35,0xbf7f3f55be95bec4,0xbf463e483ef1bf6d
.quad 0xbf353f80bf35a630,0xbf353f80bf35a7c2,0xbdc93f55bf753ec4,0x3f223e48bf623f6d,0x3f0e3ec4bf7b3f35,0x3f55bf6d3e483f35,0x3f75be48bf463f6d,0xbef1bf0e3f7fbec4
.quad 0x3f6dbf35bec43f80,0xbf6d3f353ec4bf80,0x3ef1bf7b3dc93f6d,0x3e953f55bf46bec4,0xbe48bf6d3f0e3f35,0x3f7bbec4bf553f35,0xbf46bf0e3f623ec4,0xbdc9bf7b3e953f6d
.quad 0xbf80a69f3f802654,0xbf80268d3f80271f,0xbf463f0e3f62bec4,0xbdc93f7b3e95bf6d,0xbe483f6d3f0ebf35,0x3f7b3ec4bf55bf35,0x3ef13f7b3dc9bf6d,0x3e95bf55bf463ec4
.quad 0x3f6d3f35bec4bf80,0xbf6dbf353ec43f80,0x3f753e48bf46bf6d,0xbef13f0e3f7f3ec4,0x3f0ebec4bf7bbf35,0x3f553f6d3e48bf35,0xbdc9bf55bf75bec4,0x3f22be48bf62bf6d
.quad 0xbf35bf80bf35a677,0xbf35bf80bf35268d,0xbf7fbf55be953ec4,0xbf46be483ef13f6d,0xbf55bec43e483f35,0x3f0e3f6d3f7b3f35,0xbe953e483f223f6d,0x3f623f0e3dc9bec4
.quad 0x3ec43f353f6d3f80,0xbec4bf35bf6dbf80,0x3f623f7b3f7f3f6d,0xbf75bf55bf22bec4,0x3f7b3f6d3f553f35,0x3e483ec43f0e3f35,0x3f223f0e3ef13ec4,0x3f7f3f7b3f753f6d
.quad 0x25d4a58d250d0000,0x27b1a6b0269fa68d,0xbe953e48bdc90000,0xbf623f55bf463f35,0xbf0e3ec4be480000,0xbf553f6dbf7b3f80,0xbf463f0ebe950000,0x3dc93e48bef13f35
.quad 0xbf6d3f35bec40000,0x3f6dbf353ec4269f,0xbf7f3f55bef10000,0x3f46bf7b3f75bf35,0xbf7b3f6dbf0e0000,0xbe48bec43f55bf80,0xbf623f7bbf220000,0xbf753f0e3dc9bf35
.quad 0xbf353f80bf350000,0xbf353f80bf35a6b0,0xbef13f7bbf460000,0x3e953f0ebf7f3f35,0xbe483f6dbf550000,0x3f7bbec4bf0e3f80,0x3dc93f55bf620000,0x3f22bf7b3e953f35
.quad 0x3ec43f35bf6d0000,0xbec4bf353f6d27b1,0x3f223f0ebf750000,0xbf7f3e483f62bf35,0x3f553ec4bf7b0000,0xbf0e3f6d3e48bf80,0x3f753e48bf7f0000,0x3ef13f55bf22bf35
.quad 0x3f8025d4bf800000,0x3f8027c2bf80a6d4,0x3f75be48bf7f0000,0x3ef1bf55bf223f35,0x3f55bec4bf7b0000,0xbf0ebf6d3e483f80,0x3f22bf0ebf750000,0xbf7fbe483f623f35
.quad 0x3ec4bf35bf6d0000,0xbec43f353f6da70d,0x3dc9bf55bf620000,0x3f223f7b3e95bf35,0xbe48bf6dbf550000,0x3f7b3ec4bf0ebf80,0xbef1bf7bbf460000,0x3e95bf0ebf7fbf35
.quad 0xbf35bf80bf350000,0xbf35bf80bf35a6f7,0xbf62bf7bbf220000,0xbf75bf0e3dc93f35,0xbf7bbf6dbf0e0000,0xbe483ec43f553f80,0xbf7fbf55bef10000,0x3f463f7b3f753f35
.quad 0xbf6dbf35bec40000,0x3f6d3f353ec427c2,0xbf46bf0ebe950000,0x3dc9be48bef1bf35,0xbf0ebec4be480000,0xbf55bf6dbf7bbf80,0xbe95be48bdc90000,0xbf62bf55bf46bf35
.quad 0x2677a6542630a60d,0x27c2a6f7a70da6d4,0xbf223f0ebef13ec4,0xbf7f3f7bbf753f6d,0xbf7b3f6dbf553f35,0xbe483ec4bf0e3f35,0xbf623f7bbf7f3f6d,0x3f75bf553f22bec4
.quad 0xbec43f35bf6d3f80,0x3ec4bf353f6dbf80,0x3e953e48bf223f6d,0xbf623f0ebdc9bec4,0x3f55bec4be483f35,0xbf0e3f6dbf7b3f35,0x3f7fbf553e953ec4,0x3f46be48bef13f6d
.quad 0x3f35bf803f352630,0x3f35bf803f3527c2,0x3dc9bf553f75bec4,0xbf22be483f62bf6d,0xbf0ebec43f7bbf35,0xbf553f6dbe48bf35,0xbf753e483f46bf6d,0x3ef13f0ebf7f3ec4
.quad 0xbf6d3f353ec4bf80,0x3f6dbf35bec43f80,0xbef13f7bbdc9bf6d,0xbe95bf553f463ec4,0x3e483f6dbf0ebf35,0xbf7b3ec43f55bf35,0x3f463f0ebf62bec4,0x3dc93f7bbe95bf6d
.quad 0x3f80269fbf80a654,0x3f80a68dbf80a71f,0x3f46bf0ebf623ec4,0x3dc9bf7bbe953f6d,0x3e48bf6dbf0e3f35,0xbf7bbec43f553f35,0xbef1bf7bbdc93f6d,0xbe953f553f46bec4
.quad 0xbf6dbf353ec43f80,0x3f6d3f35bec4bf80,0xbf75be483f463f6d,0x3ef1bf0ebf7fbec4,0xbf0e3ec43f7b3f35,0xbf55bf6dbe483f35,0x3dc93f553f753ec4,0xbf223e483f623f6d
.quad 0x3f353f803f352677,0x3f353f803f35a68d,0x3f7f3f553e95bec4,0x3f463e48bef1bf6d,0x3f553ec4be48bf35,0xbf0ebf6dbf7bbf35,0x3e95be48bf22bf6d,0xbf62bf0ebdc93ec4
.quad 0xbec4bf35bf6dbf80,0x3ec43f353f6d3f80,0xbf62bf7bbf7fbf6d,0x3f753f553f223ec4,0xbf7bbf6dbf55bf35,0xbe48bec4bf0ebf35,0xbf22bf0ebef1bec4,0xbf7fbf7bbf75bf6d
.quad 0xbf803f80bf803f80,0xbf803f80bf803f80,0x3e95be483dc9258d,0x3f62bf553f46bf35,0x3f55bf6d3f7bbf80,0xbf0e3ec4be48a7b1,0xbf463f0ebe95a78d,0x3dc93e48bef13f35
.quad 0xbec43f35bf6d3f80,0x3ec4bf353f6dbf80,0x3f7fbf553ef1260d,0xbf463f7bbf753f35,0xbe48bec43f55bf80,0x3f7bbf6d3f0e281f,0xbf623f7bbf22a796,0xbf753f0e3dc9bf35
.quad 0x3f35268dbf353f80,0x3f352828bf353f80,0x3ef1bf7b3f46280d,0xbe95bf0e3f7fbf35,0xbf7b3ec43f0ebf80,0xbe483f6dbf5526d4,0x3dc93f55bf62a79f,0x3f22bf7b3e953f35
.quad 0x3f6dbf35bec43f80,0xbf6d3f353ec4bf80,0xbf22bf0e3f75268d,0x3f7fbe48bf623f35,0xbf0e3f6d3e48bf80,0xbf55bec43f7b2730,0x3f753e48bf7f2731,0x3ef13f55bf22bf35
.quad 0x281fbf80a7b13f80,0x2839bf80a7e53f80,0xbf753e483f7f2816,0xbef13f553f22bf35,0x3f0e3f6dbe48bf80,0x3f55bec4bf7ba7e5,0x3f22bf0ebf75a7b1,0xbf7fbe483f623f35
.quad 0xbf6dbf353ec43f80,0x3f6d3f35bec4bf80,0xbdc93f553f6226d4,0xbf22bf7bbe953f35,0x3f7b3ec4bf0ebf80,0x3e483f6d3f552839,0xbef1bf7bbf46270d,0x3e95bf0ebf7fbf35
.quad 0xbf3526d43f353f80,0xbf35a8043f353f80,0x3f623f7b3f22281f,0x3f753f0ebdc9bf35,0x3e48bec4bf55bf80,0xbf7bbf6dbf0ea880,0xbf7fbf55bef1a7c2,0x3f463f7b3f753f35
.quad 0x3ec43f353f6d3f80,0xbec4bf35bf6dbf80,0x3f463f0e3e95270d,0xbdc93e483ef13f35,0xbf55bf6dbf7bbf80,0x3f0e3ec43e4828a3,0xbe95be48bdc926d4,0xbf62bf55bf46bf35
.quad 0xbf803f80bf803f80,0xbf803f80bf803f80,0x3f22bf0e3ef1bec4,0x3f7fbf7b3f75bf6d,0x3e48bec43f0ebf35,0xbf7b3f6dbf553f35,0xbf623f7bbf7f3f6d,0x3f75bf553f22bec4
.quad 0x3f6dbf353ec4268d,0xbf6d3f35bec426d4,0xbe95be483f22bf6d,0x3f62bf0e3dc93ec4,0xbf0e3f6dbf7b3f35,0xbf553ec43e48bf35,0x3f7fbf553e953ec4,0x3f46be48bef13f6d
.quad 0xbf35270d3f35bf80,0xbf35a7e53f35bf80,0xbdc93f55bf753ec4,0x3f223e48bf623f6d,0x3f55bf6d3e483f35,0xbf0ebec43f7bbf35,0xbf753e483f46bf6d,0x3ef13f0ebf7f3ec4
.quad 0x3ec43f35bf6d270d,0xbec4bf353f6d2754,0x3ef1bf7b3dc93f6d,0x3e953f55bf46bec4,0xbf7b3ec43f55bf35,0xbe48bf6d3f0e3f35,0x3f463f0ebf62bec4,0x3dc93f7bbe95bf6d
.quad 0x2730bf8026d43f80,0x28a3bf80a8803f80,0xbf463f0e3f62bec4,0xbdc93f7b3e95bf6d,0x3f7b3ec4bf55bf35,0x3e48bf6dbf0e3f35,0xbef1bf7bbdc93f6d,0xbe953f553f46bec4
.quad 0xbec43f353f6d2828,0x3ec4bf35bf6da804,0x3f753e48bf46bf6d,0xbef13f0e3f7f3ec4,0xbf55bf6dbe483f35,0x3f0ebec4bf7bbf35,0x3dc93f553f753ec4,0xbf223e483f623f6d
.quad 0x3f352754bf35bf80,0x3f35a731bf35bf80,0xbf7fbf55be953ec4,0xbf46be483ef13f6d,0x3f0e3f6d3f7b3f35,0x3f553ec4be48bf35,0x3e95be48bf22bf6d,0xbf62bf0ebdc93ec4
.quad 0xbf6dbf35bec4a7e5,0x3f6d3f353ec4a731,0x3f623f7b3f7f3f6d,0xbf75bf55bf22bec4,0xbe48bec4bf0ebf35,0x3f7b3f6d3f553f35,0xbf22bf0ebef1bec4,0xbf7fbf7bbf75bf6d
.quad 0xa7d4271f26d4270d,0xa7f7a78d260e2754,0x3f75bf7b3f7fbf80,0x3ef1bf0e3f22bf35,0xbf0e3ec4be4826d4,0xbf553f6dbf7b3f80,0xbf223f55bf753f80,0x3f7fbf7b3f62bf35
.quad 0x3f6dbf353ec4271f,0xbf6d3f35bec4a7f7,0x3dc9bf0e3f62bf80,0x3f22be48be953f35,0xbf7b3f6dbf0ea7d4,0xbe48bec43f55bf80,0x3ef13e48bf463f80,0xbe953f55bf7f3f35
.quad 0x3f35bf803f352730,0x3f35bf803f352842,0xbf623e483f22bf80,0xbf753f55bdc9bf35,0xbe483f6dbf55268d,0x3f7bbec4bf0e3f80,0x3f7fbf0ebef13f80,0xbf46be483f75bf35
.quad 0xbec4bf353f6d2831,0x3ec43f35bf6da60d,0xbf463f553e95bf80,0x3dc9bf7b3ef13f35,0x3f553ec4bf7ba7e5,0xbf0e3f6d3e48bf80,0x3e95bf7bbdc93f80,0x3f62bf0ebf463f35
.quad 0xbf80a7f73f802754,0xbf80a8163f80279f,0x3e953f7bbdc9bf80,0x3f623f0ebf46bf35,0x3f55bec4bf7b260e,0xbf0ebf6d3e483f80,0xbf46bf553e953f80,0x3dc93f7b3ef1bf35
.quad 0xbec43f353f6da78d,0x3ec4bf35bf6da816,0x3f7f3f0ebef1bf80,0xbf463e483f753f35,0xbe48bf6dbf55a7f7,0x3f7b3ec4bf0ebf80,0xbf62be483f223f80,0xbf75bf55bdc93f35
.quad 0x3f353f803f352777,0x3f353f803f35a70d,0x3ef1be48bf46bf80,0xbe95bf55bf7fbf35,0xbf7bbf6dbf0e21b7,0xbe483ec43f553f80,0x3dc93f0e3f623f80,0x3f223e48be95bf35
.quad 0x3f6d3f353ec42842,0xbf6dbf35bec4a70d,0xbf22bf55bf75bf80,0x3f7f3f7b3f623f35,0xbf0ebec4be48a804,0xbf55bf6dbf7bbf80,0x3f753f7b3f7f3f80,0x3ef13f0e3f223f35
.quad 0xa7e52831268d2730,0xa804284221b72777,0x3f46bf553f62bf6d,0x3dc9be483e95bec4,0xbf7b3f6dbf553f35,0xbe483ec4bf0e3f35,0x3ef1be48bdc93ec4,0x3e95bf0e3f46bf6d
.quad 0x3ec4bf353f6dbf80,0xbec43f35bf6d3f80,0xbf753f7bbf463ec4,0x3ef1bf553f7fbf6d,0x3f55bec4be483f35,0xbf0e3f6dbf7b3f35,0xbdc9bf0e3f75bf6d,0x3f22bf7b3f62bec4
.quad 0xbf353f80bf35260e,0xbf353f80bf35a80d,0x3f7fbf0ebe953f6d,0x3f46bf7b3ef13ec4,0xbf0ebec43f7bbf35,0xbf553f6dbe48bf35,0xbe953f7bbf22bec4,0x3f62bf55bdc93f6d
.quad 0x3f6dbf35bec43f80,0xbf6d3f353ec4bf80,0xbf62be483f7fbec4,0x3f75bf0ebf223f6d,0x3e483f6dbf0ebf35,0xbf7b3ec43f55bf35,0x3f22bf55bef13f6d,0x3f7fbe48bf753ec4
.quad 0xbf80a60d3f802842,0xbf80a70d3f80a70d,0x3f223f55bef1bf6d,0x3f7f3e48bf75bec4,0x3e48bf6dbf0e3f35,0xbf7bbec43f553f35,0xbf623e483f7f3ec4,0x3f753f0ebf22bf6d
.quad 0x3f6d3f35bec4bf80,0xbf6dbf353ec43f80,0xbe95bf7bbf223ec4,0x3f623f55bdc9bf6d,0xbf0e3ec43f7b3f35,0xbf55bf6dbe483f35,0x3f7f3f0ebe95bf6d,0x3f463f7b3ef1bec4
.quad 0xbf35bf80bf35a80d,0xbf35bf80bf35a896,0xbdc93f0e3f753f6d,0x3f223f7b3f623ec4,0x3f553ec4be48bf35,0xbf0ebf6dbf7bbf35,0xbf75bf7bbf46bec4,0x3ef13f553f7f3f6d
.quad 0x3ec43f353f6d3f80,0xbec4bf35bf6dbf80,0x3ef13e48bdc9bec4,0x3e953f0e3f463f6d,0xbf7bbf6dbf55bf35,0xbe48bec4bf0ebf35,0x3f463f553f623f6d,0x3dc93e483e953ec4
.quad 0x27d4a71fa6d4a70d,0x27f7278da60ea754,0xbf753f7bbf7f3f80,0xbef13f0ebf223f35,0x3f0ebec43e48a6d4,0x3f55bf6d3f7bbf80,0x3f22bf553f75bf80,0xbf7f3f7bbf623f35
.quad 0xbf6d3f35bec4a71f,0x3f6dbf353ec427f7,0xbdc93f0ebf623f80,0xbf223e483e95bf35,0x3f7bbf6d3f0e27d4,0x3e483ec4bf553f80,0xbef1be483f46bf80,0x3e95bf553f7fbf35
.quad 0xbf353f80bf35a730,0xbf353f80bf35a842,0x3f62be48bf223f80,0x3f75bf553dc93f35,0x3e48bf6d3f55a68d,0xbf7b3ec43f0ebf80,0xbf7f3f0e3ef1bf80,0x3f463e48bf753f35
.quad 0x3ec43f35bf6da831,0xbec4bf353f6d260d,0x3f46bf55be953f80,0xbdc93f7bbef1bf35,0xbf55bec43f7b27e5,0x3f0ebf6dbe483f80,0xbe953f7b3dc9bf80,0xbf623f0e3f46bf35
.quad 0x3f8027f7bf80a754,0x3f802816bf80a79f,0xbe95bf7b3dc93f80,0xbf62bf0e3f463f35,0xbf553ec43f7ba60e,0x3f0e3f6dbe48bf80,0x3f463f55be95bf80,0xbdc9bf7bbef13f35
.quad 0x3ec4bf35bf6d278d,0xbec43f353f6d2816,0xbf7fbf0e3ef13f80,0x3f46be48bf75bf35,0x3e483f6d3f5527f7,0xbf7bbec43f0e3f80,0x3f623e48bf22bf80,0x3f753f553dc9bf35
.quad 0xbf35bf80bf35a777,0xbf35bf80bf35270d,0xbef13e483f463f80,0x3e953f553f7f3f35,0x3f7b3f6d3f0ea1b7,0x3e48bec4bf55bf80,0xbdc9bf0ebf62bf80,0xbf22be483e953f35
.quad 0xbf6dbf35bec4a842,0x3f6d3f353ec4270d,0x3f223f553f753f80,0xbf7fbf7bbf62bf35,0x3f0e3ec43e482804,0x3f553f6d3f7b3f80,0xbf75bf7bbf7fbf80,0xbef1bf0ebf22bf35
.quad 0x27e5a831a68da730,0x2804a842a1b7a777,0xbf463f55bf623f6d,0xbdc93e48be953ec4,0x3f7bbf6d3f55bf35,0x3e48bec43f0ebf35,0xbef13e483dc9bec4,0xbe953f0ebf463f6d
.quad 0xbec43f35bf6d3f80,0x3ec4bf353f6dbf80,0x3f75bf7b3f46bec4,0xbef13f55bf7f3f6d,0xbf553ec43e48bf35,0x3f0ebf6d3f7bbf35,0x3dc93f0ebf753f6d,0xbf223f7bbf623ec4
.quad 0x3f35bf803f35a60e,0x3f35bf803f35280d,0xbf7f3f0e3e95bf6d,0xbf463f7bbef1bec4,0x3f0e3ec4bf7b3f35,0x3f55bf6d3e483f35,0x3e95bf7b3f223ec4,0xbf623f553dc9bf6d
.quad 0xbf6d3f353ec4bf80,0x3f6dbf35bec43f80,0x3f623e48bf7f3ec4,0xbf753f0e3f22bf6d,0xbe48bf6d3f0e3f35,0x3f7bbec4bf553f35,0xbf223f553ef1bf6d,0xbf7f3e483f75bec4
.quad 0x3f80260dbf80a842,0x3f80270dbf80270d,0xbf22bf553ef13f6d,0xbf7fbe483f753ec4,0xbe483f6d3f0ebf35,0x3f7b3ec4bf55bf35,0x3f62be48bf7fbec4,0xbf75bf0e3f223f6d
.quad 0xbf6dbf353ec43f80,0x3f6d3f35bec4bf80,0x3e953f7b3f22bec4,0xbf62bf553dc93f6d,0x3f0ebec4bf7bbf35,0x3f553f6d3e48bf35,0xbf7fbf0e3e953f6d,0xbf46bf7bbef13ec4
.quad 0x3f353f803f35280d,0x3f353f803f352896,0x3dc9bf0ebf75bf6d,0xbf22bf7bbf62bec4,0xbf55bec43e483f35,0x3f0e3f6d3f7b3f35,0x3f753f7b3f463ec4,0xbef1bf55bf7fbf6d
.quad 0xbec4bf35bf6dbf80,0x3ec43f353f6d3f80,0xbef1be483dc93ec4,0xbe95bf0ebf46bf6d,0x3f7b3f6d3f553f35,0x3e483ec43f0e3f35,0xbf46bf55bf62bf6d,0xbdc9be48be95bec4
.quad 0xbf803f80bf803f80,0xbf803f80bf803f80,0x3f75bf7b3f7fbf80,0x3ef1bf0e3f22bf35,0xbf553f6dbf7b3f80,0x3f0ebec43e482777,0x3f22bf553f75bf80,0xbf7f3f7bbf623f35
.quad 0xbec43f35bf6d3f80,0x3ec4bf353f6dbf80,0x3dc9bf0e3f62bf80,0x3f22be48be953f35,0x3e483ec4bf553f80,0xbf7b3f6dbf0ea60d,0xbef1be483f46bf80,0x3e95bf553f7fbf35
.quad 0x3f352777bf353f80,0x3f35a731bf353f80,0xbf623e483f22bf80,0xbf753f55bdc9bf35,0x3f7bbec4bf0e3f80,0x3e48bf6d3f55a731,0xbf7f3f0e3ef1bf80,0x3f463e48bf753f35
.quad 0x3f6dbf35bec43f80,0xbf6d3f353ec4bf80,0xbf463f553e95bf80,0x3dc9bf7b3ef13f35,0x3f0ebf6dbe483f80,0x3f553ec4bf7b27c2,0xbe953f7b3dc9bf80,0xbf623f0e3f46bf35
.quad 0xa731bf8027e63f80,0x286ebf80a8283f80,0x3e953f7bbdc9bf80,0x3f623f0ebf46bf35,0xbf0ebf6d3e483f80,0xbf553ec43f7b28b5,0x3f463f55be95bf80,0xbdc9bf7bbef13f35
.quad 0xbf6dbf353ec43f80,0x3f6d3f35bec4bf80,0x3f7f3f0ebef1bf80,0xbf463e483f753f35,0xbf7bbec43f0e3f80,0xbe48bf6dbf55a89a,0x3f623e48bf22bf80,0x3f753f553dc9bf35
.quad 0xbf35a8923f353f80,0xbf3527773f353f80,0x3ef1be48bf46bf80,0xbe95bf55bf7fbf35,0xbe483ec43f553f80,0x3f7b3f6d3f0e2880,0xbdc9bf0ebf62bf80,0xbf22be483e953f35
.quad 0x3ec43f353f6d3f80,0xbec4bf35bf6dbf80,0xbf22bf55bf75bf80,0x3f7f3f7b3f623f35,0x3f553f6d3f7b3f80,0xbf0ebec4be48a84b,0xbf75bf7bbf7fbf80,0xbef1bf0ebf22bf35
.quad 0xbf803f80bf803f80,0xbf803f80bf803f80,0x3f46bf553f62bf6d,0x3dc9be483e95bec4,0xbe483ec4bf0e3f35,0x3f7bbf6d3f55bf35,0xbef13e483dc9bec4,0xbe953f0ebf463f6d
.quad 0x3f6dbf353ec42839,0xbf6d3f35bec427e6,0xbf753f7bbf463ec4,0x3ef1bf553f7fbf6d,0x3f0ebf6d3f7bbf35,0x3f55bec4be483f35,0x3dc93f0ebf753f6d,0xbf223f7bbf623ec4
.quad 0xbf35a60d3f35bf80,0xbf3527c23f35bf80,0x3f7fbf0ebe953f6d,0x3f46bf7b3ef13ec4,0xbf553f6dbe48bf35,0x3f0e3ec4bf7b3f35,0x3e95bf7b3f223ec4,0xbf623f553dc9bf6d
.quad 0x3ec43f35bf6d27e6,0xbec4bf353f6da6d4,0xbf62be483f7fbec4,0x3f75bf0ebf223f6d,0x3f7bbec4bf553f35,0x3e483f6dbf0ebf35,0xbf223f553ef1bf6d,0xbf7f3e483f75bec4
.quad 0x27c2bf80a6d43f80,0x28bebf80a89a3f80,0x3f223f55bef1bf6d,0x3f7f3e48bf75bec4,0xbf7bbec43f553f35,0xbe483f6d3f0ebf35,0x3f62be48bf7fbec4,0xbf75bf0e3f223f6d
.quad 0xbec43f353f6d27c2,0x3ec4bf35bf6da777,0xbe95bf7bbf223ec4,0x3f623f55bdc9bf6d,0x3f553f6d3e48bf35,0xbf0e3ec43f7b3f35,0xbf7fbf0e3e953f6d,0xbf46bf7bbef13ec4
.quad 0x3f3527e5bf35bf80,0x3f352889bf35bf80,0xbdc93f0e3f753f6d,0x3f223f7b3f623ec4,0xbf0ebf6dbf7bbf35,0xbf55bec43e483f35,0x3f753f7b3f463ec4,0xbef1bf55bf7fbf6d
.quad 0xbf6dbf35bec4a89a,0x3f6d3f353ec42926,0x3ef13e48bdc9bec4,0x3e953f0e3f463f6d,0x3e483ec43f0e3f35,0xbf7bbf6dbf55bf35,0xbf46bf55bf62bf6d,0xbdc9be48be95bec4
.quad 0xa80da754a60d278d,0xa81fa70da88d27b0,0xbe953e48bdc9a60d,0xbf623f55bf463f35,0x3f0ebec43e48a754,0x3f55bf6d3f7bbf80,0xbf463f0ebe95a80d,0x3dc93e48bef13f35
.quad 0x3f6dbf353ec4279f,0xbf6d3f35bec4a70d,0xbf7f3f55bef1a68d,0x3f46bf7b3f75bf35,0x3f7bbf6d3f0e2854,0x3e483ec4bf553f80,0xbf623f7bbf22a816,0xbf753f0e3dc9bf35
.quad 0x3f35bf803f3527b0,0x3f35bf803f35a68e,0xbef13f7bbf46a88d,0x3e953f0ebf7f3f35,0x3e48bf6d3f55a70d,0xbf7b3ec43f0ebf80,0x3dc93f55bf62a81f,0x3f22bf7b3e953f35
.quad 0xbec4bf353f6d28b1,0x3ec43f35bf6d278d,0x3f223f0ebf75a70d,0xbf7f3e483f62bf35,0xbf55bec43f7b2865,0x3f0ebf6dbe483f80,0x3f753e48bf7f27b1,0x3ef13f55bf22bf35
.quad 0xbf80a8313f8027d4,0xbf8027543f8028c2,0x3f75be48bf7fa896,0x3ef1bf55bf223f35,0xbf553ec43f7ba68e,0x3f0e3f6dbe48bf80,0x3f22bf0ebf75a831,0xbf7fbe483f623f35
.quad 0xbec43f353f6da80d,0x3ec4bf35bf6da8a8,0x3dc9bf55bf62a754,0x3f223f7b3e95bf35,0x3e483f6d3f552877,0xbf7bbec43f0e3f80,0xbef1bf7bbf46278d,0x3e95bf0ebf7fbf35
.quad 0x3f353f803f3527f7,0x3f353f803f35288d,0xbf62bf7bbf22a89f,0xbf75bf0e3dc93f35,0x3f7b3f6d3f0ea237,0x3e48bec4bf55bf80,0xbf7fbf55bef1a842,0x3f463f7b3f753f35
.quad 0x3f6d3f353ec428c2,0xbf6dbf35bec4a865,0xbf46bf0ebe95a78d,0x3dc9be48bef1bf35,0x3f0e3ec43e482884,0x3f553f6d3f7b3f80,0xbe95be48bdc92754,0xbf62bf55bf46bf35
.quad 0xa8162854a68d279f,0x27b12865a70d28b1,0xbf223f0ebef13ec4,0xbf7f3f7bbf753f6d,0x3f7bbf6d3f55bf35,0x3e48bec43f0ebf35,0xbf623f7bbf7f3f6d,0x3f75bf553f22bec4
.quad 0x3ec4bf353f6dbf80,0xbec43f35bf6d3f80,0x3e953e48bf223f6d,0xbf623f0ebdc9bec4,0xbf553ec43e48bf35,0x3f0ebf6d3f7bbf35,0x3f7fbf553e953ec4,0x3f46be48bef13f6d
.quad 0xbf353f80bf35a70d,0xbf353f80bf35278d,0x3dc9bf553f75bec4,0xbf22be483f62bf6d,0x3f0e3ec4bf7b3f35,0x3f55bf6d3e483f35,0xbf753e483f46bf6d,0x3ef13f0ebf7f3ec4
.quad 0x3f6dbf35bec43f80,0xbf6d3f353ec4bf80,0xbef13f7bbdc9bf6d,0xbe95bf553f463ec4,0xbe48bf6d3f0e3f35,0x3f7bbec4bf553f35,0x3f463f0ebf62bec4,0x3dc93f7bbe95bf6d
.quad 0xbf80a89f3f802877,0xbf80a7b03f80268d,0x3f46bf0ebf623ec4,0x3dc9bf7bbe953f6d,0xbe483f6d3f0ebf35,0x3f7b3ec4bf55bf35,0xbef1bf7bbdc93f6d,0xbe953f553f46bec4
.quad 0x3f6d3f35bec4bf80,0xbf6dbf353ec43f80,0xbf75be483f463f6d,0x3ef1bf0ebf7fbec4,0x3f0ebec4bf7bbf35,0x3f553f6d3e48bf35,0x3dc93f553f753ec4,0xbf223e483f623f6d
.quad 0xbf35bf80bf352754,0xbf35bf80bf35a7d4,0x3f7f3f553e95bec4,0x3f463e48bef1bf6d,0xbf55bec43e483f35,0x3f0e3f6d3f7b3f35,0x3e95be48bf22bf6d,0xbf62bf0ebdc93ec4
.quad 0x3ec43f353f6d3f80,0xbec4bf35bf6dbf80,0xbf62bf7bbf7fbf6d,0x3f753f553f223ec4,0x3f7b3f6d3f553f35,0x3e483ec43f0e3f35,0xbf22bf0ebef1bec4,0xbf7fbf7bbf75bf6d
.quad 0x280d2754260da78d,0x281f270d288da7b0,0x3e95be483dc9260d,0x3f62bf553f46bf35,0xbf0e3ec4be482754,0xbf553f6dbf7b3f80,0x3f46bf0e3e95280d,0xbdc9be483ef1bf35
.quad 0xbf6d3f35bec4a79f,0x3f6dbf353ec4270d,0x3f7fbf553ef1268d,0xbf463f7bbf753f35,0xbf7b3f6dbf0ea854,0xbe48bec43f55bf80,0x3f62bf7b3f222816,0x3f75bf0ebdc93f35
.quad 0xbf353f80bf35a7b0,0xbf353f80bf35268e,0x3ef1bf7b3f46288d,0xbe95bf0e3f7fbf35,0xbe483f6dbf55270d,0x3f7bbec4bf0e3f80,0xbdc9bf553f62281f,0xbf223f7bbe95bf35
.quad 0x3ec43f35bf6da8b1,0xbec4bf353f6da78d,0xbf22bf0e3f75270d,0x3f7fbe48bf623f35,0x3f553ec4bf7ba865,0xbf0e3f6d3e48bf80,0xbf75be483f7fa7b1,0xbef1bf553f223f35
.quad 0x3f802831bf80a7d4,0x3f80a754bf80a8c2,0xbf753e483f7f2896,0xbef13f553f22bf35,0x3f55bec4bf7b268e,0xbf0ebf6d3e483f80,0xbf223f0e3f752831,0x3f7f3e48bf62bf35
.quad 0x3ec4bf35bf6d280d,0xbec43f353f6d28a8,0xbdc93f553f622754,0xbf22bf7bbe953f35,0xbe48bf6dbf55a877,0x3f7b3ec4bf0ebf80,0x3ef13f7b3f46a78d,0xbe953f0e3f7f3f35
.quad 0xbf35bf80bf35a7f7,0xbf35bf80bf35a88d,0x3f623f7b3f22289f,0x3f753f0ebdc9bf35,0xbf7bbf6dbf0e2237,0xbe483ec43f553f80,0x3f7f3f553ef12842,0xbf46bf7bbf75bf35
.quad 0xbf6dbf35bec4a8c2,0x3f6d3f353ec42865,0x3f463f0e3e95278d,0xbdc93e483ef13f35,0xbf0ebec4be48a884,0xbf55bf6dbf7bbf80,0x3e953e483dc9a754,0x3f623f553f463f35
.quad 0x2816a854268da79f,0xa7b1a865270da8b1,0x3f22bf0e3ef1bec4,0x3f7fbf7b3f75bf6d,0xbf7b3f6dbf553f35,0xbe483ec4bf0e3f35,0x3f62bf7b3f7fbf6d,0xbf753f55bf223ec4
.quad 0xbec43f35bf6d3f80,0x3ec4bf353f6dbf80,0xbe95be483f22bf6d,0x3f62bf0e3dc93ec4,0x3f55bec4be483f35,0xbf0e3f6dbf7b3f35,0xbf7f3f55be95bec4,0xbf463e483ef1bf6d
.quad 0x3f35bf803f35270d,0x3f35bf803f35a78d,0xbdc93f55bf753ec4,0x3f223e48bf623f6d,0xbf0ebec43f7bbf35,0xbf553f6dbe48bf35,0x3f75be48bf463f6d,0xbef1bf0e3f7fbec4
.quad 0xbf6d3f353ec4bf80,0x3f6dbf35bec43f80,0x3ef1bf7b3dc93f6d,0x3e953f55bf46bec4,0x3e483f6dbf0ebf35,0xbf7b3ec43f55bf35,0xbf46bf0e3f623ec4,0xbdc9bf7b3e953f6d
.quad 0x3f80289fbf80a877,0x3f8027b0bf80a68d,0xbf463f0e3f62bec4,0xbdc93f7b3e95bf6d,0x3e48bf6dbf0e3f35,0xbf7bbec43f553f35,0x3ef13f7b3dc9bf6d,0x3e95bf55bf463ec4
.quad 0xbf6dbf353ec43f80,0x3f6d3f35bec4bf80,0x3f753e48bf46bf6d,0xbef13f0e3f7f3ec4,0xbf0e3ec43f7b3f35,0xbf55bf6dbe483f35,0xbdc9bf55bf75bec4,0x3f22be48bf62bf6d
.quad 0x3f353f803f35a754,0x3f353f803f3527d4,0xbf7fbf55be953ec4,0xbf46be483ef13f6d,0x3f553ec4be48bf35,0xbf0ebf6dbf7bbf35,0xbe953e483f223f6d,0x3f623f0e3dc9bec4
.quad 0xbec4bf35bf6dbf80,0x3ec43f353f6d3f80,0x3f623f7b3f7f3f6d,0xbf75bf55bf22bec4,0xbf7bbf6dbf55bf35,0xbe48bec4bf0ebf35,0x3f223f0e3ef13ec4,0x3f7f3f7b3f753f6d
.quad 0xbf803f80bf803f80,0xbf803f80bf803f80,0xbe953e48bdc927e6,0xbf623f55bf463f35,0x3f55bf6d3f7bbf80,0xbf0e3ec4be48a892,0x3f46bf0e3e95a731,0xbdc9be483ef1bf35
.quad 0xbec43f35bf6d3f80,0x3ec4bf353f6dbf80,0xbf7f3f55bef1a6d4,0x3f46bf7b3f75bf35,0xbe48bec43f55bf80,0x3f7bbf6d3f0e27e5,0x3f62bf7b3f2227c2,0x3f75bf0ebdc93f35
.quad 0x3f3528b5bf353f80,0x3f352880bf353f80,0xbef13f7bbf46a828,0x3e953f0ebf7f3f35,0xbf7b3ec43f0ebf80,0xbe483f6dbf552777,0xbdc9bf553f62286e,0xbf223f7bbe95bf35
.quad 0x3f6dbf35bec43f80,0xbf6d3f353ec4bf80,0x3f223f0ebf75a89a,0xbf7f3e483f62bf35,0xbf0e3f6d3e48bf80,0xbf55bec43f7b2889,0xbf75be483f7f28be,0xbef1bf553f223f35
.quad 0x260cbf8027773f80,0xa85dbf80a85d3f80,0x3f75be48bf7f2777,0x3ef1bf55bf223f35,0x3f0e3f6dbe48bf80,0x3f55bec4bf7ba918,0xbf223f0e3f75260c,0x3f7f3e48bf62bf35
.quad 0xbf6dbf353ec43f80,0x3f6d3f35bec4bf80,0x3dc9bf55bf62a79f,0x3f223f7b3e95bf35,0x3f7b3ec4bf0ebf80,0x3e483f6d3f55a79f,0x3ef13f7b3f462926,0xbe953f0e3f7f3f35
.quad 0xbf35a9183f353f80,0xbf35a8803f353f80,0xbf62bf7bbf22a85d,0xbf75bf0e3dc93f35,0x3e48bec4bf55bf80,0xbf7bbf6dbf0ea880,0x3f7f3f553ef1a85d,0xbf46bf7bbf75bf35
.quad 0x3ec43f353f6d3f80,0xbec4bf35bf6dbf80,0xbf46bf0ebe95a8b5,0x3dc9be48bef1bf35,0xbf55bf6dbf7bbf80,0x3f0e3ec43e482914,0x3e953e483dc9a79f,0x3f623f553f463f35
.quad 0xbf803f80bf803f80,0xbf803f80bf803f80,0xbf223f0ebef13ec4,0xbf7f3f7bbf753f6d,0x3e48bec43f0ebf35,0xbf7b3f6dbf553f35,0x3f62bf7b3f7fbf6d,0xbf753f55bf223ec4
.quad 0x3f6dbf353ec427c2,0xbf6d3f35bec4a89a,0x3e953e48bf223f6d,0xbf623f0ebdc9bec4,0xbf0e3f6dbf7b3f35,0xbf553ec43e48bf35,0xbf7f3f55be95bec4,0xbf463e483ef1bf6d
.quad 0xbf35a89a3f35bf80,0xbf35a84b3f35bf80,0x3dc9bf553f75bec4,0xbf22be483f62bf6d,0x3f55bf6d3e483f35,0xbf0ebec43f7bbf35,0x3f75be48bf463f6d,0xbef1bf0e3f7fbec4
.quad 0x3ec43f35bf6da777,0xbec4bf353f6d2926,0xbef13f7bbdc9bf6d,0xbe95bf553f463ec4,0xbf7b3ec43f55bf35,0xbe48bf6d3f0e3f35,0xbf46bf0e3f623ec4,0xbdc9bf7b3e953f6d
.quad 0x2926bf80a79f3f80,0xa79fbf80a8b53f80,0x3f46bf0ebf623ec4,0x3dc9bf7bbe953f6d,0x3f7b3ec4bf55bf35,0x3e48bf6dbf0e3f35,0x3ef13f7b3dc9bf6d,0x3e95bf55bf463ec4
.quad 0xbec43f353f6d26d3,0x3ec4bf35bf6da8fc,0xbf75be483f463f6d,0x3ef1bf0ebf7fbec4,0xbf55bf6dbe483f35,0x3f0ebec4bf7bbf35,0xbdc9bf55bf75bec4,0x3f22be48bf62bf6d
.quad 0x3f35a79fbf35bf80,0x3f352914bf35bf80,0x3f7f3f553e95bec4,0x3f463e48bef1bf6d,0x3f0e3f6d3f7b3f35,0x3f553ec4be48bf35,0xbe953e483f223f6d,0x3f623f0e3dc9bec4
.quad 0xbf6dbf35bec4a8fc,0x3f6d3f353ec428ac,0xbf62bf7bbf7fbf6d,0x3f753f553f223ec4,0xbe48bec4bf0ebf35,0x3f7b3f6d3f553f35,0x3f223f0e3ef13ec4,0x3f7f3f7b3f753f6d
.quad 0xa831a68ea89627d4,0xa842a237a89f27f7,0xbf753f7bbf7f3f80,0xbef13f0ebf223f35,0xbf0e3ec4be48a831,0xbf553f6dbf7b3f80,0x3f22bf553f75bf80,0xbf7f3f7bbf623f35
.quad 0x3f6dbf353ec42877,0xbf6d3f35bec42754,0xbdc93f0ebf623f80,0xbf223e483e95bf35,0xbf7b3f6dbf0ea89f,0xbe48bec43f55bf80,0xbef1be483f46bf80,0x3e95bf553f7fbf35
.quad 0x3f35bf803f3528c2,0x3f35bf803f35288d,0x3f62be48bf223f80,0x3f75bf553dc93f35,0xbe483f6dbf552754,0x3f7bbec4bf0e3f80,0xbf7f3f0e3ef1bf80,0x3f463e48bf753f35
.quad 0xbec4bf353f6d268d,0x3ec43f35bf6da7d4,0x3f46bf55be953f80,0xbdc93f7bbef1bf35,0x3f553ec4bf7ba7b0,0xbf0e3f6d3e48bf80,0xbe953f7b3dc9bf80,0xbf623f0e3f46bf35
.quad 0xbf80a8653f80281f,0xbf80a9003f80a78d,0xbe95bf7b3dc93f80,0xbf62bf0e3f463f35,0x3f55bec4bf7ba865,0xbf0ebf6d3e483f80,0x3f463f55be95bf80,0xbdc9bf7bbef13f35
.quad 0xbec43f353f6d2896,0x3ec4bf35bf6da884,0xbf7fbf0e3ef13f80,0x3f46be48bf75bf35,0xbe48bf6dbf55a8b9,0x3f7b3ec4bf0ebf80,0x3f623e48bf22bf80,0x3f753f553dc9bf35
.quad 0x3f353f803f35a78d,0x3f353f803f352916,0xbef13e483f463f80,0x3e953f553f7f3f35,0xbf7bbf6dbf0ea900,0xbe483ec43f553f80,0xbdc9bf0ebf62bf80,0xbf22be483e953f35
.quad 0x3f6d3f353ec4278d,0xbf6dbf35bec427b1,0x3f223f553f753f80,0xbf7fbf7bbf62bf35,0xbf0ebec4be48a923,0xbf55bf6dbf7bbf80,0xbf75bf7bbf7fbf80,0xbef1bf0ebf22bf35
.quad 0x278d2877a754a80d,0x27542884a78d28c2,0xbf463f55bf623f6d,0xbdc93e48be953ec4,0xbf7b3f6dbf553f35,0xbe483ec4bf0e3f35,0xbef13e483dc9bec4,0xbe953f0ebf463f6d
.quad 0x3ec4bf353f6dbf80,0xbec43f35bf6d3f80,0x3f75bf7b3f46bec4,0xbef13f55bf7f3f6d,0x3f55bec4be483f35,0xbf0e3f6dbf7b3f35,0x3dc93f0ebf753f6d,0xbf223f7bbf623ec4
.quad 0xbf353f80bf35a8a8,0xbf353f80bf35a865,0xbf7f3f0e3e95bf6d,0xbf463f7bbef1bec4,0xbf0ebec43f7bbf35,0xbf553f6dbe48bf35,0x3e95bf7b3f223ec4,0xbf623f553dc9bf6d
.quad 0x3f6dbf35bec43f80,0xbf6d3f353ec4bf80,0x3f623e48bf7f3ec4,0xbf753f0e3f22bf6d,0x3e483f6dbf0ebf35,0xbf7b3ec43f55bf35,0xbf223f553ef1bf6d,0xbf7f3e483f75bec4
.quad 0xbf80a8b93f802896,0xbf80a9233f80278d,0xbf22bf553ef13f6d,0xbf7fbe483f753ec4,0x3e48bf6dbf0e3f35,0xbf7bbec43f553f35,0x3f62be48bf7fbec4,0xbf75bf0e3f223f6d
.quad 0x3f6d3f35bec4bf80,0xbf6dbf353ec43f80,0x3e953f7b3f22bec4,0xbf62bf553dc93f6d,0xbf0e3ec43f7b3f35,0xbf55bf6dbe483f35,0xbf7fbf0e3e953f6d,0xbf46bf7bbef13ec4
.quad 0xbf35bf80bf35a884,0xbf35bf80bf3527b1,0x3dc9bf0ebf75bf6d,0xbf22bf7bbf62bec4,0x3f553ec4be48bf35,0xbf0ebf6dbf7bbf35,0x3f753f7b3f463ec4,0xbef1bf55bf7fbf6d
.quad 0x3ec43f353f6d3f80,0xbec4bf35bf6dbf80,0xbef1be483dc93ec4,0xbe95bf0ebf46bf6d,0xbf7bbf6dbf55bf35,0xbe48bec4bf0ebf35,0xbf46bf55bf62bf6d,0xbdc9be48be95bec4
.quad 0x2831268e2896a7d4,0x28422237289fa7f7,0x3f75bf7b3f7fbf80,0x3ef1bf0e3f22bf35,0x3f0ebec43e482831,0x3f55bf6d3f7bbf80,0xbf223f55bf753f80,0x3f7fbf7b3f62bf35
.quad 0xbf6d3f35bec4a877,0x3f6dbf353ec4a754,0x3dc9bf0e3f62bf80,0x3f22be48be953f35,0x3f7bbf6d3f0e289f,0x3e483ec4bf553f80,0x3ef13e48bf463f80,0xbe953f55bf7f3f35
.quad 0xbf353f80bf35a8c2,0xbf353f80bf35a88d,0xbf623e483f22bf80,0xbf753f55bdc9bf35,0x3e48bf6d3f55a754,0xbf7b3ec43f0ebf80,0x3f7fbf0ebef13f80,0xbf46be483f75bf35
.quad 0x3ec43f35bf6da68d,0xbec4bf353f6d27d4,0xbf463f553e95bf80,0x3dc9bf7b3ef13f35,0xbf55bec43f7b27b0,0x3f0ebf6dbe483f80,0x3e95bf7bbdc93f80,0x3f62bf0ebf463f35
.quad 0x3f802865bf80a81f,0x3f802900bf80278d,0x3e953f7bbdc9bf80,0x3f623f0ebf46bf35,0xbf553ec43f7b2865,0x3f0e3f6dbe48bf80,0xbf46bf553e953f80,0x3dc93f7b3ef1bf35
.quad 0x3ec4bf35bf6da896,0xbec43f353f6d2884,0x3f7f3f0ebef1bf80,0xbf463e483f753f35,0x3e483f6d3f5528b9,0xbf7bbec43f0e3f80,0xbf62be483f223f80,0xbf75bf55bdc93f35
.quad 0xbf35bf80bf35278d,0xbf35bf80bf35a916,0x3ef1be48bf46bf80,0xbe95bf55bf7fbf35,0x3f7b3f6d3f0e2900,0x3e48bec4bf55bf80,0x3dc93f0e3f623f80,0x3f223e48be95bf35
.quad 0xbf6dbf35bec4a78d,0x3f6d3f353ec4a7b1,0xbf22bf55bf75bf80,0x3f7f3f7b3f623f35,0x3f0e3ec43e482923,0x3f553f6d3f7b3f80,0x3f753f7b3f7f3f80,0x3ef13f0e3f223f35
.quad 0xa78da8772754280d,0xa754a884278da8c2,0x3f46bf553f62bf6d,0x3dc9be483e95bec4,0x3f7bbf6d3f55bf35,0x3e48bec43f0ebf35,0x3ef1be48bdc93ec4,0x3e95bf0e3f46bf6d
.quad 0xbec43f35bf6d3f80,0x3ec4bf353f6dbf80,0xbf753f7bbf463ec4,0x3ef1bf553f7fbf6d,0xbf553ec43e48bf35,0x3f0ebf6d3f7bbf35,0xbdc9bf0e3f75bf6d,0x3f22bf7b3f62bec4
.quad 0x3f35bf803f3528a8,0x3f35bf803f352865,0x3f7fbf0ebe953f6d,0x3f46bf7b3ef13ec4,0x3f0e3ec4bf7b3f35,0x3f55bf6d3e483f35,0xbe953f7bbf22bec4,0x3f62bf55bdc93f6d
.quad 0xbf6d3f353ec4bf80,0x3f6dbf35bec43f80,0xbf62be483f7fbec4,0x3f75bf0ebf223f6d,0xbe48bf6d3f0e3f35,0x3f7bbec4bf553f35,0x3f22bf55bef13f6d,0x3f7fbe48bf753ec4
.quad 0x3f8028b9bf80a896,0x3f802923bf80a78d,0x3f223f55bef1bf6d,0x3f7f3e48bf75bec4,0xbe483f6d3f0ebf35,0x3f7b3ec4bf55bf35,0xbf623e483f7f3ec4,0x3f753f0ebf22bf6d
.quad 0xbf6dbf353ec43f80,0x3f6d3f35bec4bf80,0xbe95bf7bbf223ec4,0x3f623f55bdc9bf6d,0x3f0ebec4bf7bbf35,0x3f553f6d3e48bf35,0x3f7f3f0ebe95bf6d,0x3f463f7b3ef1bec4
.quad 0x3f353f803f352884,0x3f353f803f35a7b1,0xbdc93f0e3f753f6d,0x3f223f7b3f623ec4,0xbf55bec43e483f35,0x3f0e3f6d3f7b3f35,0xbf75bf7bbf46bec4,0x3ef13f553f7f3f6d
.quad 0xbec4bf35bf6dbf80,0x3ec43f353f6d3f80,0x3ef13e48bdc9bec4,0x3e953f0e3f463f6d,0x3f7b3f6d3f553f35,0x3e483ec43f0e3f35,0x3f463f553f623f6d,0x3dc93e483e953ec4
.quad 0x3f8000003f800000,0x3f8000003f800000,0x3f7fffb13f800000,0x3f7ffd393f7ffec4,0x3f7ffec43f800000,0x3f7ff4e63f7ffb11,0x3f7ffd393f800000,0x3f7fe7053f7ff4e6
.quad 0x3f7ffb113f800000,0x3f7fd3973f7fec43,0x3f7ff84a3f800000,0x3f7fba9e3f7fe129,0x3f7ff4e63f800000,0x3f7f9c183f7fd397,0x3f7ff0e33f800000,0x3f7f78083f7fc38f
.quad 0x3f7fec433f800000,0x3f7f4e6d3f7fb10f,0x3f7fe7053f800000,0x3f7f1f493f7f9c18,0x3f7fe1293f800000,0x3f7eea9d3f7f84ab,0x3f7fdaaf3f800000,0x3f7eb0693f7f6ac7
.quad 0x3f7fd3973f800000,0x3f7e70b03f7f4e6d,0x3f7fcbe23f800000,0x3f7e2b723f7f2f9d,0x3f7fc38f3f800000,0x3f7de0b13f7f0e58,0x3f7fba9e3f800000,0x3f7d906e3f7eea9d
.quad 0x3f7fb10f3f800000,0x3f7d3aac3f7ec46d,0x3f7fa6e33f800000,0x3f7cdf6c3f7e9bc9,0x3f7f9c183f800000,0x3f7c7eb03f7e70b0,0x3f7f90b13f800000,0x3f7c187a3f7e4323
.quad 0x3f7f84ab3f800000,0x3f7baccd3f7e1324,0x3f7f78083f800000,0x3f7b3bab3f7de0b1,0x3f7f6ac73f800000,0x3f7ac5163f7dabcc,0x3f7f5ce93f800000,0x3f7a49103f7d7474
.quad 0x3f7f4e6d3f800000,0x3f79c79d3f7d3aac,0x3f7f3f543f800000,0x3f7940c03f7cfe73,0x3f7f2f9d3f800000,0x3f78b47b3f7cbfc9,0x3f7f1f493f800000,0x3f7822d13f7c7eb0
.quad 0x3f7f0e583f800000,0x3f778bc53f7c3b28,0x3f7efcc93f800000,0x3f76ef5b3f7bf531,0x3f7eea9d3f800000,0x3f764d973f7baccd,0x3f7ed7d43f800000,0x3f75a67b3f7b61fc
.quad 0x3f8000003f800000,0x3f8000003f800000,0x3f7ff84a3f7ffb11,0x3f7ff0e33f7ff4e6,0x3f7fe1293f7fec43,0x3f7fc38f3f7fd397,0x3f7fba9e3f7fd397,0x3f7f78083f7f9c18
.quad 0x3f7f84ab3f7fb10f,0x3f7f0e583f7f4e6d,0x3f7f3f543f7f84ab,0x3f7e868b3f7eea9d,0x3f7eea9d3f7f4e6d,0x3f7de0b13f7e70b0,0x3f7e868b3f7f0e58,0x3f7d1cdd3f7de0b1
.quad 0x3f7e13243f7ec46d,0x3f7c3b283f7d3aac,0x3f7d906e3f7e70b0,0x3f7b3bab3f7c7eb0,0x3f7cfe733f7e1324,0x3f7a1e843f7baccd,0x3f7c5d3a3f7dabcc,0x3f78e3d63f7ac516
.quad 0x3f7baccd3f7d3aac,0x3f778bc53f79c79d,0x3f7aed373f7cbfc9,0x3f76167a3f78b47b,0x3f7a1e843f7c3b28,0x3f7484223f778bc5,0x3f7940c03f7baccd,0x3f72d4eb3f764d97
.quad 0x3f7853f83f7b14be,0x3f7109083f74fa0b,0x3f77583a3f7a7302,0x3f6f20b03f73913f,0x3f764d973f79c79d,0x3f6d1c1d3f721352,0x3f75341d3f791298,0x3f6afb8c3f708066
.quad 0x3f740bdd3f7853f8,0x3f68bf3c3f6ed89e,0x3f72d4eb3f778bc5,0x3f6667713f6d1c1d,0x3f718f573f76ba07,0x3f63f4733f6b4b0c,0x3f703b373f75dec6,0x3f61668a3f696591
.quad 0x3f6ed89e3f74fa0b,0x3f5ebe053f676bd8,0x3f6d67a13f740bdd,0x3f5bfb343f655e0b,0x3f6be8583f731447,0x3f591e6a3f633c5a,0x3f6a5ad93f721352,0x3f5627fe3f6106f2
.quad 0x3f68bf3c3f710908,0x3f5318493f5ebe05,0x3f6715993f6ff573,0x3f4fefa83f5c61c7,0x3f655e0b3f6ed89e,0x3f4cae793f59f26a,0x3f6398ac3f6db293,0x3f4955213f577026
.quad 0x8000000080000000,0x8000000080000000,0xbb490fc680000000,0xbc16cb58bbc90f88,0xbbc90f8880000000,0xbc96c9b6bc490e90,0xbc16cb5880000000,0xbce22a7abc96c9b6
.quad 0xbc490e9080000000,0xbd16c32cbcc90ab0,0xbc7b514b80000000,0xbd3c6dd5bcfb49ba,0xbc96c9b680000000,0xbd621469bd16c32c,0xbcafea6980000000,0xbd83db0abd2fe007
.quad 0xbcc90ab080000000,0xbd96a905bd48fb30,0xbce22a7a80000000,0xbda973babd621469,0xbcfb49ba80000000,0xbdbc3ac3bd7b2b74,0xbd0a342f80000000,0xbdcefdb7bd8a200a
.quad 0xbd16c32c80000000,0xbde1bc2ebd96a905,0xbd2351cb80000000,0xbdf475c0bda3308c,0xbd2fe00780000000,0xbe039502bdafb680,0xbd3c6dd580000000,0xbe0cec4abdbc3ac3
.quad 0xbd48fb3080000000,0xbe164083bdc8bd36,0xbd55880e80000000,0xbe1f917bbdd53db9,0xbd62146980000000,0xbe28defcbde1bc2e,0xbd6ea03880000000,0xbe3228d4bdee3876
.quad 0xbd7b2b7480000000,0xbe3b6ecfbdfab273,0xbd83db0a80000000,0xbe44b0b9be039502,0xbd8a200a80000000,0xbe4dee60be09cf86,0xbd9064b480000000,0xbe57278fbe1008b7
.quad 0xbd96a90580000000,0xbe605c13be164083,0xbd9cecf980000000,0xbe698bbabe1c76de,0xbda3308c80000000,0xbe72b651be22abb6,0xbda973ba80000000,0xbe7bdba4be28defc
.quad 0xbdafb68080000000,0xbe827dc0be2f10a2,0xbdb5f8da80000000,0xbe870adabe354098,0xbdbc3ac380000000,0xbe8b9507be3b6ecf,0xbdc27c3980000000,0xbe901c2cbe419b37
.quad 0x8000000080000000,0x8000000080000000,0xbc7b514bbc490e90,0xbcafea69bc96c9b6,0xbcfb49babcc90ab0,0xbd2fe007bd16c32c,0xbd3c6dd5bd16c32c,0xbd83db0abd621469
.quad 0xbd7b2b74bd48fb30,0xbdafb680bd96a905,0xbd9cecf9bd7b2b74,0xbddb7d37bdbc3ac3,0xbdbc3ac3bd96a905,0xbe039502bde1bc2e,0xbddb7d37bdafb680,0xbe195be0be039502
.quad 0xbdfab273bdc8bd36,0xbe2f10a2be164083,0xbe0cec4abde1bc2e,0xbe44b0b9be28defc,0xbe1c76debdfab273,0xbe5a3997be3b6ecf,0xbe2bf804be09cf86,0xbe6fa8b2be4dee60
.quad 0xbe3b6ecfbe164083,0xbe827dc0be605c13,0xbe4ada4fbe22abb6,0xbe8d17c0be72b651,0xbe5a3997be2f10a2,0xbe97a117be827dc0,0xbe698bbabe3b6ecf,0xbea21887be8b9507
.quad 0xbe78cfccbe47c5c2,0xbeac7cd4be94a031,0xbe840270be541501,0xbeb6ccc3be9d9e78,0xbe8b9507be605c13,0xbec1071ebea68f12,0xbe931f35be6c9a7f,0xbecb2aaebeaf713a
.quad 0xbe9aa086be78cfcc,0xbed53641beb8442a,0xbea21887be827dc0,0xbedf28a9bec1071e,0xbea986c4be888e93,0xbee900b7bec9b953,0xbeb0eacbbe8e9a22,0xbef2bd43bed25a09
.quad 0xbeb8442abe94a031,0xbefc5d27bedae880,0xbebf926fbe9aa086,0xbf02ef9fbee363fa,0xbec6d529bea09ae5,0xbf07a136beebcbbb,0xbece0beabea68f12,0xbf0c42c9bef41f07
.quad 0xbed53641beac7cd4,0xbf10d3cdbefc5d27,0xbedc53c1beb263ef,0xbf1553b7bf0242b1,0xbee363fabeb8442a,0xbf19c200bf064b82,0xbeea6681bebe1d4a,0xbf1e1e22bf0a48ad
.quad 0x3f8000003f800000,0x3f8000003f800000,0x3f7fe7053f7fec43,0x3f7fdaaf3f7fe129,0x3f7f9c183f7fb10f,0x3f7f6ac73f7f84ab,0x3f7f1f493f7f4e6d,0x3f7eb0693f7eea9d
.quad 0x3f7e70b03f7ec46d,0x3f7dabcc3f7e1324,0x3f7d906e3f7e1324,0x3f7c5d3a3f7cfe73,0x3f7c7eb03f7d3aac,0x3f7ac5163f7baccd,0x3f7b3bab3f7c3b28,0x3f78e3d63f7a1e84
.quad 0x3f79c79d3f7b14be,0x3f76ba073f7853f8,0x3f7822d13f79c79d,0x3f74484b3f764d97,0x3f764d973f7853f8,0x3f718f573f740bdd,0x3f74484b3f76ba07,0x3f6e8ff83f718f57
.quad 0x3f7213523f74fa0b,0x3f6b4b0c3f6ed89e,0x3f6faf1b3f731447,0x3f67c1873f6be858,0x3f6d1c1d3f710908,0x3f63f4733f68bf3c,0x3f6a5ad93f6ed89e,0x3f5fe4e93f655e0b
.quad 0x3f676bd83f6c835e,0x3f5b941a3f61c598,0x3f644fac3f6a09a7,0x3f5703483f5df6be,0x3f6106f23f676bd8,0x3f5233c63f59f26a,0x3f5d924d3f64aa59,0x3f4d26fd3f55b993
.quad 0x3f59f26a3f61c598,0x3f47de653f514d3d,0x3f5627fe3f5ebe05,0x3f425b893f4cae79,0x3f5233c63f5b941a,0x3f3ca0033f47de65,0x3f4e16893f584853,0x3f36ad7f3f42de29
.quad 0x3f49d1123f54db31,0x3f3085bb3f3daef9,0x3f4564393f514d3d,0x3f2a2a803f385216,0x3f40d0da3f4d9f02,0x3f239da93f32c8c9,0x3f3c17d93f49d112,0x3f1ce11f3f2d1469
.quad 0x3f373a233f45e403,0x3f15f6d93f273656,0x3f3238aa3f41d870,0x3f0ee0db3f212ff9,0x3f2d14693f3daef9,0x3f07a1363f1b02c6,0x3f27ce613f396842,0x3f003a063f14b039
.quad 0x3f8000003f800000,0x3f8000003f800000,0x3f7fcbe23f7fd397,0x3f7fba9e3f7fc38f,0x3f7f2f9d3f7f4e6d,0x3f7eea9d3f7f0e58,0x3f7e2b723f7e70b0,0x3f7d906e3f7de0b1
.quad 0x3f7cbfc93f7d3aac,0x3f7baccd3f7c3b28,0x3f7aed373f7baccd,0x3f7940c03f7a1e84,0x3f78b47b3f79c79d,0x3f764d973f778bc5,0x3f76167a3f778bc5,0x3f72d4eb3f748422
.quad 0x3f7314473f74fa0b,0x3f6ed89e3f710908,0x3f6faf1b3f721352,0x3f6a5ad93f6d1c1d,0x3f6be8583f6ed89e,0x3f655e0b3f68bf3c,0x3f67c1873f6b4b0c,0x3f5fe4e93f63f473
.quad 0x3f633c5a3f676bd8,0x3f59f26a3f5ebe05,0x3f5e5aa63f633c5a,0x3f5389c73f591e6a,0x3f591e6a3f5ebe05,0x3f4cae793f531849,0x3f5389c73f59f26a,0x3f4564393f4cae79
.quad 0x3f4d9f023f54db31,0x3f3daef93f45e403,0x3f4760853f4f7a1f,0x3f3592e73f3ebc1b,0x3f40d0da3f49d112,0x3f2d14693f373a23,0x3f39f2ac3f43e200,0x3f24381a3f2f61a5
.quad 0x3f32c8c93f3daef9,0x3f1b02c63f273656,0x3f2b561b3f373a23,0x3f11796b3f1ebc12,0x3f239da93f3085bb,0x3f07a1363f15f6d9,0x3f1ba2993f299415,0x3efafef73f0cead0
.quad 0x3f13682a3f226799,0x3ee633753f039c3d,0x3f0af1b73f1b02c6,0x3ed0eb2a3ef41f07,0x3f0242b13f13682a,0x3ebb31a03ee0924f,0x3ef2bd433f0b9a6b,0x3ea5129f3ecc9b8b
.quad 0x3ee0924f3f039c3d,0x3e8e9a223eb8442a,0x3ece0bea3ef6e0cb,0x3e6fa8b23ea395c5,0x3ebb31a03ee63375,0x3e419b373e8e9a22,0x3ea80b1f3ed53641,0x3e1324ca3e72b651
.quad 0x8000000080000000,0x8000000080000000,0xbce22a7abcc90ab0,0xbd0a342fbcfb49ba,0xbd621469bd48fb30,0xbd8a200abd7b2b74,0xbda973babd96a905,0xbdcefdb7bdbc3ac3
.quad 0xbde1bc2ebdc8bd36,0xbe09cf86bdfab273,0xbe0cec4abdfab273,0xbe2bf804be1c76de,0xbe28defcbe164083,0xbe4dee60be3b6ecf,0xbe44b0b9be2f10a2,0xbe6fa8b2be5a3997
.quad 0xbe605c13be47c5c2,0xbe888e93be78cfcc,0xbe7bdba4be605c13,0xbe9920febe8b9507,0xbe8b9507be78cfcc,0xbea986c4be9aa086,0xbe9920febe888e93,0xbeb9bb1ebea986c4
.quad 0xbea68f12be94a031,0xbec9b953beb8442a,0xbeb3dca5bea09ae5,0xbed97cb9bec6d529,0xbec1071ebeac7cd4,0xbee900b7bed53641,0xbece0beabeb8442a,0xbef840c8bee363fa
.quad 0xbedae880bec3ef15,0xbf039c3dbef15aea,0xbee79a5dbecf7bca,0xbf0af1b7beff17b2,0xbef41f07bedae880,0xbf121eb0bf064b82,0xbf003a06bee63375,0xbf19210fbf0cead0
.quad 0xbf064b82bef15aea,0xbf1ff6cbbf13682a,0xbf0c42c9befc5d27,0xbf269de3bf19c200,0xbf121eb0bf039c3d,0xbf2d1469bf1ff6cb,0xbf17de12bf08f59b,0xbf33587abf26050a
.quad 0xbf1d7fd1bf0e39da,0xbf396842bf2beb4a,0xbf2302d3bf13682a,0xbf3f41fcbf31a81d,0xbf286605bf187fc0,0xbf44e3f5bf373a23,0xbf2da859bf1d7fd1,0xbf4a4c87bf3ca003
.quad 0xbf32c8c9bf226799,0xbf4f7a1fbf41d870,0xbf37c655bf273656,0xbf546b3bbf46e22a,0xbf3ca003bf2beb4a,0xbf591e6abf4bbbf8,0xbf4154e1bf3085bb,0xbf5d924dbf5064af
.quad 0x8000000080000000,0x8000000080000000,0xbd2351cbbd16c32c,0xbd3c6dd5bd2fe007,0xbda3308cbd96a905,0xbdbc3ac3bdafb680,0xbdf475c0bde1bc2e,0xbe0cec4abe039502
.quad 0xbe22abb6be164083,0xbe3b6ecfbe2f10a2,0xbe4ada4fbe3b6ecf,0xbe698bbabe5a3997,0xbe72b651be605c13,0xbe8b9507be827dc0,0xbe8d17c0be827dc0,0xbea21887be97a117
.quad 0xbea09ae5be94a031,0xbeb8442abeac7cd4,0xbeb3dca5bea68f12,0xbece0beabec1071e,0xbec6d529beb8442a,0xbee363fabed53641,0xbed97cb9bec9b953,0xbef840c8bee900b7
.quad 0xbeebcbbbbedae880,0xbf064b82befc5d27,0xbefdbabbbeebcbbb,0xbf102dd5bf07a136,0xbf07a136befc5d27,0xbf19c200bf10d3cd,0xbf102dd5bf064b82,0xbf2302d3bf19c200
.quad 0xbf187fc0bf0e39da,0xbf2beb4abf226799,0xbf209393bf15f6d9,0xbf34768fbf2ac082,0xbf286605bf1d7fd1,0xbf3ca003bf32c8c9,0xbf2ff3e6bf24d225,0xbf446337bf3a7ca4
.quad 0xbf373a23bf2beb4a,0xbf4bbbf8bf41d870,0xbf3e35c5bf32c8c9,0xbf52a649bf48d8b3,0xbf44e3f5bf396842,0xbf591e6abf4f7a1f,0xbf4b41fabf3fc767,0xbf5f20dbbf55b993
.quad 0xbf514d3dbf45e403,0xbf64aa59bf5b941a,0xbf570348bf4bbbf8,0xbf69b7e4bf6106f2,0xbf5c61c7bf514d3d,0xbf6e46bebf660f88,0xbf61668abf5695e5,0xbf725470bf6aab7b
.quad 0xbf660f88bf5b941a,0xbf75dec6bf6ed89e,0xbf6a5ad9bf604621,0xbf78e3d6bf7294f8,0xbf6e46bebf64aa59,0xbf7b61fcbf75dec6,0xbf71d19fbf68bf3c,0xbf7d57debf78b47b
.quad 0x3f8000003f800000,0x3f8000003f800000,0x3f7fa6e33f7fb10f,0x3f7f90b13f7f9c18,0x3f7e9bc93f7ec46d,0x3f7e43233f7e70b0,0x3f7cdf6c3f7d3aac,0x3f7c187a3f7c7eb0
.quad 0x3f7a73023f7b14be,0x3f7912983f79c79d,0x3f77583a3f7853f8,0x3f75341d3f764d97,0x3f73913f3f74fa0b,0x3f7080663f721352,0x3f6f20b03f710908,0x3f6afb8c3f6d1c1d
.quad 0x3f6a09a73f6c835e,0x3f64aa593f676bd8,0x3f644fac3f676bd8,0x3f5d924d3f6106f2,0x3f5df6be3f61c598,0x3f55b9933f59f26a,0x3f5703483f5b941a,0x3f4d26fd3f5233c6
.quad 0x3f4f7a1f3f54db31,0x3f43e2003f49d112,0x3f4760853f4d9f02,0x3f39f2ac3f40d0da,0x3f3ebc1b3f45e403,0x3f2f61a53f373a23,0x3f3592e73f3daef9,0x3f24381a3f2d1469
.quad 0x3f2beb4a3f3504f3,0x3f187fc03f226799,0x3f21cbfb3f2beb4a,0x3f0c42c93f173c07,0x3f173c073f226799,0x3eff17b23f0b9a6b,0x3f0c42c93f187fc0,0x3ee4cbfe3eff17b2
.quad 0x3f00e7e43f0e39da,0x3ec9b9533ee63375,0x3eea66813f039c3d,0x3eadf73c3ecc9b8b,0x3ed25a093ef15aea,0x3e919ddd3eb263ef,0x3eb9bb1e3edae880,0x3e698bba3e97a117
.quad 0x3ea09ae53ec3ef15,0x3e2f10a23e78cfcc,0x3e870ada3eac7cd4,0x3de7fa9a3e419b37,0x3e5a39973e94a031,0x3d6214693e09cf86,0x3e25c58c3e78cfcc,0xbb490fc63da3308c
.quad 0x3de1bc2e3e47c5c2,0xbd7b2b743cc90ab0,0x3d6ea0383e164083,0xbdf475c0bcfb49ba,0x3bc90f883dc8bd36,0xbe354098bdafb680,0xbd3c6dd53d48fb30,0xbe6fa8b2be1008b7
.quad 0x3f8000003f800000,0x3f8000003f800000,0x3f7f78083f7f84ab,0x3f7f5ce93f7f6ac7,0x3f7de0b13f7e1324,0x3f7d74743f7dabcc,0x3f7b3bab3f7baccd,0x3f7a49103f7ac516
.quad 0x3f778bc53f7853f8,0x3f75dec63f76ba07,0x3f72d4eb3f740bdd,0x3f703b373f718f57,0x3f6d1c1d3f6ed89e,0x3f6965913f6b4b0c,0x3f6667713f68bf3c,0x3f61668a3f63f473
.quad 0x3f5ebe053f61c598,0x3f5848533f5b941a,0x3f5627fe3f59f26a,0x3f4e16893f5233c6,0x3f4cae793f514d3d,0x3f42de293f47de65,0x3f425b893f47de65,0x3f36ad7f3f3ca003
.quad 0x3f373a233f3daef9,0x3f2994153f3085bb,0x3f2b561b3f32c8c9,0x3f1ba2993f239da9,0x3f1ebc123f273656,0x3f0cead03f15f6d9,0x3f11796b3f1b02c6,0x3efafef73f07a136
.quad 0x3f039c3d3f0e39da,0x3edae8803ef15aea,0x3eea66813f00e7e4,0x3eb9bb1e3ed25a09,0x3ecc9b8b3ee63375,0x3e97a1173eb263ef,0x3eadf73c3ec9b953,0x3e698bba3e919ddd
.quad 0x3e8e9a223eac7cd4,0x3e22abb63e605c13,0x3e5d4b1a3e8e9a22,0x3db5f8da3e1c76de,0x3e1c76de3e605c13,0x3c96c9b63dafb680,0x3db5f8da3e22abb6,0xbd55880e3c96c9b6
.quad 0x3cc90ab03dc8bd36,0xbdfab273bd48fb30,0xbd2351cb3d16c32c,0xbe44b0b9bdee3876,0xbdd53db9bcc90ab0,0xbe8586cebe3b6ecf,0xbe2bf804bdafb680,0xbea80b1fbe7ee6e1
.quad 0xbe6c9a7fbe164083,0xbec9b953bea09ae5,0xbe9620d2be541501,0xbeea6681bec1071e,0xbeb554ecbe888e93,0xbf04f484bee0924f,0xbed3c867bea68f12,0xbf140c5fbeff17b2
.quad 0x8000000080000000,0x8000000080000000,0xbd55880ebd48fb30,0xbd6ea038bd621469,0xbdd53db9bdc8bd36,0xbdee3876bde1bc2e,0xbe1f917bbe164083,0xbe3228d4be28defc
.quad 0xbe541501be47c5c2,0xbe6c9a7fbe605c13,0xbe840270be78cfcc,0xbe931f35be8b9507,0xbe9d9e78be94a031,0xbeaf713abea68f12,0xbeb6ccc3beac7cd4,0xbecb2aaebec1071e
.quad 0xbecf7bcabec3ef15,0xbee63375bedae880,0xbee79a5dbedae880,0xbf003a06bef41f07,0xbeff17b2bef15aea,0xbf0cead0bf064b82,0xbf0af1b7bf039c3d,0xbf19210fbf121eb0
.quad 0xbf15f6d9bf0e39da,0xbf24d225bf1d7fd1,0xbf209393bf187fc0,0xbf2ff3e6bf286605,0xbf2ac082bf226799,0xbf3a7ca4bf32c8c9,0xbf34768fbf2beb4a,0xbf446337bf3ca003
.quad 0xbf3daef9bf3504f3,0xbf4d9f02bf45e403,0xbf466354bf3daef9,0xbf5627febf4e8d90,0xbf4e8d90bf45e403,0xbf5df6bebf5695e5,0xbf5627febf4d9f02,0xbf650479bf5df6be
.quad 0xbf5d2d53bf54db31,0xbf6b4b0cbf64aa59,0xbf6398acbf5b941a,0xbf70c501bf6aab7b,0xbf696591bf61c598,0xbf756d97bf6ff573,0xbf6e8ff8bf676bd8,0xbf7940c0bf748422
.quad 0xbf731447bf6c835e,0xbf7c3b28bf7853f8,0xbf76ef5bbf710908,0xbf7e5a38bf7b61fc,0xbf7a1e84bf74fa0b,0xbf7f9c18bf7dabcc,0xbf7c9f8abf7853f8,0xbf7fffb1bf7f2f9d
.quad 0xbf7e70b0bf7b14be,0xbf7f84abbf7fec43,0xbf7f90b1bf7d3aac,0xbf7e2b72bf7fe129,0xbf7ffec4bf7ec46d,0xbf7bf531bf7f0e58,0xbf7fba9ebf7fb10f,0xbf78e3d6bf7d7474
.quad 0x8000000080000000,0x8000000080000000,0xbd83db0abd7b2b74,0xbd9064b4bd8a200a,0xbe039502bdfab273,0xbe1008b7be09cf86,0xbe44b0b9be3b6ecf,0xbe57278fbe4dee60
.quad 0xbe827dc0be78cfcc,0xbe8e9a22be888e93,0xbea21887be9aa086,0xbeb0eacbbea986c4,0xbec1071ebeb8442a,0xbed25a09bec9b953,0xbedf28a9bed53641,0xbef2bd43bee900b7
.quad 0xbefc5d27bef15aea,0xbf08f59bbf039c3d,0xbf0c42c9bf064b82,0xbf17de12bf121eb0,0xbf19c200bf13682a,0xbf26050abf1ff6cb,0xbf269de3bf1ff6cb,0xbf33587abf2d1469
.quad 0xbf32c8c9bf2beb4a,0xbf3fc767bf396842,0xbf3e35c5bf373a23,0xbf4b41fabf44e3f5,0xbf48d8b3bf41d870,0xbf55b993bf4f7a1f,0xbf52a649bf4bbbf8,0xbf5f20dbbf591e6a
.quad 0xbf5b941abf54db31,0xbf676bd8bf61c598,0xbf6398acbf5d2d53,0xbf6e8ff8bf696591,0xbf6aab7bbf64aa59,0xbf748422bf6ff573,0xbf70c501bf6b4b0c,0xbf7940c0bf756d97
.quad 0xbf75dec6bf710908,0xbf7cbfc9bf79c79d,0xbf79f35ebf75dec6,0xbf7efcc9bf7cfe73,0xbf7cfe73bf79c79d,0xbf7ff4e6bf7f0e58,0xbf7efcc9bf7cbfc9,0xbf7fa6e3bf7ff4e6
.quad 0xbf7fec43bf7ec46d,0xbf7e1324bf7fb10f,0xbf7fcbe2bf7fd397,0xbf7b3babbf7e4323,0xbf7e9bc9bf7fec43,0xbf772417bf7baccd,0xbf7c5d3abf7f0e58,0xbf71d19fbf77f110
.quad 0xbf791298bf7d3aac,0xbf6b4b0cbf731447,0xbf74bf62bf7a7302,0xbf6398acbf6d1c1d,0xbf6f6830bf76ba07,0xbf5ac450bf660f88,0xbf6912aebf721352,0xbf50d937bf5df6be
.quad 0x3f8000003f800000,0x3f8000003f800000,0x3f7f3f543f7f4e6d,0x3f7f1f493f7f2f9d,0x3f7cfe733f7d3aac,0x3f7c7eb03f7cbfc9,0x3f7940c03f79c79d,0x3f7822d13f78b47b
.quad 0x3f740bdd3f74fa0b,0x3f7213523f731447,0x3f6d67a13f6ed89e,0x3f6a5ad93f6be858,0x3f655e0b3f676bd8,0x3f6106f23f633c5a,0x3f5bfb343f5ebe05,0x3f5627fe3f591e6a
.quad 0x3f514d3d3f54db31,0x3f49d1123f4d9f02,0x3f4564393f49d112,0x3f3c17d93f40d0da,0x3f3852163f3daef9,0x3f2d14693f32c8c9,0x3f2a2a803f3085bb,0x3f1ce11f3f239da9
.quad 0x3f1b02c63f226799,0x3f0b9a6b3f13682a,0x3f0af1b73f13682a,0x3ef2bd433f0242b1,0x3ef41f073f039c3d,0x3ecc9b8b3ee0924f,0x3ed0eb2a3ee63375,0x3ea5129f3ebb31a0
.quad 0x3eac7cd43ec3ef15,0x3e78cfcc3e94a031,0x3e870ada3ea09ae5,0x3e25c58c3e5a3997,0x3e419b373e78cfcc,0x3da3308c3e09cf86,0x3de7fa9a3e2f10a2,0xbb490fc63d621469
.quad 0x3d16c32c3dc8bd36,0xbdafb680bcc90ab0,0xbd2351cb3cc90ab0,0xbe2bf804bdd53db9,0xbdee3876bd48fb30,0xbe7ee6e1be3b6ecf,0xbe44b0b9bdfab273,0xbea80b1fbe8586ce
.quad 0xbe888e93be47c5c2,0xbecf7bcabeac7cd4,0xbeadf73cbe888e93,0xbef58035bed25a09,0xbed25a09beac7cd4,0xbf0cead0bef6e0cb,0xbef58035becf7bca,0xbf1e1e22bf0cead0
.quad 0xbf0b9a6bbef15aea,0xbf2e3bdebf1d7fd1,0xbf1ba299bf08f59b,0xbf3d27b8bf2d1469,0xbf2ac082bf187fc0,0xbf4ac77fbf3b8f3b,0xbf38dd65bf273656,0xbf570348bf48d8b3
.quad 0x3f8000003f800000,0x3f8000003f800000,0x3f7efcc93f7f0e58,0x3f7ed7d43f7eea9d,0x3f7bf5313f7c3b28,0x3f7b61fc3f7baccd,0x3f76ef5b3f778bc5,0x3f75a67b3f764d97
.quad 0x3f6ff5733f710908,0x3f6db2933f6ed89e,0x3f6715993f68bf3c,0x3f6398ac3f655e0b,0x3f5c61c73f5ebe05,0x3f5770263f59f26a,0x3f4fefa83f531849,0x3f4955213f4cae79
.quad 0x3f41d8703f45e403,0x3f3968423f3daef9,0x3f3238aa3f373a23,0x3f27ce613f2d1469,0x3f212ff93f273656,0x3f14b0393f1b02c6,0x3f0ee0db3f15f6d9,0x3f003a063f07a136
.quad 0x3ef6e0cb3f039c3d,0x3ed536413ee63375,0x3ece0bea3ee0924f,0x3ea80b1f3ebb31a0,0x3ea395c53eb8442a,0x3e72b6513e8e9a22,0x3e6fa8b23e8e9a22,0x3e1324ca3e419b37
.quad 0x3e1640833e47c5c2,0x3d48fb303dc8bd36,0x3d6ea0383de1bc2e,0xbd3c6dd53bc90f88,0xbcfb49ba3cc90ab0,0xbe1008b7bdafb680,0xbdf475c0bd7b2b74,0xbe6fa8b2be354098
.quad 0xbe541501be164083,0xbea68f12be888e93,0xbe9620d2be6c9a7f,0xbed3c867beb554ec,0xbec1071ebea09ae5,0xbeff17b2bee0924f,0xbeea6681bec9b953,0xbf140c5fbf04f484
.quad 0xbf08f59bbef15aea,0xbf273656bf187fc0,0xbf1ba299bf0b9a6b,0xbf38dd65bf2ac082,0xbf2d1469bf1d7fd1,0xbf48d8b3bf3b8f3b,0xbf3d27b8bf2e3bde,0xbf570348bf4ac77f
.quad 0xbf4bbbf8bf3daef9,0xbf633c5abf584853,0xbf58b3a1bf4bbbf8,0xbf6d67a1bf63f473,0xbf63f473bf584853,0xbf756d97bf6db293,0xbf6d67a1bf633c5a,0xbf7b3babbf756d97
.quad 0x8000000080000000,0x8000000080000000,0xbd9cecf9bd96a905,0xbda973babda3308c,0xbe1c76debe164083,0xbe28defcbe22abb6,0xbe698bbabe605c13,0xbe7bdba4be72b651
.quad 0xbe9aa086be94a031,0xbea68f12bea09ae5,0xbebf926fbeb8442a,0xbece0beabec6d529,0xbee363fabedae880,0xbef41f07beebcbbb,0xbf02ef9fbefc5d27,0xbf0c42c9bf07a136
.quad 0xbf13682abf0e39da,0xbf1d7fd1bf187fc0,0xbf2302d3bf1d7fd1,0xbf2da859bf286605,0xbf31a81dbf2beb4a,0xbf3ca003bf373a23,0xbf3f41fcbf396842,0xbf4a4c87bf44e3f5
.quad 0xbf4bbbf8bf45e403,0xbf5695e5bf514d3d,0xbf570348bf514d3d,0xbf61668abf5c61c7,0xbf6106f2bf5b941a,0xbf6aab7bbf660f88,0xbf69b7e4bf64aa59,0xbf725470bf6e46be
.quad 0xbf710908bf6c835e,0xbf7853f8bf74fa0b,0xbf76ef5bbf731447,0xbf7c9f8abf7a1e84,0xbf7b61fcbf7853f8,0xbf7f2f9dbf7dabcc,0xbf7e5a38bf7c3b28,0xbf7fffb1bf7f9c18
.quad 0xbf7fd397bf7ec46d,0xbf7f0e58bf7fec43,0xbf7fcbe2bf7fec43,0xbf7c5d3abf7e9bc9,0xbf7e4323bf7fb10f,0xbf77f110bf7baccd,0xbf7b3babbf7e1324,0xbf71d19fbf772417
.quad 0xbf76ba07bf7b14be,0xbf6a09a7bf710908,0xbf70c501bf76ba07,0xbf60a6cfbf696591,0xbf696591bf710908,0xbf55b993bf604621,0xbf60a6cfbf6a09a7,0xbf495521bf55b993
.quad 0xbf5695e5bf61c598,0xbf3b8f3bbf49d112,0xbf4b41fabf584853,0xbf2c800fbf3ca003,0xbf3ebc1bbf4d9f02,0xbf1c420cbf2e3bde,0xbf311722bf41d870,0xbf0af1b7bf1ebc12
.quad 0x8000000080000000,0x8000000080000000,0xbdb5f8dabdafb680,0xbdc27c39bdbc3ac3,0xbe354098be2f10a2,0xbe419b37be3b6ecf,0xbe870adabe827dc0,0xbe901c2cbe8b9507
.quad 0xbeb263efbeac7cd4,0xbebe1d4abeb8442a,0xbedc53c1bed53641,0xbeea6681bee363fa,0xbf0242b1befc5d27,0xbf0a48adbf064b82,0xbf1553b7bf10d3cd,0xbf1e1e22bf19c200
.quad 0xbf273656bf226799,0xbf3085bbbf2beb4a,0xbf37c655bf32c8c9,0xbf4154e1bf3ca003,0xbf46e22abf41d870,0xbf5064afbf4bbbf8,0xbf546b3bbf4f7a1f,0xbf5d924dbf591e6a
.quad 0xbf604621bf5b941a,0xbf68bf3cbf64aa59,0xbf6a5ad9bf660f88,0xbf71d19fbf6e46be,0xbf7294f8bf6ed89e,0xbf78b47bbf75dec6,0xbf78e3d6bf75dec6,0xbf7d57debf7b61fc
.quad 0xbf7d3aacbf7b14be,0xbf7fb10fbf7ec46d,0xbf7f90b1bf7e70b0,0xbf7fba9ebf7ffec4,0xbf7fe129bf7fec43,0xbf7d7474bf7f0e58,0xbf7e2b72bf7f84ab,0xbf78e3d6bf7bf531
.quad 0xbf7a7302bf7d3aac,0xbf721352bf76ba07,0xbf74bf62bf791298,0xbf6912aebf6f6830,0xbf6d1c1dbf731447,0xbf5df6bebf660f88,0xbf6398acbf6b4b0c,0xbf50d937bf5ac450
.quad 0xbf584853bf61c598,0xbf41d870bf4d9f02,0xbf4b41fabf5695e5,0xbf311722bf3ebc1b,0xbf3ca003bf49d112,0xbf1ebc12bf2e3bde,0xbf2c800fbf3b8f3b,0xbf0af1b7bf1c420c
.quad 0xbf1b02c6bf2beb4a,0xbeebcbbbbf08f59b,0xbf084b92bf1b02c6,0xbebf926fbee900b7,0xbee900b7bf08f59b,0xbe919dddbebe1d4a,0xbebf926fbeebcbbb,0xbe44b0b9be919ddd
.quad 0x3f8000003f800000,0x3f8000003f800000,0x3f7eb0693f7ec46d,0x3f7e868b3f7e9bc9,0x3f7ac5163f7b14be,0x3f7a1e843f7a7302,0x3f74484b3f74fa0b,0x3f72d4eb3f73913f
.quad 0x3f6b4b0c3f6c835e,0x3f68bf3c3f6a09a7,0x3f5fe4e93f61c598,0x3f5bfb343f5df6be,0x3f5233c63f54db31,0x3f4cae793f4f7a1f,0x3f425b893f45e403,0x3f3b06293f3ebc1b
.quad 0x3f3085bb3f3504f3,0x3f2736563f2beb4a,0x3f1ce11f3f226799,0x3f11796b3f173c07,0x3f07a1363f0e39da,0x3ef41f073f00e7e4,0x3ee1fb6a3ef15aea,0x3ec27b553ed25a09
.quad 0x3eb263ef3ec3ef15,0x3e8e9a223ea09ae5,0x3e80f8c03e94a031,0x3e3228d43e5a3997,0x3e1c76de3e47c5c2,0x3d8a200a3de1bc2e,0x3d55880e3dc8bd36,0xbd2351cb3bc90f88
.quad 0xbd48fb30248d3132,0xbe164083bdc8bd36,0xbe195be0bdc8bd36,0xbe80f8c0be4dee60,0xbe7ee6e1be47c5c2,0xbeb554ecbe9aa086,0xbeb0eacbbe94a031,0xbee79a5dbecc9b8b
.quad 0xbee0924fbec3ef15,0xbf0b9a6bbefc5d27,0xbf06f686bef15aea,0xbf21cbfbbf14b039,0xbf1c420cbf0e39da,0xbf36206cbf299415,0xbf2ff3e6bf226799,0xbf485bcabf3ca003
.quad 0xbf41d870bf3504f3,0xbf584853bf4d9f02,0xbf51c0c2bf45e403,0xbf65b710bf5c61c7,0xbf5f8327bf54db31,0xbf708066bf68bf3c,0xbf6afb8cbf61c598,0xbf788486bf7294f8
.quad 0xbf740bddbf6c835e,0xbf7dabccbf79c79d,0xbf7a9c59bf74fa0b,0xbf7fe705bf7e4323,0xbf7e9bc9bf7b14be,0xbf7f2f9dbf7ffb11,0xbf7fffb1bf7ec46d,0xbf7b87b2bf7eea9d
.quad 0x3f8000003f800000,0x3f8000003f800000,0x3f7e5a383f7e70b0,0x3f7e2b723f7e4323,0x3f796e4e3f79c79d,0x3f78b47b3f791298,0x3f714c7a3f721352,0x3f6faf1b3f708066
.quad 0x3f660f883f676bd8,0x3f633c5a3f64aa59,0x3f57dc7f3f59f26a,0x3f5389c73f55b993,0x3f46e22a3f49d112,0x3f40d0da3f43e200,0x3f33587a3f373a23,0x3f2b561b3f2f61a5
.quad 0x3f1d7fd13f226799,0x3f13682a3f187fc0,0x3f05a02c3f0b9a6b,0x3ef2bd433eff17b2,0x3ed8106b3ee63375,0x3ebb31a03ec9b953,0x3ea218873eb263ef,0x3e80f8c03e919ddd
.quad 0x3e5415013e78cfcc,0x3e09cf863e2f10a2,0x3dc27c393e09cf86,0x3c7b514b3d621469,0xbc96c9b63cc90ab0,0xbdd53db9bd7b2b74,0xbe06b26ebdafb680,0xbe636c83be354098
.quad 0xbe78cfccbe47c5c2,0xbeac7cd4be94a031,0xbeb3dca5be9aa086,0xbee4cbfebecc9b8b,0xbee900b7becf7bca,0xbf0cead0bf00e7e4,0xbf0d9281bf00e7e4,0xbf256bcbbf19c200
.quad 0xbf24d225bf187fc0,0xbf3b8f3bbf3085bb,0xbf39f2acbf2e3bde,0xbf4f0417bf44e3f5,0xbf4cae79bf41d870,0xbf5f8327bf5695e5,0xbf5cc7d1bf531849,0xbf6cd007bf655e0b
.quad 0xbf6a09a7bf61c598,0xbf76ba07bf710908,0xbf74484bbf6db293,0xbf7d1cddbf796e4e,0xbf7b61fcbf76ba07,0xbf7fe129bf7e70b0,0xbf7f3f54bf7cbfc9,0xbf7efcc9bf7ffec4
.quad 0xbf7fd397bf7fb10f,0xbf7a7302bf7e1324,0xbf7d1cddbf7f84ab,0xbf725470bf78b47b,0xbf772417bf7c3b28,0xbf66beccbf6ff573,0xbf6dfcf2bf75dec6,0xbf57dc7fbf63f473
.quad 0x8000000080000000,0x8000000080000000,0xbdcefdb7bdc8bd36,0xbddb7d37bdd53db9,0xbe4dee60be47c5c2,0xbe5a3997be541501,0xbe9920febe94a031,0xbea21887be9d9e78
.quad 0xbec9b953bec3ef15,0xbed53641becf7bca,0xbef840c8bef15aea,0xbf02ef9fbeff17b2,0xbf121eb0bf0e39da,0xbf19c200bf15f6d9,0xbf269de3bf226799,0xbf2ecef7bf2ac082
.quad 0xbf396842bf3504f3,0xbf41d870bf3daef9,0xbf4a4c87bf45e403,0xbf52a649bf4e8d90,0xbf591e6abf54db31,0xbf6106f2bf5d2d53,0xbf65b710bf61c598,0xbf6cd007bf696591
.quad 0xbf6ff573bf6c835e,0xbf75dec6bf731447,0xbf77beb7bf74fa0b,0xbf7c187abf7a1e84,0xbf7cfe73bf7b14be,0xbf7f6ac7bf7e70b0,0xbf7fa6e3bf7ec46d,0xbf7fcbe2bf7ffec4
.quad 0xbf7fb10fbf800000,0xbf7d3aacbf7ec46d,0xbf7d1cddbf7ec46d,0xbf77beb7bf7ac516,0xbf77f110bf7b14be,0xbf6f6830bf740bdd,0xbf703b37bf74fa0b,0xbf644facbf6aab7b
.quad 0xbf660f88bf6c835e,0xbf5695e5bf5ebe05,0xbf5988adbf61c598,0xbf466354bf5064af,0xbf4ac77fbf54db31,0xbf33e7bcbf3fc767,0xbf39f2acbf45e403,0xbf1f599fbf2d1469
.quad 0xbf273656bf3504f3,0xbf08f59bbf187fc0,0xbf12c39abf226799,0xbee1fb6abf0242b1,0xbef9a02dbf0e39da,0xbeaf713abed53641,0xbecb2aaebef15aea,0xbe75c35abea395c5
.quad 0xbe9aa086bec3ef15,0xbe09cf86be605c13,0xbe5101f1be94a031,0xbce22a7abdee3876,0xbdd53db9be47c5c2,0x3da3308cbc490e90,0xbb490fc6bdc8bd36,0x3e3e853e3dbc3ac3
.quad 0x8000000080000000,0x8000000080000000,0xbde7fa9abde1bc2e,0xbdf475c0bdee3876,0xbe667c66be605c13,0xbe72b651be6c9a7f,0xbeab0201bea68f12,0xbeb3dca5beaf713a
.quad 0xbee0924fbedae880,0xbeebcbbbbee63375,0xbf099f4ebf064b82,0xbf102dd5bf0cead0,0xbf212ff9bf1d7fd1,0xbf286605bf24d225,0xbf36ad7fbf32c8c9,0xbf3e35c5bf3a7ca4
.quad 0xbf49d112bf45e403,0xbf514d3dbf4d9f02,0xbf5a5ba0bf5695e5,0xbf61668abf5df6be,0xbf6816a8bf64aa59,0xbf6e46bebf6b4b0c,0xbf72d4ebbf6ff573,0xbf77beb7bf756d97
.quad 0xbf7a7302bf7853f8,0xbf7dabccbf7c3b28,0xbf7ed7d4bf7dabcc,0xbf7ff84abf7f9c18,0xbf7ff4e6bf7fec43,0xbf7e9bc9bf7f84ab,0xbf7dc68cbf7f0e58,0xbf799b43bf7bf531
.quad 0xbf7853f8bf7b14be,0xbf710908bf74fa0b,0xbf6faf1bbf740bdd,0xbf650479bf6aab7b,0xbf63f473bf6a09a7,0xbf55b993bf5d2d53,0xbf554aa4bf5d2d53,0xbf436051bf4cae79
.quad 0xbf43e200bf4d9f02,0xbf2e3bdebf396842,0xbf2ff3e6bf3b8f3b,0xbf16999fbf239da9,0xbf19c200bf273656,0xbef9a02dbf0b9a6b,0xbf019573bf10d3cd,0xbec27b55bee363fa
.quad 0xbecf7bcabef15aea,0xbe888e93beac7cd4,0xbe9920febebe1d4a,0xbe195be0be667c66,0xbe419b37be888e93,0xbcfb49babde1bc2e,0xbd9cecf9be22abb6,0x3db5f8da3bc90f88
.quad 0x3d16c32cbd48fb30,0x3e5415013dfab273,0x3e195be03d7b2b74,0x3ea5129f3e72b651,0x3e8586ce3e2f10a2,0x3eddbe793eb263ef,0x3ebca7af3e8e9a22,0x3f099f4e3ee900b7
.quad 0x3f8000003f800000,0x3f8000003f800000,0x3f7dfa383f7e1324,0x3f7dc68c3f7de0b1,0x3f77f1103f7853f8,0x3f7724173f778bc5,0x3f6dfcf23f6ed89e,0x3f6c36243f6d1c1d
.quad 0x3f6046213f61c598,0x3f5d2d533f5ebe05,0x3f4f04173f514d3d,0x3f4a4c873f4cae79,0x3f3a7ca43f3daef9,0x3f33e7bc3f373a23,0x3f2302d33f273656,0x3f1a62933f1ebc12
.quad 0x3f08f59b3f0e39da,0x3efc5d273f039c3d,0x3ed97cb93ee63375,0x3ebf926f3ecc9b8b,0x3e9d9e783eac7cd4,0x3e7ee6e13e8e9a22,0x3e3e853e3e605c13,0x3df475c03e1c76de
.quad 0x3d7b2b743dc8bd36,0xbc490e903cc90ab0,0xbd83db0abcc90ab0,0xbe1324cabdd53db9,0xbe419b37be164083,0xbe8b9507be6c9a7f,0xbe9f1cdfbe888e93,0xbecb2aaebeb554ec
.quad 0xbedae880bec3ef15,0xbf039c3dbef15aea,0xbf099f4ebefc5d27,0xbf1f599fbf14b039,0xbf239da9bf187fc0,0xbf385216bf2e3bde,0xbf3b0629bf3085bb,0xbf4e1689bf44e3f5
.quad 0xbf4f7a1fbf45e403,0xbf604621bf584853,0xbf60a6cfbf584853,0xbf6e8ff8bf6816a8,0xbf6e46bebf676bd8,0xbf78b47bbf740bdd,0xbf7822d1bf731447,0xbf7e868bbf7bf531
.quad 0xbf7e1324bf7b14be,0xbf7fec43bf7fb10f,0xbf7fffb1bf7f4e6d,0xbf7cdf6cbf7f2f9d,0xbf7de0b1bf7fb10f,0xbf756d97bf7a7302,0xbf77beb7bf7c3b28,0xbf69b7e4bf718f57
.quad 0xbf6db293bf74fa0b,0xbf59f26abf64aa59,0xbf5fe4e9bf6a09a7,0xbf466354bf53fac3,0xbf4e8d90bf5b941a,0xbf2f61a5bf3fc767,0xbf39f2acbf49d112,0xbf1553b7bf286605
.quad 0x3f8000003f800000,0x3f8000003f800000,0x3f7d906e3f7dabcc,0x3f7d57de3f7d7474,0x3f764d973f76ba07,0x3f756d973f75dec6,0x3f6a5ad93f6b4b0c,0x3f686b393f696591
.quad 0x3f59f26a3f5b941a,0x3f5695e53f584853,0x3f4564393f47de65,0x3f404c5c3f42de29,0x3f2d14693f3085bb,0x3f26050a3f299415,0x3f11796b3f15f6d9,0x3f084b923f0cead0
.quad 0x3ee633753ef15aea,0x3ecf7bca3edae880,0x3ea5129f3eb263ef,0x3e8a11f73e97a117,0x3e419b373e605c13,0x3e0395023e22abb6,0x3d55880e3dafb680,0xbc7b514b3c96c9b6
.quad 0xbdafb680bd48fb30,0xbe22abb6bdfab273,0xbe636c83be3b6ecf,0xbe9920febe8586ce,0xbeb554ecbea09ae5,0xbeddbe79bec9b953,0xbef58035bee0924f,0xbf0ee0dbbf04f484
.quad 0xbf187fc0bf0e39da,0xbf2beb4abf226799,0xbf33587abf299415,0xbf456439bf3ca003,0xbf4ac77fbf41d870,0xbf5ac450bf531849,0xbf5e5aa6bf5695e5,0xbf6b99fbbf655e0b
.quad 0xbf6db293bf676bd8,0xbf778bc5bf731447,0xbf788486bf740bdd,0xbf7e5a38bf7bf531,0xbf7e9bc9bf7c3b28,0xbf7fe129bf7fd397,0xbf7fdaafbf7fd397,0xbf7c187abf7e9bc9
.quad 0xbf7c3b28bf7ec46d,0xbf731447bf7853f8,0xbf73ced9bf791298,0xbf650479bf6d1c1d,0xbf66beccbf6ed89e,0xbf5233c6bf5d2d53,0xbf554aa4bf604621,0xbf3b0629bf48d8b3
.quad 0xbf3fc767bf4d9f02,0xbf1ff6cbbf3085bb,0xbf269de3bf373a23,0xbf019573bf14b039,0xbf0a48adbf1d7fd1,0xbec1071ebeebcbbb,0xbed6a399bf00e7e4,0xbe75c35abea986c4
.quad 0x8000000080000000,0x8000000080000000,0xbe007745bdfab273,0xbe06b26ebe039502,0xbe7ee6e1be78cfcc,0xbe8586cebe827dc0,0xbebca7afbeb8442a,0xbec5625cbec1071e
.quad 0xbef6e0cbbef15aea,0xbf00e7e4befc5d27,0xbf16999fbf13682a,0xbf1ce11fbf19c200,0xbf2f61a5bf2beb4a,0xbf36206cbf32c8c9,0xbf456439bf41d870,0xbf4c3578bf48d8b3
.quad 0xbf584853bf54db31,0xbf5ebe05bf5b941a,0xbf67c187bf64aa59,0xbf6d67a1bf6aab7b,0xbf73913fbf710908,0xbf77f110bf75dec6,0xbf7b87b2bf79c79d,0xbf7e2b72bf7cfe73
.quad 0xbf7f84abbf7ec46d,0xbf7ffb11bf7fec43,0xbf7f7808bf7fec43,0xbf7d57debf7e9bc9,0xbf7b61fcbf7d3aac,0xbf764d97bf791298,0xbf73530ebf76ba07,0xbf6afb8cbf6f6830
.quad 0xbf676bd8bf6c835e,0xbf5b941abf61c598,0xbf57dc7fbf5ebe05,0xbf485bcabf5064af,0xbf44e3f5bf4d9f02,0xbf31a81dbf3b8f3b,0xbf2ecef7bf396842,0xbf17de12bf239da9
.quad 0xbf15f6d9bf226799,0xbef6e0cbbf08f59b,0xbef58035bf08f59b,0xbeb9bb1ebed8106b,0xbebb31a0bedae880,0xbe72b651be9aa086,0xbe7bdba4bea09ae5,0xbddb7d37be354098
.quad 0xbdfab273be47c5c2,0x3cc90ab0bd48fb30,0x3b490fc6bd96a905,0x3e1f917b3da3308c,0x3e0395023d48fb30,0x3e919ddd3e541501,0x3e80f8c03e2f10a2,0x3ed0eb2a3ea986c4
.quad 0x3ebe1d4a3e94a031,0x3f064b823ee63375,0x3ef840c83ecf7bca,0x3f21cbfb3f0f8784,0x3f173c073f039c3d,0x3f3a7ca43f299415,0x3f2ff3e63f1d7fd1,0x3f4fefa83f40d0da
.quad 0x8000000080000000,0x8000000080000000,0xbe0cec4abe09cf86,0xbe1324cabe1008b7,0xbe8b9507be888e93,0xbe919dddbe8e9a22,0xbece0beabec9b953,0xbed6a399bed25a09
.quad 0xbf064b82bf039c3d,0xbf0b9a6bbf08f59b,0xbf2302d3bf1ff6cb,0xbf28fd41bf26050a,0xbf3ca003bf396842,0xbf42de29bf3fc767,0xbf52a649bf4f7a1f,0xbf58b3a1bf55b993
.quad 0xbf64aa59bf61c598,0xbf6a09a7bf676bd8,0xbf725470bf6ff573,0xbf76841bbf748422,0xbf7b61fcbf79c79d,0xbf7de0b1bf7cbfc9,0xbf7fa6e3bf7f0e58,0xbf7ff84abf7ff4e6
.quad 0xbf7f0e58bf7fb10f,0xbf7cbfc9bf7e1324,0xbf799b43bf7baccd,0xbf74484bbf772417,0xbf6f6830bf731447,0xbf66beccbf6b4b0c,0xbf60a6cfbf660f88,0xbf546b3bbf5ac450
.quad 0xbf4d9f02bf54db31,0xbf3daef9bf45e403,0xbf36ad7fbf3fc767,0xbf2302d3bf2d1469,0xbf1c420cbf273656,0xbf04f484bf10d3cd,0xbefdbabbbf0b9a6b,0xbec8477cbee363fa
.quad 0xbebe1d4abedae880,0xbe827dc0bea09ae5,0xbe75c35abe9aa086,0xbde7fa9abe354098,0xbdd53db9be2f10a2,0x3cfb49babd16c32c,0x3d0a342fbd16c32c,0x3e3228d43dd53db9
.quad 0x3e2f10a23dc8bd36,0x3ea09ae53e78cfcc,0x3e9c1faf3e6c9a7f,0x3ee4cbfe3ec1071e,0x3eddbe793eb8442a,0x3f121eb03f00e7e4,0x3f0d92813ef6e0cb,0x3f2ecef73f1ebc12
.quad 0x3f2994153f187fc0,0x3f47de653f396842,0x3f425b893f32c8c9,0x3f5cc7d13f5064af,0x3f5770263f49d112,0x3f6d1c1d3f633c5a,0x3f686b393f5d2d53,0x3f7884863f718f57
.quad 0x3f8000003f800000,0x3f8000003f800000,0x3f7d1cdd3f7d3aac,0x3f7cdf6c3f7cfe73,0x3f7484223f74fa0b,0x3f73913f3f740bdd,0x3f6667713f676bd8,0x3f644fac3f655e0b
.quad 0x3f5318493f54db31,0x3f4f7a1f3f514d3d,0x3f3b06293f3daef9,0x3f3592e73f385216,0x3f1ebc123f226799,0x3f173c073f1b02c6,0x3efdbabb3f039c3d,0x3eea66813ef41f07
.quad 0x3eb8442a3ec3ef15,0x3ea09ae53eac7cd4,0x3e5d4b1a3e78cfcc,0x3e25c58c3e419b37,0x3d8a200a3dc8bd36,0x3bc90f883d16c32c,0xbda973babd48fb30,0xbe195be0bdee3876
.quad 0xbe6c9a7fbe47c5c2,0xbe9aa086be888e93,0xbebf926fbeac7cd4,0xbee4cbfebed25a09,0xbf0242b1bef15aea,0xbf14b039bf0b9a6b,0xbf21cbfbbf187fc0,0xbf33587abf2ac082
.quad 0xbf3daef9bf3504f3,0xbf4d9f02bf45e403,0xbf554aa4bf4d9f02,0xbf62df7bbf5c61c7,0xbf6816a8bf61c598,0xbf7294f8bf6db293,0xbf75a67bbf710908,0xbf7c5d3abf796e4e
.quad 0xbf7dabccbf7b14be,0xbf7ffb11bf7f4e6d,0xbf7ff84abf7fb10f,0xbf7d57debf7f2f9d,0xbf7c7eb0bf7ec46d,0xbf748422bf791298,0xbf73530ebf7853f8,0xbf65b710bf6d1c1d
.quad 0xbf64aa59bf6c835e,0xbf514d3dbf5b941a,0xbf50d937bf5b941a,0xbf37c655bf44e3f5,0xbf385216bf45e403,0xbf19c200bf299415,0xbf1ba299bf2beb4a,0xbeeff7fbbf0a48ad
.quad 0xbef6e0cbbf0e39da,0xbea68f12becf7bca,0xbeb0eacbbedae880,0xbe3228d4be8586ce,0xbe4dee60be94a031,0xbc96c9b6bde1bc2e,0xbd55880ebe164083,0x3e0cec4a3d2fe007
.quad 0x3f8000003f800000,0x3f8000003f800000,0x3f7c9f8a3f7cbfc9,0x3f7c5d3a3f7c7eb0,0x3f7294f83f731447,0x3f718f573f721352,0x3f62241a3f633c5a,0x3f5fe4e93f6106f2
.quad 0x3f4bbbf83f4d9f02,0x3f47de653f49d112,0x3f2ff3e63f32c8c9,0x3f2a2a803f2d1469,0x3f0f87843f13682a,0x3f07a1363f0b9a6b,0x3ed6a3993ee0924f,0x3ec27b553ecc9b8b
.quad 0x3e888e933e94a031,0x3e605c133e78cfcc,0x3ddb7d373e09cf86,0x3d55880e3da3308c,0xbd621469bcc90ab0,0xbdee3876bdafb680,0xbe5d4b1abe3b6ecf,0xbe901c2cbe7ee6e1
.quad 0xbebe1d4abeac7cd4,0xbee0924fbecf7bca,0xbf044889bef6e0cb,0xbf1553b7bf0cead0,0xbf26050abf1d7fd1,0xbf36206cbf2e3bde,0xbf436051bf3b8f3b,0xbf51c0c2bf4ac77f
.quad 0xbf5b941abf54db31,0xbf676bd8bf61c598,0xbf6dfcf2bf68bf3c,0xbf76841bbf7294f8,0xbf7a1e84bf76ba07,0xbf7e9bc9bf7cbfc9,0xbf7fa6e3bf7e70b0,0xbf7f7808bf7ffec4
.quad 0xbf7e70b0bf7fb10f,0xbf791298bf7c3b28,0xbf76841bbf7a7302,0xbf6b99fbbf718f57,0xbf6816a8bf6ed89e,0xbf577026bf604621,0xbf5389c7bf5d2d53,0xbf3d27b8bf48d8b3
.quad 0xbf396842bf45e403,0xbf1d7fd1bf2beb4a,0xbf1a6293bf299415,0xbef2bd43bf0a48ad,0xbeee9479bf08f59b,0xbea395c5bec9b953,0xbea21887bec9b953,0xbe1f917bbe72b651
.quad 0xbe22abb6be78cfcc,0x3c490e90bd96a905,0x3b490fc6bdafb680,0x3e3857ec3dbc3ac3,0x3e28defc3d96a905,0x3eaf713a3e827dc0,0x3ea5129f3e6c9a7f,0x3efdbabb3ed25a09
.quad 0x8000000080000000,0x8000000080000000,0xbe195be0be164083,0xbe1f917bbe1c76de,0xbe97a117be94a031,0xbe9d9e78be9aa086,0xbedf28a9bedae880,0xbee79a5dbee363fa
.quad 0xbf10d3cdbf0e39da,0xbf15f6d9bf13682a,0xbf2ecef7bf2beb4a,0xbf34768fbf31a81d,0xbf48d8b3bf45e403,0xbf4e8d90bf4bbbf8,0xbf5e5aa6bf5b941a,0xbf6398acbf6106f2
.quad 0xbf6ed89ebf6c835e,0xbf731447bf710908,0xbf79f35ebf7853f8,0xbf7c9f8abf7b61fc,0xbf7f6ac7bf7ec46d,0xbf7ffec4bf7fd397,0xbf7f1f49bf7fb10f,0xbf7d1cddbf7e4323
.quad 0xbf791298bf7b14be,0xbf740bddbf76ba07,0xbf6d67a1bf710908,0xbf650479bf696591,0xbf5c61c7bf61c598,0xbf5064afbf5695e5,0xbf466354bf4d9f02,0xbf36ad7fbf3ebc1b
.quad 0xbf2beb4abf3504f3,0xbf187fc0bf226799,0xbf0d9281bf187fc0,0xbeed3063bf0242b1,0xbed8106bbef15aea,0xbea395c5bebe1d4a,0xbe901c2cbeac7cd4,0xbe2bf804be667c66
.quad 0xbe09cf86be47c5c2,0xbc490e90bd96a905,0x3c7b514bbd48fb30,0x3e1324ca3da3308c,0x3e28defc3dc8bd36,0x3e97a1173e6c9a7f,0x3e9f1cdf3e78cfcc,0x3ee1fb6a3ec1071e
.quad 0x3ee633753ec3ef15,0x3f13682a3f039c3d,0x3f140c5f3f039c3d,0x3f3238aa3f239da9,0x3f31a81d3f226799,0x3f4cae793f3fc767,0x3f4b41fa3f3daef9,0x3f62241a3f577026
.quad 0x3f6046213f54db31,0x3f7213523f6a09a7,0x3f703b373f676bd8,0x3f7c187a3f772417,0x3f7ac5163f74fa0b,0x3f7ff4e63f7e70b0,0x3f7fa6e33f7d3aac,0x3f7d906e3f7fc38f
.quad 0x8000000080000000,0x8000000080000000,0xbe25c58cbe22abb6,0xbe2bf804be28defc,0xbea395c5bea09ae5,0xbea986c4bea68f12,0xbeeff7fbbeebcbbb,0xbef840c8bef41f07
.quad 0xbf1b02c6bf187fc0,0xbf1ff6cbbf1d7fd1,0xbf39f2acbf373a23,0xbf3f41fcbf3ca003,0xbf53fac3bf514d3d,0xbf591e6abf5695e5,0xbf686b39bf660f88,0xbf6cd007bf6aab7b
.quad 0xbf76ba07bf74fa0b,0xbf79c79dbf7853f8,0xbf7e868bbf7dabcc,0xbf7fa6e3bf7f2f9d,0xbf7f9c18bf7fec43,0xbf7e4323bf7f0e58,0xbf79f35ebf7baccd,0xbf75a67bbf77f110
.quad 0xbf6db293bf710908,0xbf660f88bf6a09a7,0xbf5b2c79bf604621,0xbf4fefa8bf55b993,0xbf42de29bf49d112,0xbf33e7bcbf3b8f3b,0xbf256bcbbf2e3bde,0xbf12c39abf1c420c
.quad 0xbf039c3dbf0e39da,0xbedae880bef15aea,0xbebca7afbed53641,0xbe8a11f7bea395c5,0xbe5a3997be888e93,0xbdd53db9be22abb6,0xbd55880ebde1bc2e,0x3d83db0a3bc90f88
.quad 0x3de1bc2e3d48fb30,0x3e6c9a7f3e2f10a2,0x3e8a11f73e541501,0x3ec8477c3ea986c4,0x3ed8106b3eb8442a,0x3f0a48ad3ef6e0cb,0x3f102dd53f00e7e4,0x3f2c800f3f1ebc12
.quad 0x3f3085bb3f226799,0x3f49d1123f3daef9,0x3f4c35783f3fc767,0x3f61668a3f577026,0x3f6282103f584853,0x3f7294f83f6b4b0c,0x3f72d4eb3f6b4b0c,0x3f7cdf6c3f78b47b
.quad 0x3f7cbfc93f7853f8,0x3f7ffb113f7f4e6d,0x3f7fffb13f7f0e58,0x3f7bd14d3f7eea9d,0x3f7c7eb03f7f4e6d,0x3f7080663f778bc5,0x3f7254703f791298,0x3f5e5aa63f696591
.quad 0x3f8000003f800000,0x3f8000003f800000,0x3f7c187a3f7c3b28,0x3f7bd14d3f7bf531,0x3f7080663f710908,0x3f6f68303f6ff573,0x3f5d924d3f5ebe05,0x3f5b2c793f5c61c7
.quad 0x3f43e2003f45e403,0x3f3fc7673f41d870,0x3f24381a3f273656,0x3f1e1e223f212ff9,0x3eff17b23f039c3d,0x3eee94793ef6e0cb,0x3eadf73c3eb8442a,0x3e9920fe3ea395c5
.quad 0x3e2f10a23e47c5c2,0x3dfab2733e164083,0xbb490fc63cc90ab0,0xbd6ea038bcfb49ba,0xbe354098be164083,0xbe72b651be541501,0xbeb0eacbbea09ae5,0xbed0eb2abec1071e
.quad 0xbf00e7e4bef15aea,0xbf10d3cdbf08f59b,0xbf256bcbbf1d7fd1,0xbf34768fbf2d1469,0xbf44e3f5bf3daef9,0xbf5233c6bf4bbbf8,0xbf5e5aa6bf584853,0xbf6912aebf63f473
.quad 0xbf710908bf6c835e,0xbf7853f8bf74fa0b,0xbf7c5d3abf79c79d,0xbf7f7808bf7e4323,0xbf7ffec4bf7fb10f,0xbf7e4323bf7f84ab,0xbf7bd14dbf7e1324,0xbf74bf62bf78b47b
.quad 0xbf6ff573bf74fa0b,0xbf633c5abf6a09a7,0xbf5cc7d1bf64aa59,0xbf4a4c87bf53fac3,0xbf42de29bf4d9f02,0xbf2ac082bf373a23,0xbf2302d3bf3085bb,0xbf05a02cbf14b039
.quad 0xbefc5d27bf0e39da,0xbeb8442abedae880,0xbeab0201becf7bca,0xbe3e853ebe8586ce,0xbe28defcbe78cfcc,0xbbc90f88bdafb680,0x3c16cb58bd96a905,0x3e3228d43dbc3ac3
.quad 0x3e3b6ecf3dc8bd36,0x3eb263ef3e888e93,0x3eb3dca53e888e93,0x3f02ef9f3eddbe79,0x3f0242b13edae880,0x3f2866053f15f6d9,0x3f269de33f13682a,0x3f485bca3f385216
.quad 0x3f8000003f800000,0x3f8000003f800000,0x3f7b87b23f7baccd,0x3f7b3bab3f7b61fc,0x3f6e46be3f6ed89e,0x3f6d1c1d3f6db293,0x3f58b3a13f59f26a,0x3f5627fe3f577026
.quad 0x3f3b8f3b3f3daef9,0x3f373a233f396842,0x3f17de123f1b02c6,0x3f11796b3f14b039,0x3eddbe793ee63375,0x3ecc9b8b3ed53641,0x3e8402703e8e9a22,0x3e5d4b1a3e72b651
.quad 0x3d96a9053dc8bd36,0x3cc90ab03d48fb30,0xbde7fa9abdafb680,0xbe2bf804be1008b7,0xbe97a117be888e93,0xbeb554ecbea68f12,0xbeeff7fbbee0924f,0xbf06f686beff17b2
.quad 0xbf1ff6cbbf187fc0,0xbf2e3bdebf273656,0xbf425b89bf3b8f3b,0xbf4f0417bf48d8b3,0xbf5df6bebf584853,0xbf6816a8bf633c5a,0xbf71d19fbf6db293,0xbf788486bf756d97
.quad 0xbf7d3aacbf7b14be,0xbf7fb10fbf7ec46d,0xbf7fcbe2bf7ffb11,0xbf7d57debf7eea9d,0xbf796e4ebf7c3b28,0xbf718f57bf75dec6,0xbf6a5ad9bf6ff573,0xbf5cc7d1bf63f473
.quad 0xbf531849bf5b941a,0xbf3fc767bf49d112,0xbf34768fbf3fc767,0xbf1ba299bf286605,0xbf0f8784bf1d7fd1,0xbee363fabf00e7e4,0xbecb2aaebeebcbbb,0xbe870adabea986c4
.quad 0xbe605c13be94a031,0xbd96a905be164083,0xbd0a342fbde1bc2e,0x3df475c03d2fe007,0x3e1c76de3d96a905,0x3e9d9e783e6c9a7f,0x3eab02013e827dc0,0x3ef840c83ed25a09
.quad 0x3f00e7e43edae880,0x3f24d2253f13682a,0x3f27ce613f15f6d9,0x3f4760853f385216,0x3f48d8b33f396842,0x3f6282103f5695e5,0x3f62df7b3f5695e5,0x3f75341d3f6d1c1d
.quad 0x8000000080000000,0x8000000080000000,0xbe3228d4be2f10a2,0xbe3857ecbe354098,0xbeaf713abeac7cd4,0xbeb554ecbeb263ef,0xbf003a06befc5d27,0xbf044889bf0242b1
.quad 0xbf24d225bf226799,0xbf299415bf273656,0xbf446337bf41d870,0xbf495521bf46e22a,0xbf5df6bebf5b941a,0xbf628210bf604621,0xbf70c501bf6ed89e,0xbf74484bbf7294f8
.quad 0xbf7c3b28bf7b14be,0xbf7e1324bf7d3aac,0xbf7fffb1bf7fec43,0xbf7f90b1bf7fe129,0xbf7bf531bf7d3aac,0xbf78b47bbf7a7302,0xbf703b37bf731447,0xbf69b7e4bf6d1c1d
.quad 0xbf5d2d53bf61c598,0xbf531849bf584853,0xbf436051bf49d112,0xbf3592e7bf3ca003,0xbf239da9bf2beb4a,0xbf121eb0bf1b02c6,0xbefdbabbbf08f59b,0xbed3c867bee900b7
.quad 0xbeac7cd4bec3ef15,0xbe78cfccbe94a031,0xbe2bf804be605c13,0xbd83db0abdee3876,0x3bc90f88bd48fb30,0x3dee38763d7b2b74,0x3e3857ec3dfab273,0x3e9620d23e72b651
.quad 0x3eb263ef3e94a031,0x3eebcbbb3ecf7bca,0x3f0195733ee63375,0x3f1ce11f3f0f8784,0x3f26050a3f187fc0,0x3f3ebc1b3f32c8c9,0x3f4564393f396842,0x3f5a5ba03f5064af
.quad 0x3f5ebe053f54db31,0x3f6ed89e3f676bd8,0x3f714c7a3f6a09a7,0x3f7b87b23f772417,0x3f7c7eb03f7853f8,0x3f7ffec43f7f0e58,0x3f7ffd393f7f4e6d,0x3f7c187a3f7eea9d
.quad 0x3f7baccd3f7ec46d,0x3f6ff5733f76ba07,0x3f6faf1b3f76ba07,0x3f5bfb343f66becc,0x3f5c61c73f676bd8,0x3f40d0da3f4f7a1f,0x3f425b893f514d3d,0x3f1f599f3f31a81d
.quad 0x8000000080000000,0x8000000080000000,0xbe3e853ebe3b6ecf,0xbe44b0b9be419b37,0xbebb31a0beb8442a,0xbec1071ebebe1d4a,0xbf084b92bf064b82,0xbf0c42c9bf0a48ad
.quad 0xbf2e3bdebf2beb4a,0xbf32c8c9bf3085bb,0xbf4e1689bf4bbbf8,0xbf52a649bf5064af,0xbf66beccbf64aa59,0xbf6aab7bbf68bf3c,0xbf77583abf75dec6,0xbf79f35ebf78b47b
.quad 0xbf7f4e6dbf7ec46d,0xbf7fec43bf7fb10f,0xbf7e5a38bf7f0e58,0xbf7c5d3abf7d7474,0xbf748422bf76ba07,0xbf6f6830bf721352,0xbf62241abf660f88,0xbf5988adbf5df6be
.quad 0xbf47de65bf4d9f02,0xbf3b8f3bbf41d870,0xbf269de3bf2e3bde,0xbf16999fbf1ebc12,0xbeff17b2bf08f59b,0xbed8106bbeebcbbb,0xbea80b1fbebe1d4a,0xbe75c35abe919ddd
.quad 0xbe164083be47c5c2,0xbd48fb30bdc8bd36,0x3d2351cbbc490e90,0x3e1324ca3dbc3ac3,0x3e667c663e2f10a2,0x3ea986c43e8e9a22,0x3ece0bea3eb263ef,0x3f0195733ee900b7
.quad 0x3f10d3cd3f039c3d,0x3f2994153f1d7fd1,0x3f3592e73f299415,0x3f4b41fa3f40d0da,0x3f53fac33f49d112,0x3f655e0b3f5d2d53,0x3f6afb8c3f633c5a,0x3f76ef5b3f718f57
.quad 0x3f79c79d3f74fa0b,0x3f7f4e6d3f7d3aac,0x3f7fdaaf3f7e70b0,0x3f7e2b723f7fc38f,0x3f7cfe733f7f4e6d,0x3f73913f3f791298,0x3f714c7a3f778bc5,0x3f5fe4e93f696591
.quad 0x3f5d2d533f676bd8,0x3f43e2003f514d3d,0x3f4154e13f4f7a1f,0x3f2093933f31a81d,0x3f1ebc123f3085bb,0x3eee94793f0b9a6b,0x3eed30633f0b9a6b,0x3e931f353ec1071e
.quad 0x3612492536124925,0x3612492536124925,0x361248f736124925,0x3612478f36124870,0x3612487036124925,0x361242cc36124653,0x3612478f36124925,0x36123ade361242cc
.quad 0x3612465336124925,0x36122fc436123ddd,0x361244bd36124925,0x3612217f36123785,0x361242cc36124925,0x3612100e36122fc4,0x3612408236124925,0x3611fb723612269b
.quad 0x36123ddd36124925,0x3611e3ac36121c09,0x36123ade36124925,0x3611c8bc3612100e,0x3612378536124925,0x3611aaa3361202ab,0x361233d236124925,0x361189613611f3e0
.quad 0x36122fc436124925,0x361164f73611e3ac,0x36122b5d36124925,0x36113d663611d211,0x3612269b36124925,0x361112ae3611bf0e,0x3612217f36124925,0x3610e4d13611aaa3
.quad 0x36121c0936124925,0x3610b3d0361194d1,0x3612163836124925,0x36107fab36117d97,0x3612100e36124925,0x36104865361164f7,0x3612098a36124925,0x36100dfd36114af0
.quad 0x361202ab36124925,0x360fd07536112f82,0x3611fb7236124925,0x360f8fcf361112ae,0x3611f3e036124925,0x360f4c0c3610f474,0x3611ebf336124925,0x360f052e3610d4d5
.quad 0x3611e3ac36124925,0x360ebb353610b3d0,0x3611db0c36124925,0x360e6e2536109166,0x3611d21136124925,0x360e1dfd36106d98,0x3611c8bc36124925,0x360dcac036104865
.quad 0x3611bf0e36124925,0x360d7471361021ce,0x3611b50536124925,0x360d1b10360ff9d3,0x3611aaa336124925,0x360cbe9f360fd075,0x36119fe736124925,0x360c5f21360fa5b5
.quad 0x3612492536124925,0x3612492536124925,0x361244bd36124653,0x36124082361242cc,0x3612378536123ddd,0x3612269b36122fc4,0x3612217f36122fc4,0x3611fb723612100e
.quad 0x361202ab36121c09,0x3611bf0e3611e3ac,0x3611db0c361202ab,0x361171743611aaa3,0x3611aaa33611e3ac,0x361112ae361164f7,0x361171743611bf0e,0x3610a2c8361112ae
.quad 0x36112f82361194d1,0x361021ce3610b3d0,0x3610e4d1361164f7,0x360f8fcf36104865,0x3610916636112f82,0x360eecde360fd075,0x361035463610f474,0x360e390d360f4c0c
.quad 0x360fd0753610b3d0,0x360d7471360ebb35,0x360f62fb36106d98,0x360c9f21360e1dfd,0x360eecde361021ce,0x360bb938360d7471,0x360e6e25360fd075,0x360ac2cf360cbe9f
.quad 0x360de6d7360f7991,0x3609bc05360bfc98,0x360d56fd360f1d26,0x3608a4f7360b2e6d,0x360cbe9f360ebb35,0x36077dc8360a542f,0x360c1dc7360e53c4,0x3606469936096df1
.quad 0x360b747e360de6d7,0x3604ff9036087bc8,0x360ac2cf360d7471,0x3603a8d336077dc8,0x360a08c4360cfc96,0x3602428b36067407,0x36094668360c7f4d,0x3600cce136055e9c
.quad 0x36087bc8360bfc98,0x35fe900636043da0,0x3607a8ef360b747e,0x35fb683c3603112b,0x3606cde9360ae704,0x35f822c33601d958,0x3605eac5360a542f,0x35f4bffe36009641
.quad 0x3604ff903609bc05,0x35f1405335fe9006,0x36040c5836091e8b,0x35eda42d35fbdd75,0x3603112b36087bc8,0x35e9ebf935f9150b,0x36020e193607d3c2,0x35e6182635f63706
.quad 0x0,0x0,0x31e5c8e200000000,0x32ac561c3265c89b,0x3265c89b00000000,0x332c543e32e5c780,0x32ac561c00000000,0x33813cd8332c543e
.quad 0x32e5c78000000000,0x33ac4cc43365c312,0x330f9c2b00000000,0x33d758f4338f97d8,0x332c543e00000000,0x3401303c33ac4cc4,0x33490be600000000,0x3416b13133c90008
.quad 0x3365c31200000000,0x342c2ee133e5b15b,0x33813cd800000000,0x3441a8d53401303c,0x338f97d800000000,0x34571e96340f868b,0x339df27f00000000,0x346c8fad341ddb79
.quad 0x33ac4cc400000000,0x3480fdd1342c2ee1,0x33baa69f00000000,0x348bb100343a80a0,0x33c9000800000000,0x349661273448d093,0x33d758f400000000,0x34a10e0b34571e96
.quad 0x33e5b15b00000000,0x34abb77234656a87,0x33f4093400000000,0x34b65d1f3473b441,0x3401303c00000000,0x34c0fed73480fdd1,0x34085b8e00000000,0x34cb9c6034882044
.quad 0x340f868b00000000,0x34d6357f348f4166,0x3416b13100000000,0x34e0c9f834966127,0x341ddb7900000000,0x34eb5992349d7f75,0x3425056000000000,0x34f5e41134a49c3e
.quad 0x342c2ee100000000,0x3500349d34abb772,0x343357f800000000,0x3505746b34b2d0fd,0x343a80a000000000,0x350ab15334b9e8cf,0x3441a8d500000000,0x350feb3934c0fed7
.quad 0x3448d09300000000,0x3515220134c81302,0x344ff7d500000000,0x351a558c34cf2540,0x34571e9600000000,0x351f85bf34d6357f,0x345e44d300000000,0x3524b27c34dd43ad
.quad 0x0,0x0,0x330f9c2b32e5c780,0x33490be6332c543e,0x338f97d83365c312,0x33c9000833ac4cc4,0x33d758f433ac4cc4,0x3416b1313401303c
.quad 0x340f868b33e5b15b,0x3448d093342c2ee1,0x343357f8340f868b,0x347ad83f34571e96,0x34571e96342c2ee1,0x349661273480fdd1,0x347ad83f3448d093,0x34af446d34966127
.quad 0x348f416634656a87,0x34c8130234abb772,0x34a10e0b3480fdd1,0x34e0c9f834c0fed7,0x34b2d0fd348f4166,0x34f9666434d6357f,0x34c48929349d7f75,0x3508f2af34eb5992
.quad 0x34d6357f34abb772,0x351522013500349d,0x34e7d4ed34b9e8cf,0x35213fb7350ab153,0x34f9666434c81302,0x352d4a6335152201,0x3505746b34d6357f,0x3539409a351f85bf
.quad 0x350e2d9934e44fb9,0x354520f23529dba6,0x3516de3734f26126,0x3550ea04353422d2,0x351f85bf3500349d,0x355c9a6b353e5a5e,0x352823aa350733b6,0x356830c735488167
.quad 0x3530b775350e2d99,0x3573abb83552970b,0x3539409a35152201,0x357f09e5355c9a6b,0x3541be97351c10a8,0x358524fb35668aa8,0x354a30e83522f94b,0x358ab54b357066e6
.quad 0x3552970b3529dba6,0x3590353b357a2e49,0x355af07e3530b775,0x3595a4243581effd,0x35633cc235378c73,0x359b01623586bd8f,0x356b7b55353e5a5e,0x35a04c53358b7f72
.quad 0x3573abb8354520f2,0x35a584583590353b,0x357bcd6e354bdfec,0x35aaa8d13594de81,0x3581effd3552970b,0x35afb92535997ade,0x3585f16e3559460b,0x35b4b4b9359e09eb
.quad 0x3612492536124925,0x3612492536124925,0x36123ade36123ddd,0x361233d236123785,0x3612100e36121c09,0x3611f3e0361202ab,0x3611c8bc3611e3ac,0x361189613611aaa3
.quad 0x361164f7361194d1,0x3610f47436112f82,0x3610e4d136112f82,0x3610354636109166,0x361048653610b3d0,0x360f4c0c360fd075,0x360f8fcf361021ce,0x360e390d360eecde
.quad 0x360ebb35360f7991,0x360cfc96360de6d7,0x360dcac0360ebb35,0x360b9706360cbe9f,0x360cbe9f360de6d7,0x360a08c4360b747e,0x360b9706360cfc96,0x36085244360a08c4
.quad 0x360a542f360bfc98,0x3606740736087bc8,0x3608f659360ae704,0x36046e963606cde9,0x36077dc83609bc05,0x3602428b3604ff90,0x3605eac536087bc8,0x35ffe10a3603112b
.quad 0x36043da03607267f,0x35faf26736010332,0x360276ac3605bc5f,0x35f5ba9b35fdac47,0x3600964136043da0,0x35f03b2c35f9150b,0x35fd397d3602aa7c,0x35ea75b435f441cc
.quad 0x35f9150b36010332,0x35e46be135ef33b3,0x35f4bffe35fe9006,0x35de1f7735e9ebf9,0x35f03b2c35faf267,0x35d7924c35e46be1,0x35eb877735f72e15,0x35d0c64935deb4c1
.quad 0x35e6a5cc35f343a6,0x35c9bd6835d8c7f8,0x35e1971d35ef33b3,0x35c279b635d2a6f4,0x35dc5c6635eafede,0x35bafd5335cc532f,0x35d6f6af35e6a5cc,0x35b34a6d35c5ce2f
.quad 0x35d1670335e22928,0x35ab634135bf1987,0x35cbae7935dd89a5,0x35a34a1f35b836d3,0x35c5ce2f35d8c7f8,0x359b016235b127bd,0x35bfc74a35d3e4dd,0x35928b7535a9edf8
.quad 0x3612492536124925,0x3612492536124925,0x36122b5d36122fc4,0x3612217f3612269b,0x3611d2113611e3ac,0x3611aaa33611bf0e,0x36113d66361164f7,0x3610e4d1361112ae
.quad 0x36106d983610b3d0,0x360fd075361021ce,0x360f62fb360fd075,0x360e6e25360eecde,0x360e1dfd360ebb35,0x360cbe9f360d7471,0x360c9f21360d7471,0x360ac2cf360bb938
.quad 0x360ae704360bfc98,0x36087bc83609bc05,0x3608f659360a542f,0x3605eac536077dc8,0x3606cde936087bc8,0x3603112b3604ff90,0x36046e9636067407,0x35ffe10a3602428b
.quad 0x3601d95836043da0,0x35f9150b35fe9006,0x35fe1e753601d958,0x35f1c20835f822c3,0x35f822c335fe9006,0x35e9ebf935f14053,0x35f1c20835f9150b,0x35e1971d35e9ebf9
.quad 0x35eafede35f343a6,0x35d8c7f835e22928,0x35e3dc0635ed1ddb,0x35cf835235d9fb8d,0x35dc5c6635e6a5cc,0x35c5ce2f35d16703,0x35d4830e35dfddb7,0x35bbadd435c86f98
.quad 0x35cc532f35d8c7f8,0x35b127bd35bf1987,0x35c3d01e35d16703,0x35a6419f35b56939,0x35bafd5335c9bd68,0x359b016235ab6341,0x35b1de6635c1cdce,0x358f6d2035a10c5c
.quad 0x35a8770c35b99af8,0x35838b1e3596696a,0x359ecb1a35b127bd,0x356ec39e358b7f72,0x3594de8135a8770c,0x3555ef933580539b,0x358ab54b359f8be8,0x353ca7913569d656
.quad 0x3580539b3596696a,0x3522f94b3552970b,0x356b7b55358d12bd,0x3508f2af353af44f,0x3555ef9335838b1e,0x34dd43ad3522f94b,0x35400cb63573abb8,0x34a82a0c350ab153
.quad 0x0,0x0,0x33813cd83365c312,0x339df27f338f97d8,0x3401303c33e5b15b,0x341ddb79340f868b,0x3441a8d5342c2ee1,0x346c8fad34571e96
.quad 0x3480fdd134656a87,0x349d7f75348f4166,0x34a10e0b348f4166,0x34c4892934b2d0fd,0x34c0fed734abb772,0x34eb599234d6357f,0x34e0c9f834c81302,0x3508f2af34f96664
.quad 0x3500349d34e44fb9,0x351c10a8350e2d99,0x350feb393500349d,0x352f0122351f85bf,0x351f85bf350e2d99,0x3541be973530b775,0x352f0122351c10a8,0x355443903541be97
.quad 0x353e5a5e3529dba6,0x35668aa83552970b,0x354d8e7335378c73,0x35788e8a35633cc2,0x355c9a6b354520f2,0x358524fb3573abb8,0x356b7b553552970b,0x358ddbe03581effd
.quad 0x357a2e49355fecab,0x3596696a3589eacf,0x35845835356d1fc2,0x359ecb1a3591c466,0x358b7f72357a2e49,0x35a6fe8035997ade,0x35928b7535838b1e,0x35af013635a10c5c
.quad 0x35997ade3589eacf,0x35b6d0e835a8770c,0x35a04c533590353b,0x35be6b4d35afb925,0x35a6fe803596696a,0x35c5ce2f35b6d0e8,0x35ad9015359c8668,0x35ccf76735bdbc9e
.quad 0x35b3ffcb35a28b42,0x35d3e4dd35c47a9d,0x35ba4c5f35a8770c,0x35da948e35cb0946,0x35c0749835ae48db,0x35e1048635d16703,0x35c6774135b3ffcb,0x35e732e435d7924c
.quad 0x35cc532f35b99af8,0x35ed1ddb35dd89a5,0x35d2073c35bf1987,0x35f2c3b235e34b9d,0x35d7924c35c47a9d,0x35f822c335e8d6d2,0x35dcf34a35c9bd68,0x35fd397d35ee29ed
.quad 0x0,0x0,0x33baa69f33ac4cc4,0x33d758f433c90008,0x343a80a0342c2ee1,0x34571e963448d093,0x348bb1003480fdd1,0x34a10e0b34966127
.quad 0x34b9e8cf34abb772,0x34d6357f34c81302,0x34e7d4ed34d6357f,0x3505746b34f96664,0x350ab1533500349d,0x351f85bf35152201,0x35213fb735152201,0x3539409a352d4a63
.quad 0x35378c733529dba6,0x3552970b354520f2,0x354d8e73353e5a5e,0x356b7b55355c9a6b,0x35633cc23552970b,0x3581effd3573abb8,0x35788e8a35668aa8,0x358ddbe0358524fb
.quad 0x3586bd8f357a2e49,0x35997ade3590353b,0x3590fcfd3586bd8f,0x35a4c6aa359b0162,0x359b01623590353b,0x35afb92535a58458,0x35a4c6aa35997ade,0x35ba4c5f35afb925
.quad 0x35ae48db35a28b42,0x35c47a9d35b99af8,0x35b7841635ab6341,0x35ce3e5b35c32527,0x35c0749835b3ffcb,0x35d7924c35cc532f,0x35c916be35bc5de1,0x35e0716435d520bc
.quad 0x35d1670335c47a9d,0x35e8d6d235dd89a5,0x35d9620635cc532f,0x35f0be0a35e589f2,0x35e1048635d3e4dd,0x35f822c335ed1ddb,0x35e84b6735db2d08,0x35ff00fa35f441cc
.quad 0x35ef33b335e22928,0x3602aa7c35faf267,0x35f5ba9b35e8d6d2,0x36058da736009641,0x35fbdd7535ef33b3,0x3608286d36037697,0x3600cce135f53d98,0x360a7965360618d8
.quad 0x3603769735faf267,0x360c7f4d36087bc8,0x3605eac536002813,0x360e390d360a9e45,0x3608286d3602aa7c,0x360fa5b5360c7f4d,0x360a2ea43604ff90,0x3610c47f360e1dfd
.quad 0x3612492536124925,0x3612492536124925,0x3612163836121c09,0x3612098a3612100e,0x36117d97361194d1,0x36114af0361164f7,0x36107fab3610b3d0,0x36100dfd36104865
.quad 0x360f1d26360f7991,0x360e53c4360ebb35,0x360d56fd360de6d7,0x360c1dc7360cbe9f,0x360b2e6d360bfc98,0x36096df1360a542f,0x3608a4f73609bc05,0x3606469936077dc8
.quad 0x3605bc5f3607267f,0x3602aa7c36043da0,0x360276ac36043da0,0x35fd397d36009641,0x35fdac4736010332,0x35f441cc35f9150b,0x35f5ba9b35faf267,0x35ea75b435f03b2c
.quad 0x35ed1ddb35f343a6,0x35dfddb735e6a5cc,0x35e3dc0635eafede,0x35d4830e35dc5c66,0x35d9fb8d35e22928,0x35c86f9835d16703,0x35cf835235d8c7f8,0x35bbadd435c5ce2f
.quad 0x35c47a9d35cee116,0x35ae48db35b99af8,0x35b8e91f35c47a9d,0x35a04c5335acd6e4,0x35acd6e435b99af8,0x3591c466359f8be8,0x35a04c5335ae48db,0x3582bdb63591c466
.quad 0x3593522935a28b42,0x35668aa835838b1e,0x3585f16e3596696a,0x3546d16a3569d656,0x357066e63589eacf,0x35266b46354bdfec,0x35544390357a2e49,0x3505746b352d4a63
.quad 0x35378c73355fecab,0x34c81302350e2d99,0x351a558c354520f2,0x34848f3334dd43ad,0x34f966643529dba6,0x3401303c349d7f75,0x34bd740e350e2d99,0xb1e5c8e2343a80a0
.quad 0x3480fdd134e44fb9,0xb40f868b3365c312,0x34085b8e34abb772,0xb48bb100b38f97d8,0x3265c89b34656a87,0xb4cf2540b448d093,0xb3d758f433e5b15b,0xb508f2afb4a49c3e
.quad 0x3612492536124925,0x3612492536124925,0x3611fb72361202ab,0x3611ebf33611f3e0,0x361112ae36112f82,0x3610d4d53610f474,0x360f8fcf360fd075,0x360f052e360f4c0c
.quad 0x360d7471360de6d7,0x360c7f4d360cfc96,0x360ac2cf360b747e,0x36094668360a08c4,0x36077dc836087bc8,0x36055e9c36067407,0x3603a8d33604ff90,0x3600cce13602428b
.quad 0x35fe900636010332,0x35f72e1535faf267,0x35f4bffe35f9150b,0x35eb877735f03b2c,0x35e9ebf935ef33b3,0x35deb4c135e46be1,0x35de1f7735e46be1,0x35d0c64935d7924c
.quad 0x35d1670335d8c7f8,0x35c1cdce35c9bd68,0x35c3d01e35cc532f,0x35b1de6635bafd53,0x35b5693935bf1987,0x35a10c5c35ab6341,0x35a6419f35b127bd,0x358f6d20359b0162
.quad 0x3596696a35a28b42,0x357a2e493589eacf,0x3585f16e35935229,0x35544390357066e6,0x3569d65635838b1e,0x352d4a63354bdfec,0x3546d16a35668aa8,0x3505746b35266b46
.quad 0x3522f94b354520f2,0x34b9e8cf3500349d,0x34fce81d3522f94b,0x344ff7d534b2d0fd,0x34b2d0fd3500349d,0x332c543e3448d093,0x344ff7d534b9e8cf,0xb3f40934332c543e
.quad 0x3365c31234656a87,0xb48f4166b3e5b15b,0xb3baa69f33ac4cc4,0xb4e0c9f8b4882044,0xb473b441b365c312,0xb5189a11b4d6357f,0xb4c48929b448d093,0xb5400cb6b511a880
.quad 0xb50733b6b4abb772,0xb5668aa8b5378c73,0xb52b933ab4f26126,0xb585f16eb55c9a6b,0xb54f3c7bb51c10a8,0xb597f2e0b580539b,0xb572099ab53e5a5e,0xb5a932b6b591c466
.quad 0x0,0x0,0x33f4093433e5b15b,0x34085b8e3401303c,0x3473b44134656a87,0x348820443480fdd1,0x34b65d1f34abb772,0x34cb9c6034c0fed7
.quad 0x34f2612634e44fb9,0x350733b63500349d,0x3516de37350e2d99,0x352823aa351f85bf,0x353422d23529dba6,0x35488167353e5a5e,0x3550ea04354520f2,0x356830c7355c9a6b
.quad 0x356d1fc2355fecab,0x35838b1e357a2e49,0x35845835357a2e49,0x35928b75358b7f72,0x3591c4663589eacf,0x35a10c5c35997ade,0x359ecb1a3596696a,0x35af013635a6fe80
.quad 0x35ab634135a28b42,0x35bc5de135b3ffcb,0x35b7841635ae48db,0x35c916be35c07498,0x35c3252735b99af8,0x35d520bc35cc532f,0x35ce3e5b35c47a9d,0x35e0716435d7924c
.quad 0x35d8c7f835cee116,0x35eafede35e22928,0x35e2baa935d8c7f8,0x35f4bffe35ec0f80,0x35ec0f8035e22928,0x35fdac4735f53d98,0x35f4bffe35eafede,0x3602ddfc35fdac47
.quad 0x35fcc61635f343a6,0x360674073602aa7c,0x36020e1935faf267,0x36099525360618d8,0x36055e9c36010332,0x360c3ea036091e8b,0x3608524436043da0,0x360e6e25360bb938
.quad 0x360ae7043607267f,0x361021ce360de6d7,0x360d1b103609bc05,0x36115820360fa5b5,0x360eecde360bfc98,0x3612100e3610f474,0x36105b2b360de6d7,0x361248f73611d211
.quad 0x361164f7360f7991,0x361202ab36123ddd,0x3612098a3610b3d0,0x36113d6636123785,0x36124870361194d1,0x360ff9d33611bf0e,0x3612217f36121c09,0x360e390d3610d4d5
.quad 0x0,0x0,0x3416b131340f868b,0x34250560341ddb79,0x34966127348f4166,0x34a49c3e349d7f75,0x34e0c9f834d6357f,0x34f5e41134eb5992
.quad 0x35152201350e2d99,0x3522f94b351c10a8,0x3539409a3530b775,0x354a30e83541be97,0x355c9a6b3552970b,0x357066e635668aa8,0x357f09e53573abb8,0x358ab54b358524fb
.quad 0x3590353b3589eacf,0x359c86683596696a,0x35a04c5335997ade,0x35ad901535a6fe80,0x35afb92535a8770c,0x35bdbc9e35b6d0e8,0x35be6b4d35b6d0e8,0x35ccf76735c5ce2f
.quad 0x35cc532f35c47a9d,0x35db2d0835d3e4dd,0x35d9620635d16703,0x35e84b6735e10486,0x35e589f235dd89a5,0x35f441cc35ed1ddb,0x35f0be0a35e8d6d2,0x35ff00fa35f822c3
.quad 0x35faf26735f343a6,0x36043da036010332,0x36020e1935fcc616,0x3608524436055e9c,0x360618d83602aa7c,0x360bb93836091e8b,0x3609952536067407,0x360e6e25360c3ea0
.quad 0x360c7f4d3609bc05,0x36106d98360ebb35,0x360ed436360c7f4d,0x3611b50536109166,0x36109166360ebb35,0x361242cc3611bf0e,0x3611b50536106d98,0x36121638361242cc
.quad 0x36123ddd361194d1,0x36112f8236121c09,0x36122b5d36122fc4,0x360f8fcf36114af0,0x36117d9736123ddd,0x360d3932360fd075,0x361035463611bf0e,0x360a2ea4360dae53
.quad 0x360e53c43610b3d0,0x36067407360ae704,0x360bdb13360f1d26,0x36020e1936077dc8,0x3608cdd2360cfc96,0x35fa04ee36037697,0x36052f3f360a542f,0x35eeaf1a35fdac47
.quad 0x3612492536124925,0x3612492536124925,0x3611db0c3611e3ac,0x3611c8bc3611d211,0x361091663610b3d0,0x3610486536106d98,0x360e6e25360ebb35,0x360dcac0360e1dfd
.quad 0x360b747e360bfc98,0x360a542f360ae704,0x3607a8ef36087bc8,0x3605eac53606cde9,0x3603112b36043da0,0x360096413601d958,0x35fb683c35fe9006,0x35f4bffe35f822c3
.quad 0x35ef33b335f343a6,0x35e6a5cc35eafede,0x35e1971d35e6a5cc,0x35d6f6af35dc5c66,0x35d2a6f435d8c7f8,0x35c5ce2f35cc532f,0x35c279b635c9bd68,0x35b34a6d35bafd53
.quad 0x35b127bd35b99af8,0x359f8be835a8770c,0x359ecb1a35a8770c,0x358ab54b3594de81,0x358b7f723596696a,0x3569d6563580539b,0x356ec39e35838b1e,0x353ca7913555ef93
.quad 0x354520f2355fecab,0x350e2d993529dba6,0x351a558c35378c73,0x34bd740e34f96664,0x34dd43ad350e2d99,0x343a80a0349d7f75,0x34848f3334c81302,0xb1e5c8e23401303c
.quad 0x33ac4cc434656a87,0xb448d093b365c312,0xb3baa69f3365c312,0xb4c48929b473b441,0xb4882044b3e5b15b,0xb511a880b4d6357f,0xb4e0c9f8b48f4166,0xb5400cb6b5189a11
.quad 0xb51c10a8b4e44fb9,0xb56d1fc2b54520f2,0xb546d16ab51c10a8,0xb58c4943b57066e6,0xb57066e6b54520f2,0xb5a10c5cb58d12bd,0xb58c4943b56d1fc2,0xb5b4b4b9b5a10c5c
.quad 0xb59f8be8b589eacf,0xb5c71fd9b5b3ffcb,0xb5b1de66b59c8668,0xb5d82d65b5c5ce2f,0xb5c32527b5ae48db,0xb5e7bf6db5d65a8d,0xb5d3462ab5bf1987,0xb5f5ba9bb5e589f2
.quad 0x3612492536124925,0x3612492536124925,0x3611b5053611bf0e,0x36119fe73611aaa3,0x360ff9d3361021ce,0x360fa5b5360fd075,0x360d1b10360d7471,0x360c5f21360cbe9f
.quad 0x36091e8b3609bc05,0x3607d3c236087bc8,0x36040c583604ff90,0x36020e193603112b,0x35fbdd7535fe9006,0x35f6370635f9150b,0x35eda42d35f14053,0x35e6182635e9ebf9
.quad 0x35dd89a535e22928,0x35d3e4dd35d8c7f8,0x35cbae7935d16703,0x35bfc74a35c5ce2f,0x35b836d335bf1987,0x35a9edf835b127bd,0x35a34a1f35ab6341,0x35928b75359b0162
.quad 0x358d12bd3596696a,0x3573abb835838b1e,0x356b7b553580539b,0x35400cb63555ef93,0x353af44f3552970b,0x350ab1533522f94b,0x3508f2af3522f94b,0x34a82a0c34dd43ad
.quad 0x34abb77234e44fb9,0x33e5b15b34656a87,0x34085b8e3480fdd1,0xb3d758f43265c89b,0xb38f97d83365c312,0xb4a49c3eb448d093,0xb48bb100b40f868b,0xb508f2afb4cf2540
.quad 0xb4f26126b4abb772,0xb53e5a5eb51c10a8,0xb52b933ab50733b6,0xb572099ab54f3c7b,0xb55c9a6bb5378c73,0xb591c466b580539b,0xb585f16eb5668aa8,0xb5a932b6b597f2e0
.quad 0xb59c8668b589eacf,0xb5bf1987b5ae48db,0xb5b1de66b59f8be8,0xb5d3462ab5c32527,0xb5c5ce2fb5b3ffcb,0xb5e589f2b5d65a8d,0xb5d82d65b5c71fd9,0xb5f5ba9bb5e7bf6d
.quad 0xb5e8d6d2b5d8c7f8,0xb601d958b5f72e15,0xb5f7a8b8b5e8d6d2,0xb607a8efb602428b,0xb602428bb5f72e15,0xb60c3ea0b607d3c2,0xb607a8efb601d958,0xb60f8fcfb60c3ea0
.quad 0x0,0x0,0x343357f8342c2ee1,0x3441a8d5343a80a0,0x34b2d0fd34abb772,0x34c0fed734b9e8cf,0x3505746b3500349d,0x350feb39350ab153
.quad 0x3530b7753529dba6,0x353e5a5e35378c73,0x355af07e3552970b,0x356b7b5535633cc2,0x3581effd357a2e49,0x358b7f723586bd8f,0x3595a4243590353b,0x35a04c53359b0162
.quad 0x35a8770c35a28b42,0x35b3ffcb35ae48db,0x35ba4c5f35b3ffcb,0x35c6774135c07498,0x35cb094635c47a9d,0x35d7924c35d16703,0x35da948e35d3e4dd,0x35e732e435e10486
.quad 0x35e8d6d235e22928,0x35f53d9835ef33b3,0x35f5ba9b35ef33b3,0x3600cce135fbdd75,0x3600964135faf267,0x360618d836037697,0x36058da73602aa7c,0x360a79653608286d
.quad 0x3609bc053607267f,0x360de6d7360bfc98,0x360d1b10360ae704,0x36105b2b360eecde,0x360fa5b5360de6d7,0x3611d2113610f474,0x36115820361021ce,0x361248f73612100e
.quad 0x36122fc4361194d1,0x3611bf0e36123ddd,0x36122b5d36123ddd,0x3610354636117d97,0x36114af036121c09,0x360dae53360fd075,0x360f8fcf36112f82,0x360a2ea4360d3932
.quad 0x360cfc96360f7991,0x3605bc5f3609bc05,0x36099525360cfc96,0x36005f5236055e9c,0x36055e9c3609bc05,0x35f441cc36002813,0x36005f523605bc5f,0x35e6182635f441cc
.quad 0x35f53d9836010332,0x35d65a8d35e6a5cc,0x35e84b6735f72e15,0x35c524a335d7924c,0x35d9fb8d35eafede,0x35b294a035c71fd9,0x35ca639535dd89a5,0x359ecb1a35b56939
.quad 0x0,0x0,0x344ff7d53448d093,0x345e44d334571e96,0x34cf254034c81302,0x34dd43ad34d6357f,0x351a558c35152201,0x3524b27c351f85bf
.quad 0x354bdfec354520f2,0x3559460b3552970b,0x357bcd6e3573abb8,0x3585f16e3581effd,0x3594de813590353b,0x359e09eb35997ade,0x35aaa8d135a58458,0x35b4b4b935afb925
.quad 0x35bf198735b99af8,0x35c9bd6835c47a9d,0x35d2073c35cc532f,0x35dcf34a35d7924c,0x35e34b9d35dd89a5,0x35ee29ed35e8d6d2,0x35f2c3b235ed1ddb,0x35fd397d35f822c3
.quad 0x3600281335faf267,0x3604ff903602aa7c,0x3605eac536037697,0x360a2ea43608286d,0x360a9e4536087bc8,0x360e1dfd360c7f4d,0x360e390d360c7f4d,0x3610c47f360fa5b5
.quad 0x3610b3d0360f7991,0x36121c09361194d1,0x3612098a361164f7,0x3612217f36124870,0x3612378536123ddd,0x3610d4d53611bf0e,0x36113d66361202ab,0x360e390d360ff9d3
.quad 0x360f1d263610b3d0,0x360a542f360cfc96,0x360bdb13360e53c4,0x36052f3f3608cdd2,0x36077dc8360ae704,0x35fdac4736037697,0x36020e1936067407,0x35eeaf1a35fa04ee
.quad 0x35f72e1536010332,0x35dd89a535eafede,0x35e84b6735f53d98,0x35ca639535d9fb8d,0x35d7924c35e6a5cc,0x35b5693935c71fd9,0x35c524a335d65a8d,0x359ecb1a35b294a0
.quad 0x35b127bd35c47a9d,0x3586bd8f359c8668,0x359bc41535b127bd,0x355af07e358524fb,0x358524fb359c8668,0x35266b463559460b,0x355af07e3586bd8f,0x34e0c9f835266b46
.quad 0x361194d136124925,0x360bfc98360f7991,0x3611896136124925,0x360b9706360f4c0c,0x36117d9736124925,0x360b2e6d360f1d26,0x3611717436124925,0x360ac2cf360eecde
.quad 0x361164f736124925,0x360a542f360ebb35,0x3611582036124925,0x3609e28f360e882d,0x36114af036124925,0x36096df1360e53c4,0x36113d6636124925,0x3608f659360e1dfd
.quad 0x36112f8236124925,0x36087bc8360de6d7,0x3611214536124925,0x3607fe41360dae53,0x361112ae36124925,0x36077dc8360d7471,0x361103be36124925,0x3606fa5e360d3932
.quad 0x3610f47436124925,0x36067407360cfc96,0x3610e4d136124925,0x3605eac5360cbe9f,0x3610d4d536124925,0x36055e9c360c7f4d,0x3610c47f36124925,0x3604cf8f360c3ea0
.quad 0x3610b3d036124925,0x36043da0360bfc98,0x3610a2c836124925,0x3603a8d3360bb938,0x3610916636124925,0x3603112b360b747e,0x36107fab36124925,0x360276ac360b2e6d
.quad 0x36106d9836124925,0x3601d958360ae704,0x36105b2b36124925,0x36013933360a9e45,0x3610486536124925,0x36009641360a542f,0x3610354636124925,0x35ffe10a360a08c4
.quad 0x361021ce36124925,0x35fe90063609bc05,0x36100dfd36124925,0x35fd397d36096df1,0x360ff9d336124925,0x35fbdd7536091e8b,0x360fe55136124925,0x35fa7bf83608cdd2
.quad 0x360fd07536124925,0x35f9150b36087bc8,0x360fbb4136124925,0x35f7a8b83608286d,0x360fa5b536124925,0x35f637063607d3c2,0x360f8fcf36124925,0x35f4bffe36077dc8
.quad 0x360103323607267f,0x35e2292835f343a6,0x35ffe10a36067407,0x35de1f7735f03b2c,0x35fdac473605bc5f,0x35d9fb8d35ed1ddb,0x35fb683c3604ff90,0x35d5bde635e9ebf9
.quad 0x35f9150b36043da0,0x35d1670335e6a5cc,0x35f6b2da36037697,0x35ccf76735e34b9d,0x35f441cc3602aa7c,0x35c86f9835dfddb7,0x35f1c2083601d958,0x35c3d01e35dc5c66
.quad 0x35ef33b336010332,0x35bf198735d8c7f8,0x35ec96f636002813,0x35ba4c5f35d520bc,0x35e9ebf935fe9006,0x35b5693935d16703,0x35e732e435fcc616,0x35b070a835cd9b20
.quad 0x35e46be135faf267,0x35ab634135c9bd68,0x35e1971d35f9150b,0x35a6419f35c5ce2f,0x35deb4c135f72e15,0x35a10c5c35c1cdce,0x35dbc4fb35f53d98,0x359bc41535bdbc9e
.quad 0x35d8c7f835f343a6,0x3596696a35b99af8,0x35d5bde635f14053,0x3590fcfd35b56939,0x35d2a6f435ef33b3,0x358b7f7235b127bd,0x35cf835235ed1ddb,0x3585f16e35acd6e4
.quad 0x35cc532f35eafede,0x3580539b35a8770c,0x35c916be35e8d6d2,0x35754d4135a40897,0x35c5ce2f35e6a5cc,0x3569d656359f8be8,0x35c279b635e46be1,0x355e43cf359b0162
.quad 0x35bf198735e22928,0x3552970b3596696a,0x35bbadd435dfddb7,0x3546d16a3591c466,0x35b836d335dd89a5,0x353af44f358d12bd,0x35b4b4b935db2d08,0x352f0122358854d7
.quad 0x35b127bd35d8c7f8,0x3522f94b35838b1e,0x35ad901535d65a8d,0x3516de37357d6bf8,0x35a9edf835d3e4dd,0x350ab1533573abb8,0x35a6419f35d16703,0x34fce81d3569d656
.quad 0x34656a8700000000,0x3529dba634e44fb9,0x346c8fad00000000,0x352f012234eb5992,0x3473b44100000000,0x353422d234f26126,0x347ad83f00000000,0x3539409a34f96664
.quad 0x3480fdd100000000,0x353e5a5e3500349d,0x34848f3300000000,0x354370013503b4cc,0x3488204400000000,0x35488167350733b6,0x348bb10000000000,0x354d8e73350ab153
.quad 0x348f416600000000,0x3552970b350e2d99,0x3492d17400000000,0x35579b113511a880,0x3496612700000000,0x355c9a6b35152201,0x3499f07e00000000,0x356194fc35189a11
.quad 0x349d7f7500000000,0x35668aa8351c10a8,0x34a10e0b00000000,0x356b7b55351f85bf,0x34a49c3e00000000,0x357066e63522f94b,0x34a82a0c00000000,0x35754d4135266b46
.quad 0x34abb77200000000,0x357a2e493529dba6,0x34af446d00000000,0x357f09e5352d4a63,0x34b2d0fd00000000,0x3581effd3530b775,0x34b65d1f00000000,0x35845835353422d2
.quad 0x34b9e8cf00000000,0x3586bd8f35378c73,0x34bd740e00000000,0x35891ffd353af44f,0x34c0fed700000000,0x358b7f72353e5a5e,0x34c4892900000000,0x358ddbe03541be97
.quad 0x34c8130200000000,0x3590353b354520f2,0x34cb9c6000000000,0x35928b7535488167,0x34cf254000000000,0x3594de81354bdfec,0x34d2ada000000000,0x35972e53354f3c7b
.quad 0x34d6357f00000000,0x35997ade3552970b,0x34d9bcd900000000,0x359bc4153555ef93,0x34dd43ad00000000,0x359e09eb3559460b,0x34e0c9f800000000,0x35a04c53355c9a6b
.quad 0x3589eacf355fecab,0x35b99af835a28b42,0x358ddbe035668aa8,0x35be6b4d35a6fe80,0x3591c466356d1fc2,0x35c3252735ab6341,0x3595a4243573abb8,0x35c7c7f635afb925
.quad 0x35997ade357a2e49,0x35cc532f35b3ffcb,0x359d485a3580539b,0x35d0c64935b836d3,0x35a10c5c35838b1e,0x35d520bc35bc5de1,0x35a4c6aa3586bd8f,0x35d9620635c07498
.quad 0x35a8770c3589eacf,0x35dd89a535c47a9d,0x35ac1d48358d12bd,0x35e1971d35c86f98,0x35afb9253590353b,0x35e589f235cc532f,0x35b34a6d35935229,0x35e961ad35d0250d
.quad 0x35b6d0e83596696a,0x35ed1ddb35d3e4dd,0x35ba4c5f35997ade,0x35f0be0a35d7924c,0x35bdbc9e359c8668,0x35f441cc35db2d08,0x35c1216f359f8be8,0x35f7a8b835deb4c1
.quad 0x35c47a9d35a28b42,0x35faf26735e22928,0x35c7c7f635a58458,0x35fe1e7535e589f2,0x35cb094635a8770c,0x3600964135e8d6d2,0x35ce3e5b35ab6341,0x36020e1935ec0f80
.quad 0x35d1670335ae48db,0x3603769735ef33b3,0x35d4830e35b127bd,0x3604cf8f35f24328,0x35d7924c35b3ffcb,0x360618d835f53d98,0x35da948e35b6d0e8,0x3607524d35f822c3
.quad 0x35dd89a535b99af8,0x36087bc835faf267,0x35e0716435bc5de1,0x3609952535fdac47,0x35e34b9d35bf1987,0x360a9e4536002813,0x35e6182635c1cdce,0x360b970636016ee5
.quad 0x35e8d6d235c47a9d,0x360c7f4d3602aa7c,0x35eb877735c71fd9,0x360d56fd3603dabe,0x35ee29ed35c9bd68,0x360e1dfd3604ff90,0x35f0be0a35cc532f,0x360ed436360618d8
.quad 0x35b99af835cee116,0x3589eacf35a28b42,0x35b34a6d35c9bd68,0x358121f4359b0162,0x35acd6e435c47a9d,0x357066e635935229,0x35a6419f35bf1987,0x355e43cf358b7f72
.quad 0x359f8be835b99af8,0x354bdfec35838b1e,0x3598b70e35b3ffcb,0x3539409a3576ee32,0x3591c46635ae48db,0x35266b4635668aa8,0x358ab54b35a8770c,0x3513656e3555ef93
.quad 0x35838b1e35a28b42,0x3500349d354520f2,0x35788e8a359c8668,0x34d9bcd9353422d2,0x3569d6563596696a,0x34b2d0fd3522f94b,0x355af07e3590353b,0x348bb1003511a880
.quad 0x354bdfec3589eacf,0x3448d0933500349d,0x353ca79135838b1e,0x33f4093434dd43ad,0x352d4a63357a2e49,0x332c543e34b9e8cf,0x351dcb64356d1fc2,0xb30f9c2b34966127
.quad 0x350e2d99355fecab,0xb3e5b15b34656a87,0x34fce81d3552970b,0xb441a8d5341ddb79,0x34dd43ad354520f2,0xb488204433ac4cc4,0x34bd740e35378c73,0xb4af446d3265c89b
.quad 0x349d7f753529dba6,0xb4d6357fb365c312,0x347ad83f351c10a8,0xb4fce81db401303c,0x343a80a0350e2d99,0xb511a880b448d093,0x33f409343500349d,0xb524b27cb4882044
.quad 0x3365c31234e44fb9,0xb5378c73b4abb772,0xb1e5c8e234c81302,0xb54a30e8b4cf2540,0xb38f97d834abb772,0xb55c9a6bb4f26126,0xb4085b8e348f4166,0xb56ec39eb50ab153
.quad 0xb448d09334656a87,0xb580539bb51c10a8,0xb4848f33342c2ee1,0xb5891ffdb52d4a63,0xb4a49c3e33e5b15b,0xb591c466b53e5a5e,0xb4c489293365c312,0xb59a3e50b54f3c7b
.quad 0x3529dba6355fecab,0x34656a8734e44fb9,0x3513656e354bdfec,0x33f4093434b2d0fd,0x34f9666435378c73,0x3265c89b3480fdd1,0x34cb9c603522f94b,0xb3baa69f341ddb79
.quad 0x349d7f75350e2d99,0xb448d0933365c312,0x345e44d334f26126,0xb499f07eb32c543e,0x3401303c34c81302,0xb4cf2540b40f868b,0x330f9c2b349d7f75,0xb501f4ddb473b441
.quad 0xb365c31234656a87,0xb51c10a8b4abb772,0xb416b131340f868b,0xb535d7dbb4dd43ad,0xb473b4413365c312,0xb54f3c7bb50733b6,0xb4a82a0cb2e5c780,0xb56830c7b51f85bf
.quad 0xb4d6357fb3e5b15b,0xb580539bb5378c73,0xb501f4ddb448d093,0xb58c4943b54f3c7b,0xb5189a11b48f4166,0xb597f2e0b5668aa8,0xb52f0122b4b9e8cf,0xb5a34a1fb57d6bf8
.quad 0xb54520f2b4e44fb9,0xb5ae48dbb589eacf,0xb55af07eb50733b6,0xb5b8e91fb594de81,0xb57066e6b51c10a8,0xb5c32527b59f8be8,0xb582bdb6b530b775,0xb5ccf767b5a9edf8
.quad 0xb58d12bdb54520f2,0xb5d65a8db5b3ffcb,0xb5972e53b559460b,0xb5df4981b5bdbc9e,0xb5a10c5cb56d1fc2,0xb5e7bf6db5c71fd9,0xb5aaa8d1b580539b,0xb5efb7bab5d0250d
.quad 0xb5b3ffcbb589eacf,0xb5f72e15b5d8c7f8,0xb5bd0d7ab5935229,0xb5fe1e75b5e10486,0xb5c5ce2fb59c8668,0xb602428bb5e8d6d2,0xb5ce3e5bb5a58458,0xb6052f3fb5f03b2c
.quad 0xb5d65a8db5ae48db,0xb607d3c2b5f72e15,0xb5de1f77b5b6d0e8,0xb60a2ea4b5fdac47,0xb5e589f2b5bf1987,0xb60c3ea0b601d958,0xb5ec96f6b5c71fd9,0xb60e0296b6049f3b
.quad 0x35e2292835cee116,0x3601033235f343a6,0x35e732e435d3e4dd,0x3603440935f822c3,0x35ec0f8035d8c7f8,0x36055e9c35fcc616,0x35f0be0a35dd89a5,0x3607524d36009641
.quad 0x35f53d9835e22928,0x36091e8b3602aa7c,0x35f98d4935e6a5cc,0x360ac2cf36049f3b,0x35fdac4735eafede,0x360c3ea036067407,0x3600cce135ef33b3,0x360d918d3608286d
.quad 0x3602aa7c35f343a6,0x360ebb353609bc05,0x36046e9635f72e15,0x360fbb41360b2e6d,0x360618d835faf267,0x36109166360c7f4d,0x3607a8ef35fe9006,0x36113d66360dae53
.quad 0x36091e8b36010332,0x3611bf0e360ebb35,0x360a79653602aa7c,0x36121638360fa5b5,0x360bb93836043da0,0x361242cc36106d98,0x360cddc63605bc5f,0x361244bd361112ae
.quad 0x360de6d73607267f,0x36121c09361194d1,0x360ed43636087bc8,0x3611c8bc3611f3e0,0x360fa5b53609bc05,0x36114af036122fc4,0x36105b2b360ae704,0x3610a2c836124870
.quad 0x3610f474360bfc98,0x360fd07536123ddd,0x36117174360cfc96,0x360ed4363612100e,0x3611d211360de6d7,0x360dae533611bf0e,0x36121638360ebb35,0x360c5f2136114af0
.quad 0x36123ddd360f7991,0x360ae7043610b3d0,0x361248f7361021ce,0x36094668360ff9d3,0x361237853610b3d0,0x36077dc8360f1d26,0x3612098a36112f82,0x36058da7360e1dfd
.quad 0x3611bf0e361194d1,0x36037697360cfc96,0x361158203611e3ac,0x36013933360bb938,0x3610d4d536121c09,0x35fdac47360a542f,0x3610354636123ddd,0x35f89c343608cdd2
.quad 0x360bfc983607267f,0x361194d1360f7991,0x360d918d36091e8b,0x3612163836109166,0x360eecde360ae704,0x36124870361164f7,0x36100dfd360c7f4d,0x36122b5d3611f3e0
.quad 0x3610f474360de6d7,0x3611bf0e36123ddd,0x36119fe7360f1d26,0x361103be361242cc,0x3612100e361021ce,0x360ff9d3361202ab,0x361244bd3610f474,0x360ea1dd36117d97
.quad 0x36123ddd361194d1,0x360cfc963610b3d0,0x3611fb72361202ab,0x360b0ae4360fa5b5,0x36117d9736123ddd,0x3608cdd2360e53c4,0x3610c47f36124653,0x36064699360cbe9f
.quad 0x360fd07536121c09,0x36037697360ae704,0x360ea1dd3611bf0e,0x36005f523608cdd2,0x360d393236112f82,0x35fa04ee36067407,0x360b970636106d98,0x35f2c3b23603dabe
.quad 0x3609bc05360f7991,0x35eafede36010332,0x3607a8ef360e53c4,0x35e2baa935fbdd75,0x36055e9c360cfc96,0x35d9fb8d35f53d98,0x3602ddfc360b747e,0x35d0c64935ee29ed
.quad 0x360028133609bc05,0x35c71fd935e6a5cc,0x35fa7bf83607d3c2,0x35bd0d7a35deb4c1,0x35f441cc3605bc5f,0x35b294a035d65a8d,0x35eda42d36037697,0x35a7bafa35cd9b20
.quad 0x35e6a5cc36010332,0x359c866835c47a9d,0x35df498135fcc616,0x3590fcfd35bafd53,0x35d7924c35f72e15,0x358524fb35b127bd,0x35cf835235f14053,0x3572099a35a6fe80
.quad 0x35c71fd935eafede,0x3559460b359c8668,0x35be6b4d35e46be1,0x35400cb63591c466,0x35b5693935dd89a5,0x35266b463586bd8f,0x35ac1d4835d65a8d,0x350c6fa13576ee32
.quad 0xb4656a871b215ccb,0xb529dba6b4e44fb9,0xb4af446db3e5b15b,0xb54a30e8b511a880,0xb4eb5992b4656a87,0xb569d656b530b775,0xb513656eb4abb772,0xb5845835b54f3c7b
.quad 0xb530b775b4e44fb9,0xb5935229b56d1fc2,0xb54d8e73b50e2d99,0xb5a1cc01b58524fb,0xb569d656b529dba6,0xb5afb925b5935229,0xb582bdb6b54520f2,0xb5bd0d7ab5a10c5c
.quad 0xb590353bb55fecab,0xb5c9bd68b5ae48db,0xb59d485ab57a2e49,0xb5d5bde6b5bafd53,0xb5a9edf8b589eacf,0xb5e10486b5c71fd9,0xb5b61d48b596696a,0xb5eb8777b5d2a6f4
.quad 0xb5c1cdceb5a28b42,0xb5f53d98b5dd89a5,0xb5ccf767b5ae48db,0xb5fe1e75b5e7bf6d,0xb5d7924cb5b99af8,0xb603112bb5f14053,0xb5e1971db5c47a9d,0xb606a121b5fa04ee
.quad 0xb5eafedeb5cee116,0xb609bc05b6010332,0xb5f3c304b5d8c7f8,0xb60c5f21b6049f3b,0xb5fbdd75b5e22928,0xb60e882db607d3c2,0xb601a446b5eafede,0xb6103546b60a9e45
.quad 0xb604ff90b5f343a6,0xb61164f7b60cfc96,0xb607fe41b5faf267,0xb6121638b60eecde,0xb60a9e45b6010332,0xb6124870b6106d98,0xb60cddc6b6043da0,0xb611fb72b6117d97
.quad 0xb60ebb35b607267f,0xb6112f82b6121c09,0xb6103546b609bc05,0xb60fe551b6124870,0xb6114af0b60bfc98,0xb60e1dfdb61202ab,0xb611fb72b60de6d7,0xb60bdb13b6114af0
.quad 0xb6124653b60f7991,0xb6091e8bb61021ce,0xb6122b5db610b3d0,0xb605eac5b60e882d,0xb611aaa3b61194d1,0xb602428bb60c7f4d,0xb610c47fb6121c09,0xb5fc5213b60a08c4
.quad 0xb589eacfb55fecab,0xb5b99af8b5a28b42,0xb59a3e50b580539b,0xb5c916beb5b294a0,0xb5a9edf8b590353b,0xb5d7924cb5c1cdce,0xb5b8e91fb59f8be8,0xb5e4fb30b5d0250d
.quad 0xb5c71fd9b5ae48db,0xb5f14053b5dd89a5,0xb5d4830eb5bc5de1,0xb5fc5213b5e9ebf9,0xb5e10486b5c9bd68,0xb603112bb5f53d98,0xb5ec96f6b5d65a8d,0xb607524db5ff7151
.quad 0xb5f72e15b5e22928,0xb60ae704b6043da0,0xb6005f52b5ed1ddb,0xb60dcac0b608286d,0xb6049f3bb5f72e15,0xb60ff9d3b60b747e,0xb6085244b6002813,0xb6117174b60e1dfd
.quad 0xb60b747eb6043da0,0xb6122fc4b61021ce,0xb60e0296b607d3c2,0xb61233d2b6117d97,0xb60ff9d3b60ae704,0xb6117d97b6122fc4,0xb6115820b60d7471,0xb6100dfdb6123785
.quad 0xb6121c09b60f7991,0xb60de6d7b61194d1,0xb61244bdb610f474,0xb60b0ae4b6104865,0xb611d211b611e3ac,0xb6077dc8b60e53c4,0xb610c47fb6124653,0xb6034409b60bb938
.quad 0xb60f1d26b6121c09,0xb5fcc616b6087bc8,0xb60cddc6b61164f7,0xb5f1c208b6049f3b,0xb60a08c4b61021ce,0xb5e589f2b6002813,0xb606a121b60e53c4,0xb5d82d65b5f63706
.quad 0xb602aa7cb60bfc98,0xb5c9bd68b5eafede,0xb5fc5213b6091e8b,0xb5ba4c5fb5deb4c1,0xb5f24328b605bc5f,0xb5a9edf8b5d16703,0xb5e732e4b601d958,0xb598b70eb5c32527
.quad 0xb5db2d08b5faf267,0xb586bd8fb5b3ffcb,0xb5ce3e5bb5f14053,0xb56830c7b5a40897,0xb5c07498b5e6a5cc,0xb541be97b5935229,0xb5b1de66b5db2d08,0xb51a558cb581effd
.quad 0x361194d136124925,0x360bfc98360f7991,0x3610a2c836121c09,0x36094668360dae53,0x360f4c0c361194d1,0x360618d8360b747e,0x360d918d3610b3d0,0x360276ac3608cdd2
.quad 0x360b747e360f7991,0x35fcc6163605bc5f,0x3608f659360de6d7,0x35f3c3043602428b,0x360618d8360bfc98,0x35e9ebf935fcc616,0x3602ddfc3609bc05,0x35df498135f441cc
.quad 0x35fe90063607267f,0x35d3e4dd35eafede,0x35f6b2da36043da0,0x35c7c7f635e10486,0x35ee29ed36010332,0x35bafd5335d65a8d,0x35e4fb3035faf267,0x35ad901535cb0946
.quad 0x35db2d0835f343a6,0x359f8be835bf1987,0x35d0c64935eafede,0x3590fcfd35b294a0,0x35c5ce2f35e22928,0x3581effd35a58458,0x35ba4c5f35d8c7f8,0x3564e3fb3597f2e0
.quad 0x35ae48db35cee116,0x354520f23589eacf,0x35a1cc0135c47a9d,0x3524b27c3576ee32,0x3594de8135b99af8,0x3503b4cc3559460b,0x3587895d35ae48db,0x34c48929353af44f
.quad 0x3573abb835a28b42,0x3480fdd1351c10a8,0x35579b113596696a,0x33f4093434f96664,0x353af44f3589eacf,0xb265c89b34b9e8cf,0x351dcb64357a2e49,0xb416b1313473b441
.quad 0x3500349d355fecab,0xb48f416633e5b15b,0x34c48929354520f2,0xb4d2ada0b265c89b,0x348820443529dba6,0xb50ab153b40f868b,0x3416b131350e2d99,0xb52b933ab4882044
.quad 0x32e5c78034e44fb9,0xb54bdfecb4c81302,0xb3baa69f34abb772,0xb56b7b55b503b4cc,0xb4571e9634656a87,0xb58524fbb522f94b,0xb4a82a0c33e5b15b,0xb5941883b541be97
.quad 0x360103323607267f,0x35e2292835f343a6,0x35f89c3436037697,0x35d4830e35e7bf6d,0x35ee29ed35fe9006,0x35c5ce2f35db2d08,0x35e2baa935f53d98,0x35b61d4835cd9b20
.quad 0x35d65a8d35eafede,0x35a5845835bf1987,0x35c916be35dfddb7,0x3594188335afb925,0x35bafd5335d3e4dd,0x3581effd359f8be8,0x35ac1d4835c71fd9,0x355e43cf358ea4ac
.quad 0x359c866835b99af8,0x35378c73357a2e49,0x358c494335ab6341,0x350feb393555ef93,0x3576ee32359c8668,0x34cf25403530b775,0x35544390358d12bd,0x347ad83f350ab153
.quad 0x3530b775357a2e49,0x33ac4cc434c81302,0x350c6fa13559460b,0xb39df27f3473b441,0x34cf254035378c73,0xb473b44133ac4cc4,0x34848f3335152201,0xb4cb9c60b38f97d8
.quad 0x33e5b15b34e44fb9,0xb50e2d99b4656a87,0xb30f9c2b349d7f75,0xb535d7dbb4c0fed7,0xb43a80a0342c2ee1,0xb55c9a6bb50733b6,0xb4a82a0c32e5c780,0xb58121f4b52d4a63
.quad 0xb4f26126b3e5b15b,0xb5935229b552970b,0xb51dcb64b480fdd1,0xb5a4c6aab576ee32,0xb541be97b4c81302,0xb5b56939b58d12bd,0xb564e3fbb50733b6,0xb5c524a3b59e09eb
.quad 0xb5838b1eb529dba6,0xb5d3e4ddb5ae48db,0xb5941883b54bdfec,0xb5e1971db5bdbc9e,0xb5a40897b56d1fc2,0xb5ee29edb5cc532f,0xb5b34a6db586bd8f,0xb5f98d49b5d9fb8d
.quad 0xb5c1cdceb596696a,0xb601d958b5e6a5cc,0xb5cf8352b5a58458,0xb6064699b5f24328,0xb5dc5c66b5b3ffcb,0xb60a08c4b5fcc616,0xb5e84b67b5c1cdce,0xb60d1b10b603112b
.quad 0xb5e22928b5cee116,0xb6010332b5f343a6,0xb5efb7bab5dd89a5,0xb6064699b5ff7151,0xb5fbdd75b5eafede,0xb60a9e45b604ff90,0xb6034409b5f72e15,0xb60e0296b6096df1
.quad 0xb607d3c2b6010332,0xb6106d98b60cfc96,0xb60b9706b605bc5f,0xb611db0cb60fa5b5,0xb60e882db609bc05,0xb6124870b61164f7,0xb610a2c8b60cfc96,0xb611b505b6123785
.quad 0xb611e3acb60f7991,0xb61021ceb6121c09,0xb61248f7b6112f82,0xb60d918db61112ae,0xb611d211b6121c09,0xb60a08c4b60f1d26,0xb6107fabb6123ddd,0xb6058da7b60c3ea0
.quad 0xb60e53c4b61194d1,0xb6002813b6087bc8,0xb60b51a1b61021ce,0xb5f3c304b603dabe,0xb6077dc8b60de6d7,0xb5e589f2b5fcc616,0xb602ddfcb60ae704,0xb5d5bde6b5f03b2c
.quad 0xb5faf267b607267f,0xb5c47a9db5e22928,0xb5eeaf1ab602aa7c,0xb5b1de66b5d2a6f4,0xb5e10486b5faf267,0xb59e09ebb5c1cdce,0xb5d2073cb5ef33b3,0xb5891ffdb5afb925
.quad 0xb5c1cdceb5e22928,0xb5668aa8b59c8668,0xb5b070a8b5d3e4dd,0xb539409ab58854d7,0xb59e09ebb5c47a9d,0xb50ab153b5668aa8,0xb58ab54bb5b3ffcb,0xb4b65d1fb53af44f
.quad 0xb56d1fc2b5a28b42,0xb42c2ee1b50e2d99,0xb5437001b590353b,0x32ac561cb4c0fed7,0xb5189a11b57a2e49,0x34571e96b448d093,0xb4d9bcd9b552970b,0x34cb9c60b265c89b
.quad 0xb480fdd1b529dba6,0x35152201342c2ee1,0xb39df27fb500349d,0x3543700134b2d0fd,0x33c90008b4abb772,0x357066e6350733b6,0x348bb100b42c2ee1,0x358ddbe0353422d2
.quad 0xb60bfc98b607267f,0xb61194d1b60f7991,0xb60f34c5b60b747e,0xb61248f7b6117d97,0xb6114af0b60ebb35,0xb611aaa3b6124653,0xb6123adeb610f474,0xb60fbb41b611d211
.quad 0xb61202abb6121c09,0xb60c7f4db61021ce,0xb610a2c8b6122fc4,0xb607fe41b60d3932,0xb60e1dfdb6112f82,0xb602428bb6091e8b,0xb60a7965b60f1d26,0xb5f6b2dab603dabe
.quad 0xb605bc5fb60bfc98,0xb5e6a5ccb5faf267,0xb5ffe10ab607d3c2,0xb5d4830eb5ec0f80,0xb5f24328b602aa7c,0xb5c07498b5db2d08,0xb5e2baa9b5f9150b,0xb5aaa8d1b5c86f98
.quad 0xb5d16703b5eafede,0xb5935229b5b3ffcb,0xb5be6b4db5db2d08,0xb5754d41b59e09eb,0xb5a9edf8b5c9bd68,0xb541be97b586bd8f,0xb5941883b5b6d0e8,0xb50c6fa1b55c9a6b
.quad 0xb57a2e49b5a28b42,0xb4abb772b529dba6,0xb54a30e8b58d12bd,0xb3f40934b4eb5992,0xb5189a11b56d1fc2,0x33c90008b480fdd1,0xb4cb9c60b53e5a5e,0x34a10e0bb32c543e
.quad 0xb448d093b50e2d99,0x350733b6342c2ee1,0x31e5c8e2b4b9e8cf,0x353ca79134c0fed7,0x34571e96b42c2ee1,0x357066e635152201,0x34d2ada032e5c780,0x3590fcfd35488167
.quad 0x351c10a834656a87,0x35a8770c357a2e49,0x354d8e7334d6357f,0x35be6b4d3594de81,0x357d6bf8351c10a8,0x35d2a6f435ab6341,0x3595a424354bdfec,0x35e4fb3035c07498
.quad 0x35ab6341357a2e49,0x35f53d9835d3e4dd,0x35bfc74a35935229,0x3601a44635e589f2,0x35d2a6f435a8770c,0x36077dc835f53d98,0x35e3dc0635bc5de1,0x360c1dc736016ee5
.quad 0x35b99af835cee116,0x3589eacf35a28b42,0x35a7bafa35bf1987,0x356830c7358ea4ac,0x3594de8135ae48db,0x353af44f3573abb8,0x358121f4359c8668,0x350c6fa135488167
.quad 0x3559460b3589eacf,0x34b9e8cf351c10a8,0x352f0122356d1fc2,0x343357f834dd43ad,0x3503b4cc354520f2,0xb265c89b3480fdd1,0x34af446d351c10a8,0xb44ff7d5338f97d8
.quad 0x342c2ee134e44fb9,0xb4c81302b3e5b15b,0xb1e5c8e2348f4166,0xb513656eb4966127,0xb43a80a033e5b15b,0xb541be97b4f26126,0xb4b65d1fb365c312,0xb56ec39eb5266b46
.quad 0xb50733b6b4656a87,0xb58d12bdb552970b,0xb5326d5ab4c81302,0xb5a1cc01b57d6bf8,0xb55c9a6bb50e2d99,0xb5b56939b5935229,0xb582bdb6b5378c73,0xb5c7c7f6b5a6fe80
.quad 0xb596696ab55fecab,0xb5d8c7f8b5b99af8,0xb5a932b6b5838b1e,0xb5e84b67b5cb0946,0xb5bafd53b596696a,0xb5f63706b5db2d08,0xb5cbae79b5a8770c,0xb6013933b5e9ebf9
.quad 0xb5db2d08b5b99af8,0xb6067407b5f72e15,0xb5e961adb5c9bd68,0xb60ac2cfb6016ee5,0xb5f63706b5d8c7f8,0xb60e1dfdb6067407,0xb600cce1b5e6a5cc,0xb6107fabb60a9e45
.quad 0xb605bc5fb5f343a6,0xb611e3acb60de6d7,0xb609e28fb5fe9006,0xb612478fb6104865,0xb60d3932b6043da0,0xb611aaa3b611bf0e,0xb60fbb41b6087bc8,0xb6100dfdb6124870
.quad 0xb61164f7b60bfc98,0xb60d7471b611e3ac,0xb61233d2b60ebb35,0xb609e28fb6109166,0xb612269bb610b3d0,0xb6055e9cb60e53c4,0xb6113d66b611e3ac,0xb5ffe10ab60b2e6d
.quad 0x3529dba6355fecab,0x34656a8734e44fb9,0x34eedda63530b775,0x31e5c8e23473b441,0x348820443500349d,0xb4571e9632e5c780,0x33813cd8349d7f75,0xb4d9bcd9b43a80a0
.quad 0xb40f868b33e5b15b,0xb522f94bb4c81302,0xb4af446db3ac4cc4,0xb5579b11b5189a11,0xb50ab153b48f4166,0xb58524fbb54bdfec,0xb53ca791b4f26126,0xb59d485ab57d6bf8
.quad 0xb56d1fc2b529dba6,0xb5b3ffcbb596696a,0xb58ddbe0b559460b,0xb5c916beb5acd6e4,0xb5a40897b5838b1e,0xb5dc5c66b5c1cdce,0xb5b8e91fb5997ade,0xb5eda42db5d520bc
.quad 0xb5cc532fb5ae48db,0xb5fcc616b5e6a5cc,0xb5de1f77b5c1cdce,0xb604cf8fb5f63706,0xb5ee29edb5d3e4dd,0xb60a08c4b601d958,0xb5fc5213b5e46be1,0xb60e0296b6077dc8
.quad 0xb6043da0b5f343a6,0xb610b3d0b60bfc98,0xb6094668b6002813,0xb6121638b60f4c0c,0xb60d3932b605bc5f,0xb612269bb61164f7,0xb6100dfdb60a542f,0xb610e4d1b61242cc
.quad 0xb611bf0eb60de6d7,0xb60e53c4b611e3ac,0xb61248f7b6106d98,0xb60a7965b6104865,0xb611aaa3b611e3ac,0xb6055e9cb60d7471,0xb60fe551b6124653,0xb5fe1e75b6096df1
.quad 0xb60cfc96b61194d1,0xb5ef33b3b6043da0,0xb608f659b60fd075,0xb5de1f77b5fbdd75,0xb603dabeb60cfc96,0xb5cb0946b5ed1ddb,0xb5fb683cb6091e8b,0xb5b61d48b5dc5c66
.quad 0xb5ed1ddbb6043da0,0xb59f8be8b5c9bd68,0xb5dcf34ab5fcc616,0xb587895db5b56939,0xb5cb0946b5ef33b3,0xb55c9a6bb59f8be8,0xb5b78416b5dfddb7,0xb52823aab58854d7
```
